```python
import torch

def _softmax(x, axis=-1):
    return torch.softmax(x, dim=axis)
def _gelu(x):
    return torch.nn.functional.gelu(x, approximate="tanh")
def _silu(x):
    return torch.nn.functional.silu(x)
def _sigmoid(x):
    return torch.sigmoid(x)
def _layernorm(x, axis=-1, eps=1e-5):
    m = x.mean(dim=axis, keepdim=True)
    v = x.var(dim=axis, keepdim=True, unbiased=False)
    return (x - m) / torch.sqrt(v + eps)
def _scatter_add(tgt, idx, src, axis=0):
    return tgt.clone().index_add_(axis, idx, src)
def _segment_sum(src, seg, n):
    out = torch.zeros((n,) + src.shape[1:], dtype=src.dtype)
    return out.index_add_(0, seg, src)
def _pad(x, pw):
    flat = tuple(v for pair in reversed(pw) for v in pair)
    return torch.nn.functional.pad(x, flat)

kernel_name = 'concat_heads__gqa_block_cached__gqa_block_cached__near_ridge'

def setup_inputs():

    _w = (lambda a: (lambda t: t.to(torch.bfloat16) if t.is_floating_point() else t)(torch.as_tensor(a)))
    def _A_setup():
        B, Sq, D = 16, 128, 448
        Hq, Hkv, Sk, Dh = 16, 8, 1024, 256
        assert Hq % Hkv == 0, (Hq, Hkv)
        return {
            "x": _w((lambda *s: torch.randn(*s, dtype=torch.bfloat16) * 0.8)(B, Sq, D)),
            "k_cache": _w((lambda *s: torch.randn(*s, dtype=torch.bfloat16) * 0.8)(B, Hkv, Sk, Dh)),
            "v_cache": _w((lambda *s: torch.randn(*s, dtype=torch.bfloat16) * 0.05)(B, Hkv, Sk, Dh)),
            "wq": _w((lambda *s: torch.randn(*s, dtype=torch.bfloat16) * 0.8)(D, Hq * Dh) * (D ** -0.5)),
            "wo": _w((lambda *s: torch.randn(*s, dtype=torch.bfloat16) * 0.05)(Hq * Dh, D) * ((Hq * Dh) ** -0.5)),
        }
    _A_in = _A_setup()

    def _B_setup():
        B, Sq, D = 16, 128, 448
        Hq, Hkv, Sk, Dh = 16, 8, 1024, 256
        assert Hq % Hkv == 0, (Hq, Hkv)
        return {
            "x": _w((lambda *s: torch.randn(*s, dtype=torch.bfloat16) * 0.8)(B, Sq, D)),
            "k_cache": _w((lambda *s: torch.randn(*s, dtype=torch.bfloat16) * 0.8)(B, Hkv, Sk, Dh)),
            "v_cache": _w((lambda *s: torch.randn(*s, dtype=torch.bfloat16) * 0.05)(B, Hkv, Sk, Dh)),
            "wq": _w((lambda *s: torch.randn(*s, dtype=torch.bfloat16) * 0.8)(D, Hq * Dh) * (D ** -0.5)),
            "wo": _w((lambda *s: torch.randn(*s, dtype=torch.bfloat16) * 0.05)(Hq * Dh, D) * ((Hq * Dh) ** -0.5)),
        }
    _B_in = _B_setup()

    return {
        "A_x": _A_in["x"],
        "A_k_cache": _A_in["k_cache"],
        "A_v_cache": _A_in["v_cache"],
        "A_wq": _A_in["wq"],
        "A_wo": _A_in["wo"],
        "B_x": _B_in["x"],
        "B_k_cache": _B_in["k_cache"],
        "B_v_cache": _B_in["v_cache"],
        "B_wq": _B_in["wq"],
        "B_wo": _B_in["wo"],
    }

def reference(A_x, A_k_cache, A_v_cache, A_wq, A_wo, B_x, B_k_cache, B_v_cache, B_wq, B_wo):
    def _A_ref(x, k_cache, v_cache, wq, wo):
        B, Sq, D = x.shape
        Hq, Dh = 16, 256
        Hkv = k_cache.shape[1]
        rep = Hq // Hkv
        q = (lambda x, *d: x.permute(*d))((x @ wq).reshape(B, Sq, Hq, Dh), 0, 2, 1, 3)
        k = (lambda x, n, axis: torch.repeat_interleave(x, n, dim=axis))(k_cache, rep, axis=1)
        v = (lambda x, n, axis: torch.repeat_interleave(x, n, dim=axis))(v_cache, rep, axis=1)
        scores = torch.einsum("bhqd,bhkd->bhqk", q, k) * (Dh ** -0.5)
        p = _softmax(scores, axis=-1)
        o = torch.einsum("bhqk,bhkd->bhqd", p, v)
        return (lambda x, *d: x.permute(*d))(o, 0, 2, 1, 3).reshape(B, Sq, Hq * Dh) @ wo

    def _B_ref(x, k_cache, v_cache, wq, wo):
        B, Sq, D = x.shape
        Hq, Dh = 16, 256
        Hkv = k_cache.shape[1]
        rep = Hq // Hkv
        q = (lambda x, *d: x.permute(*d))((x @ wq).reshape(B, Sq, Hq, Dh), 0, 2, 1, 3)
        k = (lambda x, n, axis: torch.repeat_interleave(x, n, dim=axis))(k_cache, rep, axis=1)
        v = (lambda x, n, axis: torch.repeat_interleave(x, n, dim=axis))(v_cache, rep, axis=1)
        scores = torch.einsum("bhqd,bhkd->bhqk", q, k) * (Dh ** -0.5)
        p = _softmax(scores, axis=-1)
        o = torch.einsum("bhqk,bhkd->bhqd", p, v)
        return (lambda x, *d: x.permute(*d))(o, 0, 2, 1, 3).reshape(B, Sq, Hq * Dh) @ wo

    a = _A_ref(A_x, A_k_cache, A_v_cache, A_wq, A_wo)
    b = _B_ref(B_x, B_k_cache, B_v_cache, B_wq, B_wo)
    return torch.concatenate([a, b], axis=-1)
```

```asm
; @launch grid=(256,1,1) block=(256,1,1) lds=149760
.amdgcn_target "amdgcn-amd-amdhsa--gfx950"
.text
.globl concat_heads__gqa_block_cached__gqa_block_cached__near_ridge_kernel
.p2align 8
.type concat_heads__gqa_block_cached__gqa_block_cached__near_ridge_kernel,@function
concat_heads__gqa_block_cached__gqa_block_cached__near_ridge_kernel:
    s_cmp_ge_u32 s2, 256
    s_cbranch_scc1 L_end
    s_load_dwordx16 s[64:79], s[0:1], 0
    s_load_dwordx4 s[80:83], s[0:1], 64
    s_load_dwordx2 s[84:85], s[0:1], 96
    s_load_dwordx2 s[86:87], s[0:1], 80
    s_load_dwordx2 s[88:89], s[0:1], 88
    v_lshrrev_b32 v129, 6, v0
    v_and_b32 v128, 63, v0
    v_readfirstlane_b32 s28, v129
    s_and_b32 s3, s2, 3
    s_lshl_b32 s3, s3, 1
    s_bfe_u32 s36, s2, 0x10003
    s_or_b32 s3, s3, s36
    s_lshr_b32 s45, s2, 4
    s_bfe_u32 s44, s2, 0x10002
    s_lshl_b32 s36, s44, 4
    s_or_b32 s36, s36, s45
    s_lshl_b32 s2, s36, 3
    s_or_b32 s2, s2, s3
    s_mul_i32 s29, s28, 4160
    v_lshrrev_b32 v130, 3, v128
    v_mul_u32_u24 v130, 896, v130
    v_and_b32 v131, 7, v128
    v_lshl_add_u32 v15, v131, 4, v130
    v_lshrrev_b32 v130, 5, v128
    v_lshlrev_b32 v130, 4, v130
    v_bfe_u32 v131, v128, 4, 1
    v_lshl_add_u32 v130, v131, 2, v130
    v_lshrrev_b32 v131, 1, v129
    v_lshl_add_u32 v130, v131, 3, v130
    v_and_b32 v131, 1, v129
    v_lshl_add_u32 v130, v131, 1, v130
    v_lshlrev_b32 v130, 13, v130
    v_and_b32 v131, 15, v128
    v_lshl_add_u32 v14, v131, 4, v130
    s_cmp_eq_u32 s44, 1
    s_waitcnt lgkmcnt(0)
    s_cselect_b64 s[4:5], s[74:75], s[64:65]
    s_cselect_b64 s[8:9], s[80:81], s[70:71]
    s_cselect_b64 s[12:13], s[76:77], s[66:67]
    s_cselect_b64 s[16:17], s[78:79], s[68:69]
    s_cselect_b64 s[20:21], s[82:83], s[72:73]
    s_and_b32 s36, s3, 1
    s_mul_i32 s36, s36, 3
    s_add_u32 s36, s36, s45
    s_mul_i32 s44, s36, 37
    s_lshr_b32 s44, s44, 8
    s_mul_i32 s44, s44, 7
    s_sub_u32 s36, s36, s44
    s_lshl_b32 s62, s36, 19
    s_mul_i32 s46, s45, 114688
    s_mul_i32 s47, s28, 28672
    s_add_u32 s46, s46, s47
    s_add_u32 s4, s4, s46
    s_addc_u32 s5, s5, 0
    s_mov_b32 s6, 28672
    s_mov_b32 s7, 0x20000
    s_lshl_b32 s46, s3, 10
    s_add_u32 s8, s8, s46
    s_addc_u32 s9, s9, 0
    s_sub_u32 s10, 3670016, s46
    s_mov_b32 s11, 0x20000
    s_add_u32 m0, s29, 33280
    s_lshr_b32 s44, s62, 12
    s_add_u32 s36, s44, 0
    buffer_load_dwordx4 v15, s[4:7], s36 offen offset:0 nt lds
    s_add_u32 s36, s44, 6128
    buffer_load_dwordx4 v15, s[4:7], s36 offen offset:1040 nt lds
    s_add_u32 s36, s44, 12256
    buffer_load_dwordx4 v15, s[4:7], s36 offen offset:2080 nt lds
    s_add_u32 s36, s44, 18384
    buffer_load_dwordx4 v15, s[4:7], s36 offen offset:3120 nt lds
    s_add_u32 m0, s29, 133120
    s_add_u32 s36, s62, 0
    buffer_load_dwordx4 v14, s[8:11], s36 offen offset:0 nt lds
    s_add_u32 s36, s62, 261104
    buffer_load_dwordx4 v14, s[8:11], s36 offen offset:1040 nt lds
    s_add_u32 s36, s62, 6112
    buffer_load_dwordx4 v14, s[8:11], s36 offen offset:2080 nt lds
    s_add_u32 s36, s62, 267216
    buffer_load_dwordx4 v14, s[8:11], s36 offen offset:3120 nt lds
    s_add_u32 s63, s62, 524288
    s_cmp_eq_u32 s63, 3670016
    s_cselect_b32 s63, 0, s63
    s_add_u32 s82, s63, 524288
    s_cmp_eq_u32 s82, 3670016
    s_cselect_b32 s82, 0, s82
    s_add_u32 s83, s82, 524288
    s_cmp_eq_u32 s83, 3670016
    s_cselect_b32 s83, 0, s83
    s_add_u32 s80, s83, 524288
    s_cmp_eq_u32 s80, 3670016
    s_cselect_b32 s80, 0, s80
    s_add_u32 s81, s80, 524288
    s_cmp_eq_u32 s81, 3670016
    s_cselect_b32 s81, 0, s81
    s_add_u32 s79, s81, 524288
    s_cmp_eq_u32 s79, 3670016
    s_cselect_b32 s79, 0, s79
    s_add_u32 m0, s29, 49920
    s_add_u32 s36, s62, 256
    buffer_load_dwordx4 v14, s[8:11], s36 offen offset:0 nt lds
    s_add_u32 s36, s62, 261360
    buffer_load_dwordx4 v14, s[8:11], s36 offen offset:1040 nt lds
    s_add_u32 s36, s62, 6368
    buffer_load_dwordx4 v14, s[8:11], s36 offen offset:2080 nt lds
    s_add_u32 s36, s62, 267472
    buffer_load_dwordx4 v14, s[8:11], s36 offen offset:3120 nt lds
    s_add_u32 m0, s29, 66560
    s_lshr_b32 s44, s63, 12
    s_add_u32 s36, s44, 0
    buffer_load_dwordx4 v15, s[4:7], s36 offen offset:0 nt lds
    s_add_u32 s36, s44, 6128
    buffer_load_dwordx4 v15, s[4:7], s36 offen offset:1040 nt lds
    s_add_u32 s36, s44, 12256
    buffer_load_dwordx4 v15, s[4:7], s36 offen offset:2080 nt lds
    s_add_u32 s36, s44, 18384
    buffer_load_dwordx4 v15, s[4:7], s36 offen offset:3120 nt lds
    s_lshl_b32 s46, s45, 3
    s_add_u32 s46, s46, s3
    s_lshl_b32 s46, s46, 19
    s_add_u32 s12, s12, s46
    s_addc_u32 s13, s13, 0
    s_sub_u32 s12, s12, 64
    s_subb_u32 s13, s13, 0
    s_mov_b32 s14, 524352
    s_mov_b32 s15, 0x20000
    s_add_u32 s16, s16, s46
    s_addc_u32 s17, s17, 0
    s_sub_u32 s16, s16, 64
    s_subb_u32 s17, s17, 0
    s_mov_b32 s18, 524352
    s_mov_b32 s19, 0x20000
    s_mul_i32 s46, s3, 458752
    s_add_u32 s20, s20, s46
    s_addc_u32 s21, s21, 0
    s_sub_u32 s20, s20, 2048
    s_subb_u32 s21, s21, 0
    s_mov_b32 s22, 460800
    s_mov_b32 s23, 0x20000
    s_mov_b32 s24, s84
    s_mov_b32 s25, s85
    s_lshr_b32 s46, s2, 3
    s_mul_i32 s46, s46, 917504
    s_lshl_b32 s47, s28, 12
    s_add_u32 s46, s46, s47
    s_add_u32 s24, s24, s46
    s_addc_u32 s25, s25, 0
    s_mov_b32 s26, 905216
    s_mov_b32 s27, 0x20000
    s_mov_b32 s42, 0x3db8aa3b
    s_mov_b32 s43, 0x49800000
    s_mov_b32 s32, -16
    s_mov_b32 s55, -16
    s_mov_b32 s33, -32
    s_mov_b32 s60, -32
    s_mov_b32 s54, -48
    s_mov_b32 s61, -48
    s_mov_b32 s34, 16384
    s_mov_b32 s35, 16384
    s_mov_b32 s30, 81984
    s_mov_b32 s31, 65600
    s_mov_b32 s41, 0
    s_mov_b32 s37, 16640
    s_mov_b32 s38, 33280
    s_mov_b32 s39, 49920
    s_mov_b32 s40, 0
    v_lshlrev_b32 v130, 12, v129
    v_lshl_add_u32 v4, v128, 4, v130
    v_mov_b32 v5, v4
    v_and_b32 v130, 7, v128
    v_mul_u32_u24 v130, 2080, v130
    v_bfe_u32 v131, v128, 3, 1
    v_lshl_add_u32 v130, v131, 9, v130
    v_lshrrev_b32 v131, 4, v128
    v_lshl_add_u32 v0, v131, 4, v130
    v_bfe_u32 v130, v128, 2, 3
    v_mul_u32_u24 v130, 2080, v130
    v_lshrrev_b32 v131, 5, v128
    v_lshl_add_u32 v130, v131, 9, v130
    v_and_b32 v131, 3, v128
    v_lshl_add_u32 v1, v131, 3, v130
    v_add_u32 v3, 133120, v1
    v_bfe_u32 v130, v128, 3, 1
    v_mul_u32_u24 v130, 1040, v130
    v_and_b32 v131, 7, v128
    v_lshl_add_u32 v130, v131, 7, v130
    v_lshrrev_b32 v131, 4, v128
    v_lshl_add_u32 v130, v131, 4, v130
    v_add_u32 v16, s29, v130
    v_add_u32 v2, 33280, v16
    s_getpc_b64 s[48:49]
    s_and_b32 s36, s45, 3
    s_lshl_b32 s36, s36, 2
    s_add_u32 s36, s36, s28
    s_mul_i32 s36, s36, 3072
    v_min_u32 v130, 23, v128
    v_lshlrev_b32 v130, 7, v130
    v_add_u32 v130, s36, v130
    global_load_dword v20, v130, s[48:49]
    s_waitcnt vmcnt(9)
    s_barrier
    ds_read_b128 a[0:3], v2 offset:0
    ds_read_b128 a[4:7], v2 offset:2080
    ds_read_b128 a[8:11], v2 offset:64
    ds_read_b128 a[12:15], v2 offset:2144
    ds_read_b64_tr_b16 v[24:25], v3 offset:0
    ds_read_b64_tr_b16 v[26:27], v3 offset:256
    ds_read_b64_tr_b16 v[28:29], v3 offset:1040
    ds_read_b64_tr_b16 v[30:31], v3 offset:1296
    ds_read_b64_tr_b16 v[32:33], v3 offset:32
    ds_read_b64_tr_b16 v[34:35], v3 offset:288
    ds_read_b64_tr_b16 v[36:37], v3 offset:1072
    ds_read_b64_tr_b16 v[38:39], v3 offset:1328
    ds_read_b64_tr_b16 v[40:41], v3 offset:64
    ds_read_b64_tr_b16 v[42:43], v3 offset:320
    s_waitcnt lgkmcnt(6)
    ds_read_b64_tr_b16 v[44:45], v3 offset:1104
    ds_read_b64_tr_b16 v[46:47], v3 offset:1360
    v_mfma_f32_16x16x32_bf16 v[64:67], v[24:27], a[0:3], 0
    ds_read_b64_tr_b16 v[48:49], v3 offset:96
    ds_read_b64_tr_b16 v[50:51], v3 offset:352
    v_mfma_f32_16x16x32_bf16 v[64:67], v[28:31], a[8:11], v[64:67]
    s_add_u32 m0, s29, 83200
    s_add_u32 s36, s63, 0
    v_mfma_f32_16x16x32_bf16 v[68:71], v[24:27], a[4:7], 0
    ds_read_b64_tr_b16 v[52:53], v3 offset:1136
    ds_read_b64_tr_b16 v[54:55], v3 offset:1392
    v_mfma_f32_16x16x32_bf16 v[68:71], v[28:31], a[12:15], v[68:71]
    s_waitcnt lgkmcnt(8)
    buffer_load_dwordx4 v14, s[8:11], s36 offen offset:0 nt lds
    v_mfma_f32_16x16x32_bf16 v[72:75], v[32:35], a[0:3], 0
    ds_read_b64_tr_b16 v[24:25], v3 offset:128
    ds_read_b64_tr_b16 v[26:27], v3 offset:384
    v_mfma_f32_16x16x32_bf16 v[72:75], v[36:39], a[8:11], v[72:75]
    s_add_u32 s36, s63, 261104
    buffer_load_dwordx4 v14, s[8:11], s36 offen offset:1040 nt lds
    v_mfma_f32_16x16x32_bf16 v[76:79], v[32:35], a[4:7], 0
    ds_read_b64_tr_b16 v[28:29], v3 offset:1168
    ds_read_b64_tr_b16 v[30:31], v3 offset:1424
    v_mfma_f32_16x16x32_bf16 v[76:79], v[36:39], a[12:15], v[76:79]
    s_waitcnt lgkmcnt(8)
    s_add_u32 s36, s63, 6112
    v_mfma_f32_16x16x32_bf16 v[80:83], v[40:43], a[0:3], 0
    ds_read_b64_tr_b16 v[32:33], v3 offset:160
    ds_read_b64_tr_b16 v[34:35], v3 offset:416
    v_mfma_f32_16x16x32_bf16 v[80:83], v[44:47], a[8:11], v[80:83]
    buffer_load_dwordx4 v14, s[8:11], s36 offen offset:2080 nt lds
    v_mfma_f32_16x16x32_bf16 v[84:87], v[40:43], a[4:7], 0
    ds_read_b64_tr_b16 v[36:37], v3 offset:1200
    ds_read_b64_tr_b16 v[38:39], v3 offset:1456
    v_mfma_f32_16x16x32_bf16 v[84:87], v[44:47], a[12:15], v[84:87]
    s_waitcnt lgkmcnt(8)
    s_add_u32 s36, s63, 267216
    v_mfma_f32_16x16x32_bf16 v[88:91], v[48:51], a[0:3], 0
    ds_read_b64_tr_b16 v[40:41], v3 offset:192
    ds_read_b64_tr_b16 v[42:43], v3 offset:448
    buffer_load_dwordx4 v14, s[8:11], s36 offen offset:3120 nt lds
    v_mfma_f32_16x16x32_bf16 v[88:91], v[52:55], a[8:11], v[88:91]
    s_waitcnt vmcnt(9)
    s_barrier
    v_mfma_f32_16x16x32_bf16 v[92:95], v[48:51], a[4:7], 0
    ds_read_b64_tr_b16 v[44:45], v3 offset:1232
    ds_read_b64_tr_b16 v[46:47], v3 offset:1488
    v_mfma_f32_16x16x32_bf16 v[92:95], v[52:55], a[12:15], v[92:95]
    s_waitcnt lgkmcnt(8)
    s_add_u32 m0, s29, 0
    v_mfma_f32_16x16x32_bf16 v[96:99], v[24:27], a[0:3], 0
    ds_read_b64_tr_b16 v[48:49], v3 offset:224
    ds_read_b64_tr_b16 v[50:51], v3 offset:480
    v_mfma_f32_16x16x32_bf16 v[96:99], v[28:31], a[8:11], v[96:99]
    s_add_u32 s36, s63, 256
    buffer_load_dwordx4 v14, s[8:11], s36 offen offset:0 nt lds
    v_mfma_f32_16x16x32_bf16 v[100:103], v[24:27], a[4:7], 0
    ds_read_b64_tr_b16 v[52:53], v3 offset:1264
    ds_read_b64_tr_b16 v[54:55], v3 offset:1520
    v_mfma_f32_16x16x32_bf16 v[100:103], v[28:31], a[12:15], v[100:103]
    s_waitcnt lgkmcnt(8)
    s_add_u32 s36, s63, 261360
    v_add_u32 v3, 49920, v1
    v_mfma_f32_16x16x32_bf16 v[104:107], v[32:35], a[0:3], 0
    ds_read_b64_tr_b16 v[24:25], v3 offset:0
    ds_read_b64_tr_b16 v[26:27], v3 offset:256
    v_mfma_f32_16x16x32_bf16 v[104:107], v[36:39], a[8:11], v[104:107]
    buffer_load_dwordx4 v14, s[8:11], s36 offen offset:1040 nt lds
    v_mfma_f32_16x16x32_bf16 v[108:111], v[32:35], a[4:7], 0
    ds_read_b64_tr_b16 v[28:29], v3 offset:1040
    ds_read_b64_tr_b16 v[30:31], v3 offset:1296
    v_mfma_f32_16x16x32_bf16 v[108:111], v[36:39], a[12:15], v[108:111]
    s_waitcnt lgkmcnt(8)
    s_add_u32 s36, s63, 6368
    v_mfma_f32_16x16x32_bf16 v[112:115], v[40:43], a[0:3], 0
    ds_read_b64_tr_b16 v[32:33], v3 offset:32
    ds_read_b64_tr_b16 v[34:35], v3 offset:288
    v_mfma_f32_16x16x32_bf16 v[112:115], v[44:47], a[8:11], v[112:115]
    buffer_load_dwordx4 v14, s[8:11], s36 offen offset:2080 nt lds
    v_mfma_f32_16x16x32_bf16 v[116:119], v[40:43], a[4:7], 0
    ds_read_b64_tr_b16 v[36:37], v3 offset:1072
    ds_read_b64_tr_b16 v[38:39], v3 offset:1328
    v_mfma_f32_16x16x32_bf16 v[116:119], v[44:47], a[12:15], v[116:119]
    s_waitcnt lgkmcnt(8)
    s_add_u32 s36, s63, 267472
    v_mfma_f32_16x16x32_bf16 v[120:123], v[48:51], a[0:3], 0
    ds_read_b64_tr_b16 v[40:41], v3 offset:64
    ds_read_b64_tr_b16 v[42:43], v3 offset:320
    v_mfma_f32_16x16x32_bf16 v[120:123], v[52:55], a[8:11], v[120:123]
    buffer_load_dwordx4 v14, s[8:11], s36 offen offset:3120 nt lds
    v_mfma_f32_16x16x32_bf16 v[124:127], v[48:51], a[4:7], 0
    ds_read_b64_tr_b16 v[44:45], v3 offset:1104
    ds_read_b64_tr_b16 v[46:47], v3 offset:1360
    v_mfma_f32_16x16x32_bf16 v[124:127], v[52:55], a[12:15], v[124:127]
    s_waitcnt lgkmcnt(8)
    s_add_u32 m0, s29, 99840
    v_mfma_f32_16x16x32_bf16 v[192:195], v[24:27], a[0:3], 0
    ds_read_b64_tr_b16 v[48:49], v3 offset:96
    ds_read_b64_tr_b16 v[50:51], v3 offset:352
    v_mfma_f32_16x16x32_bf16 v[192:195], v[28:31], a[8:11], v[192:195]
    s_lshr_b32 s44, s82, 12
    s_add_u32 s36, s44, 0
    v_add_u32 v2, 66560, v16
    v_mfma_f32_16x16x32_bf16 v[196:199], v[24:27], a[4:7], 0
    ds_read_b64_tr_b16 v[52:53], v3 offset:1136
    ds_read_b64_tr_b16 v[54:55], v3 offset:1392
    v_mfma_f32_16x16x32_bf16 v[196:199], v[28:31], a[12:15], v[196:199]
    s_waitcnt lgkmcnt(8)
    buffer_load_dwordx4 v15, s[4:7], s36 offen offset:0 nt lds
    v_mfma_f32_16x16x32_bf16 v[200:203], v[32:35], a[0:3], 0
    ds_read_b64_tr_b16 v[24:25], v3 offset:128
    ds_read_b64_tr_b16 v[26:27], v3 offset:384
    v_mfma_f32_16x16x32_bf16 v[200:203], v[36:39], a[8:11], v[200:203]
    s_add_u32 s36, s44, 6128
    buffer_load_dwordx4 v15, s[4:7], s36 offen offset:1040 nt lds
    v_mfma_f32_16x16x32_bf16 v[204:207], v[32:35], a[4:7], 0
    ds_read_b64_tr_b16 v[28:29], v3 offset:1168
    ds_read_b64_tr_b16 v[30:31], v3 offset:1424
    v_mfma_f32_16x16x32_bf16 v[204:207], v[36:39], a[12:15], v[204:207]
    s_waitcnt lgkmcnt(8)
    s_add_u32 s36, s44, 12256
    v_mfma_f32_16x16x32_bf16 v[208:211], v[40:43], a[0:3], 0
    ds_read_b64_tr_b16 v[32:33], v3 offset:160
    ds_read_b64_tr_b16 v[34:35], v3 offset:416
    v_mfma_f32_16x16x32_bf16 v[208:211], v[44:47], a[8:11], v[208:211]
    buffer_load_dwordx4 v15, s[4:7], s36 offen offset:2080 nt lds
    v_mfma_f32_16x16x32_bf16 v[212:215], v[40:43], a[4:7], 0
    ds_read_b64_tr_b16 v[36:37], v3 offset:1200
    ds_read_b64_tr_b16 v[38:39], v3 offset:1456
    v_mfma_f32_16x16x32_bf16 v[212:215], v[44:47], a[12:15], v[212:215]
    s_waitcnt lgkmcnt(8)
    s_add_u32 s36, s44, 18384
    v_mfma_f32_16x16x32_bf16 v[216:219], v[48:51], a[0:3], 0
    ds_read_b64_tr_b16 v[40:41], v3 offset:192
    ds_read_b64_tr_b16 v[42:43], v3 offset:448
    buffer_load_dwordx4 v15, s[4:7], s36 offen offset:3120 nt lds
    v_mfma_f32_16x16x32_bf16 v[216:219], v[52:55], a[8:11], v[216:219]
    s_waitcnt vmcnt(8)
    s_barrier
    v_mfma_f32_16x16x32_bf16 v[220:223], v[48:51], a[4:7], 0
    ds_read_b64_tr_b16 v[44:45], v3 offset:1232
    ds_read_b64_tr_b16 v[46:47], v3 offset:1488
    v_mfma_f32_16x16x32_bf16 v[220:223], v[52:55], a[12:15], v[220:223]
    s_waitcnt lgkmcnt(8)
    s_add_u32 m0, s29, 16640
    v_mfma_f32_16x16x32_bf16 v[224:227], v[24:27], a[0:3], 0
    ds_read_b64_tr_b16 v[48:49], v3 offset:224
    ds_read_b64_tr_b16 v[50:51], v3 offset:480
    v_mfma_f32_16x16x32_bf16 v[224:227], v[28:31], a[8:11], v[224:227]
    ds_read_b128 a[16:19], v2 offset:0
    v_mfma_f32_16x16x32_bf16 v[228:231], v[24:27], a[4:7], 0
    ds_read_b64_tr_b16 v[52:53], v3 offset:1264
    ds_read_b64_tr_b16 v[54:55], v3 offset:1520
    v_mfma_f32_16x16x32_bf16 v[228:231], v[28:31], a[12:15], v[228:231]
    s_waitcnt lgkmcnt(9)
    s_add_u32 s36, s82, 0
    v_add_u32 v3, 83200, v1
    v_mfma_f32_16x16x32_bf16 v[232:235], v[32:35], a[0:3], 0
    ds_read_b64_tr_b16 v[24:25], v3 offset:0
    ds_read_b64_tr_b16 v[26:27], v3 offset:256
    v_mfma_f32_16x16x32_bf16 v[232:235], v[36:39], a[8:11], v[232:235]
    ds_read_b128 a[20:23], v2 offset:2080
    v_mfma_f32_16x16x32_bf16 v[236:239], v[32:35], a[4:7], 0
    ds_read_b64_tr_b16 v[28:29], v3 offset:1040
    ds_read_b64_tr_b16 v[30:31], v3 offset:1296
    v_mfma_f32_16x16x32_bf16 v[236:239], v[36:39], a[12:15], v[236:239]
    s_waitcnt lgkmcnt(10)
    buffer_load_dwordx4 v14, s[8:11], s36 offen offset:0 nt lds
    v_mfma_f32_16x16x32_bf16 v[240:243], v[40:43], a[0:3], 0
    ds_read_b64_tr_b16 v[32:33], v3 offset:32
    ds_read_b64_tr_b16 v[34:35], v3 offset:288
    v_mfma_f32_16x16x32_bf16 v[240:243], v[44:47], a[8:11], v[240:243]
    ds_read_b128 a[24:27], v2 offset:64
    v_mfma_f32_16x16x32_bf16 v[244:247], v[40:43], a[4:7], 0
    ds_read_b64_tr_b16 v[36:37], v3 offset:1072
    ds_read_b64_tr_b16 v[38:39], v3 offset:1328
    v_mfma_f32_16x16x32_bf16 v[244:247], v[44:47], a[12:15], v[244:247]
    s_waitcnt lgkmcnt(10)
    s_add_u32 s36, s82, 261104
    v_mfma_f32_16x16x32_bf16 v[248:251], v[48:51], a[0:3], 0
    ds_read_b64_tr_b16 v[40:41], v3 offset:64
    ds_read_b64_tr_b16 v[42:43], v3 offset:320
    v_mfma_f32_16x16x32_bf16 v[248:251], v[52:55], a[8:11], v[248:251]
    ds_read_b128 a[28:31], v2 offset:2144
    v_mfma_f32_16x16x32_bf16 v[252:255], v[48:51], a[4:7], 0
    ds_read_b64_tr_b16 v[44:45], v3 offset:1104
    ds_read_b64_tr_b16 v[46:47], v3 offset:1360
    v_mfma_f32_16x16x32_bf16 v[252:255], v[52:55], a[12:15], v[252:255]
    s_waitcnt lgkmcnt(2)
    buffer_load_dwordx4 v14, s[8:11], s36 offen offset:1040 nt lds
    v_mfma_f32_16x16x32_bf16 v[64:67], v[24:27], a[16:19], v[64:67]
    ds_read_b64_tr_b16 v[48:49], v3 offset:96
    ds_read_b64_tr_b16 v[50:51], v3 offset:352
    v_mfma_f32_16x16x32_bf16 v[64:67], v[28:31], a[24:27], v[64:67]
    s_add_u32 s36, s82, 6112
    buffer_load_dwordx4 v14, s[8:11], s36 offen offset:2080 nt lds
    v_mfma_f32_16x16x32_bf16 v[68:71], v[24:27], a[20:23], v[68:71]
    ds_read_b64_tr_b16 v[52:53], v3 offset:1136
    ds_read_b64_tr_b16 v[54:55], v3 offset:1392
    v_mfma_f32_16x16x32_bf16 v[68:71], v[28:31], a[28:31], v[68:71]
    s_add_u32 s36, s82, 267216
    buffer_load_dwordx4 v14, s[8:11], s36 offen offset:3120 nt lds
    v_mfma_f32_16x16x32_bf16 v[72:75], v[32:35], a[16:19], v[72:75]
    ds_read_b64_tr_b16 v[24:25], v3 offset:128
    ds_read_b64_tr_b16 v[26:27], v3 offset:384
    v_mfma_f32_16x16x32_bf16 v[72:75], v[36:39], a[24:27], v[72:75]
    s_add_u32 m0, s29, 116480
    s_add_u32 s36, s82, 256
    v_mfma_f32_16x16x32_bf16 v[76:79], v[32:35], a[20:23], v[76:79]
    ds_read_b64_tr_b16 v[28:29], v3 offset:1168
    ds_read_b64_tr_b16 v[30:31], v3 offset:1424
    v_mfma_f32_16x16x32_bf16 v[76:79], v[36:39], a[28:31], v[76:79]
    s_waitcnt lgkmcnt(8)
    buffer_load_dwordx4 v14, s[8:11], s36 offen offset:0 nt lds
    v_mfma_f32_16x16x32_bf16 v[80:83], v[40:43], a[16:19], v[80:83]
    ds_read_b64_tr_b16 v[32:33], v3 offset:160
    ds_read_b64_tr_b16 v[34:35], v3 offset:416
    v_mfma_f32_16x16x32_bf16 v[80:83], v[44:47], a[24:27], v[80:83]
    s_add_u32 s36, s82, 261360
    buffer_load_dwordx4 v14, s[8:11], s36 offen offset:1040 nt lds
    v_mfma_f32_16x16x32_bf16 v[84:87], v[40:43], a[20:23], v[84:87]
    ds_read_b64_tr_b16 v[36:37], v3 offset:1200
    ds_read_b64_tr_b16 v[38:39], v3 offset:1456
    v_mfma_f32_16x16x32_bf16 v[84:87], v[44:47], a[28:31], v[84:87]
    s_waitcnt lgkmcnt(8)
    s_add_u32 s36, s82, 6368
    v_mfma_f32_16x16x32_bf16 v[88:91], v[48:51], a[16:19], v[88:91]
    ds_read_b64_tr_b16 v[40:41], v3 offset:192
    ds_read_b64_tr_b16 v[42:43], v3 offset:448
    buffer_load_dwordx4 v14, s[8:11], s36 offen offset:2080 nt lds
    s_add_u32 s36, s82, 267472
    buffer_load_dwordx4 v14, s[8:11], s36 offen offset:3120 nt lds
    v_mfma_f32_16x16x32_bf16 v[88:91], v[52:55], a[24:27], v[88:91]
    s_waitcnt vmcnt(12)
    s_barrier
    v_mfma_f32_16x16x32_bf16 v[92:95], v[48:51], a[20:23], v[92:95]
    ds_read_b64_tr_b16 v[44:45], v3 offset:1232
    ds_read_b64_tr_b16 v[46:47], v3 offset:1488
    v_mfma_f32_16x16x32_bf16 v[92:95], v[52:55], a[28:31], v[92:95]
    s_waitcnt lgkmcnt(8)
    s_add_u32 m0, s29, 33280
    v_mfma_f32_16x16x32_bf16 v[96:99], v[24:27], a[16:19], v[96:99]
    ds_read_b64_tr_b16 v[48:49], v3 offset:224
    ds_read_b64_tr_b16 v[50:51], v3 offset:480
    v_mfma_f32_16x16x32_bf16 v[96:99], v[28:31], a[24:27], v[96:99]
    s_lshr_b32 s44, s83, 12
    s_add_u32 s36, s44, 0
    v_mfma_f32_16x16x32_bf16 v[100:103], v[24:27], a[20:23], v[100:103]
    ds_read_b64_tr_b16 v[52:53], v3 offset:1264
    ds_read_b64_tr_b16 v[54:55], v3 offset:1520
    v_mfma_f32_16x16x32_bf16 v[100:103], v[28:31], a[28:31], v[100:103]
    s_waitcnt lgkmcnt(8)
    v_add_u32 v3, 0, v1
    v_mfma_f32_16x16x32_bf16 v[104:107], v[32:35], a[16:19], v[104:107]
    ds_read_b64_tr_b16 v[24:25], v3 offset:0
    ds_read_b64_tr_b16 v[26:27], v3 offset:256
    v_mfma_f32_16x16x32_bf16 v[104:107], v[36:39], a[24:27], v[104:107]
    buffer_load_dwordx4 v15, s[4:7], s36 offen offset:0 nt lds
    v_mfma_f32_16x16x32_bf16 v[108:111], v[32:35], a[20:23], v[108:111]
    ds_read_b64_tr_b16 v[28:29], v3 offset:1040
    ds_read_b64_tr_b16 v[30:31], v3 offset:1296
    v_mfma_f32_16x16x32_bf16 v[108:111], v[36:39], a[28:31], v[108:111]
    s_waitcnt lgkmcnt(8)
    s_add_u32 s36, s44, 6128
    v_mfma_f32_16x16x32_bf16 v[112:115], v[40:43], a[16:19], v[112:115]
    ds_read_b64_tr_b16 v[32:33], v3 offset:32
    ds_read_b64_tr_b16 v[34:35], v3 offset:288
    v_mfma_f32_16x16x32_bf16 v[112:115], v[44:47], a[24:27], v[112:115]
    buffer_load_dwordx4 v15, s[4:7], s36 offen offset:1040 nt lds
    v_mfma_f32_16x16x32_bf16 v[116:119], v[40:43], a[20:23], v[116:119]
    ds_read_b64_tr_b16 v[36:37], v3 offset:1072
    ds_read_b64_tr_b16 v[38:39], v3 offset:1328
    v_mfma_f32_16x16x32_bf16 v[116:119], v[44:47], a[28:31], v[116:119]
    s_waitcnt lgkmcnt(8)
    s_add_u32 s36, s44, 12256
    v_mfma_f32_16x16x32_bf16 v[120:123], v[48:51], a[16:19], v[120:123]
    ds_read_b64_tr_b16 v[40:41], v3 offset:64
    ds_read_b64_tr_b16 v[42:43], v3 offset:320
    v_mfma_f32_16x16x32_bf16 v[120:123], v[52:55], a[24:27], v[120:123]
    buffer_load_dwordx4 v15, s[4:7], s36 offen offset:2080 nt lds
    v_mfma_f32_16x16x32_bf16 v[124:127], v[48:51], a[20:23], v[124:127]
    ds_read_b64_tr_b16 v[44:45], v3 offset:1104
    ds_read_b64_tr_b16 v[46:47], v3 offset:1360
    v_mfma_f32_16x16x32_bf16 v[124:127], v[52:55], a[28:31], v[124:127]
    s_waitcnt lgkmcnt(8)
    s_add_u32 s36, s44, 18384
    v_mfma_f32_16x16x32_bf16 v[192:195], v[24:27], a[16:19], v[192:195]
    ds_read_b64_tr_b16 v[48:49], v3 offset:96
    ds_read_b64_tr_b16 v[50:51], v3 offset:352
    v_mfma_f32_16x16x32_bf16 v[192:195], v[28:31], a[24:27], v[192:195]
    v_add_u32 v2, 99840, v16
    v_mfma_f32_16x16x32_bf16 v[196:199], v[24:27], a[20:23], v[196:199]
    ds_read_b64_tr_b16 v[52:53], v3 offset:1136
    ds_read_b64_tr_b16 v[54:55], v3 offset:1392
    v_mfma_f32_16x16x32_bf16 v[196:199], v[28:31], a[28:31], v[196:199]
    s_waitcnt lgkmcnt(8)
    buffer_load_dwordx4 v15, s[4:7], s36 offen offset:3120 nt lds
    v_mfma_f32_16x16x32_bf16 v[200:203], v[32:35], a[16:19], v[200:203]
    ds_read_b64_tr_b16 v[24:25], v3 offset:128
    ds_read_b64_tr_b16 v[26:27], v3 offset:384
    v_mfma_f32_16x16x32_bf16 v[200:203], v[36:39], a[24:27], v[200:203]
    s_add_u32 m0, s29, 133120
    s_add_u32 s36, s83, 0
    v_mfma_f32_16x16x32_bf16 v[204:207], v[32:35], a[20:23], v[204:207]
    ds_read_b64_tr_b16 v[28:29], v3 offset:1168
    ds_read_b64_tr_b16 v[30:31], v3 offset:1424
    v_mfma_f32_16x16x32_bf16 v[204:207], v[36:39], a[28:31], v[204:207]
    s_waitcnt lgkmcnt(8)
    buffer_load_dwordx4 v14, s[8:11], s36 offen offset:0 nt lds
    v_mfma_f32_16x16x32_bf16 v[208:211], v[40:43], a[16:19], v[208:211]
    ds_read_b64_tr_b16 v[32:33], v3 offset:160
    ds_read_b64_tr_b16 v[34:35], v3 offset:416
    v_mfma_f32_16x16x32_bf16 v[208:211], v[44:47], a[24:27], v[208:211]
    s_add_u32 s36, s83, 261104
    buffer_load_dwordx4 v14, s[8:11], s36 offen offset:1040 nt lds
    v_mfma_f32_16x16x32_bf16 v[212:215], v[40:43], a[20:23], v[212:215]
    ds_read_b64_tr_b16 v[36:37], v3 offset:1200
    ds_read_b64_tr_b16 v[38:39], v3 offset:1456
    v_mfma_f32_16x16x32_bf16 v[212:215], v[44:47], a[28:31], v[212:215]
    s_waitcnt lgkmcnt(8)
    s_add_u32 s36, s83, 6112
    v_mfma_f32_16x16x32_bf16 v[216:219], v[48:51], a[16:19], v[216:219]
    ds_read_b64_tr_b16 v[40:41], v3 offset:192
    ds_read_b64_tr_b16 v[42:43], v3 offset:448
    buffer_load_dwordx4 v14, s[8:11], s36 offen offset:2080 nt lds
    s_add_u32 s36, s83, 267216
    buffer_load_dwordx4 v14, s[8:11], s36 offen offset:3120 nt lds
    v_mfma_f32_16x16x32_bf16 v[216:219], v[52:55], a[24:27], v[216:219]
    s_waitcnt vmcnt(8)
    s_barrier
    v_mfma_f32_16x16x32_bf16 v[220:223], v[48:51], a[20:23], v[220:223]
    ds_read_b64_tr_b16 v[44:45], v3 offset:1232
    ds_read_b64_tr_b16 v[46:47], v3 offset:1488
    v_mfma_f32_16x16x32_bf16 v[220:223], v[52:55], a[28:31], v[220:223]
    s_waitcnt lgkmcnt(8)
    s_add_u32 m0, s29, 49920
    v_mfma_f32_16x16x32_bf16 v[224:227], v[24:27], a[16:19], v[224:227]
    ds_read_b64_tr_b16 v[48:49], v3 offset:224
    ds_read_b64_tr_b16 v[50:51], v3 offset:480
    v_mfma_f32_16x16x32_bf16 v[224:227], v[28:31], a[24:27], v[224:227]
    ds_read_b128 a[32:35], v2 offset:0
    v_mfma_f32_16x16x32_bf16 v[228:231], v[24:27], a[20:23], v[228:231]
    ds_read_b64_tr_b16 v[52:53], v3 offset:1264
    ds_read_b64_tr_b16 v[54:55], v3 offset:1520
    v_mfma_f32_16x16x32_bf16 v[228:231], v[28:31], a[28:31], v[228:231]
    s_waitcnt lgkmcnt(9)
    s_add_u32 s36, s83, 256
    v_add_u32 v3, 16640, v1
    v_mfma_f32_16x16x32_bf16 v[232:235], v[32:35], a[16:19], v[232:235]
    ds_read_b64_tr_b16 v[24:25], v3 offset:0
    ds_read_b64_tr_b16 v[26:27], v3 offset:256
    v_mfma_f32_16x16x32_bf16 v[232:235], v[36:39], a[24:27], v[232:235]
    ds_read_b128 a[36:39], v2 offset:2080
    v_mfma_f32_16x16x32_bf16 v[236:239], v[32:35], a[20:23], v[236:239]
    ds_read_b64_tr_b16 v[28:29], v3 offset:1040
    ds_read_b64_tr_b16 v[30:31], v3 offset:1296
    v_mfma_f32_16x16x32_bf16 v[236:239], v[36:39], a[28:31], v[236:239]
    s_waitcnt lgkmcnt(10)
    buffer_load_dwordx4 v14, s[8:11], s36 offen offset:0 nt lds
    v_mfma_f32_16x16x32_bf16 v[240:243], v[40:43], a[16:19], v[240:243]
    ds_read_b64_tr_b16 v[32:33], v3 offset:32
    ds_read_b64_tr_b16 v[34:35], v3 offset:288
    v_mfma_f32_16x16x32_bf16 v[240:243], v[44:47], a[24:27], v[240:243]
    ds_read_b128 a[40:43], v2 offset:64
    v_mfma_f32_16x16x32_bf16 v[244:247], v[40:43], a[20:23], v[244:247]
    ds_read_b64_tr_b16 v[36:37], v3 offset:1072
    ds_read_b64_tr_b16 v[38:39], v3 offset:1328
    v_mfma_f32_16x16x32_bf16 v[244:247], v[44:47], a[28:31], v[244:247]
    s_waitcnt lgkmcnt(10)
    s_add_u32 s36, s83, 261360
    v_mfma_f32_16x16x32_bf16 v[248:251], v[48:51], a[16:19], v[248:251]
    ds_read_b64_tr_b16 v[40:41], v3 offset:64
    ds_read_b64_tr_b16 v[42:43], v3 offset:320
    v_mfma_f32_16x16x32_bf16 v[248:251], v[52:55], a[24:27], v[248:251]
    ds_read_b128 a[44:47], v2 offset:2144
    v_mfma_f32_16x16x32_bf16 v[252:255], v[48:51], a[20:23], v[252:255]
    ds_read_b64_tr_b16 v[44:45], v3 offset:1104
    ds_read_b64_tr_b16 v[46:47], v3 offset:1360
    v_mfma_f32_16x16x32_bf16 v[252:255], v[52:55], a[28:31], v[252:255]
    s_waitcnt lgkmcnt(2)
    buffer_load_dwordx4 v14, s[8:11], s36 offen offset:1040 nt lds
    v_mfma_f32_16x16x32_bf16 v[64:67], v[24:27], a[32:35], v[64:67]
    ds_read_b64_tr_b16 v[48:49], v3 offset:96
    ds_read_b64_tr_b16 v[50:51], v3 offset:352
    v_mfma_f32_16x16x32_bf16 v[64:67], v[28:31], a[40:43], v[64:67]
    s_add_u32 s36, s83, 6368
    buffer_load_dwordx4 v14, s[8:11], s36 offen offset:2080 nt lds
    v_mfma_f32_16x16x32_bf16 v[68:71], v[24:27], a[36:39], v[68:71]
    ds_read_b64_tr_b16 v[52:53], v3 offset:1136
    ds_read_b64_tr_b16 v[54:55], v3 offset:1392
    v_mfma_f32_16x16x32_bf16 v[68:71], v[28:31], a[44:47], v[68:71]
    s_add_u32 s36, s83, 267472
    buffer_load_dwordx4 v14, s[8:11], s36 offen offset:3120 nt lds
    v_mfma_f32_16x16x32_bf16 v[72:75], v[32:35], a[32:35], v[72:75]
    ds_read_b64_tr_b16 v[24:25], v3 offset:128
    ds_read_b64_tr_b16 v[26:27], v3 offset:384
    v_mfma_f32_16x16x32_bf16 v[72:75], v[36:39], a[40:43], v[72:75]
    s_add_u32 m0, s29, 66560
    s_lshr_b32 s44, s80, 12
    v_mfma_f32_16x16x32_bf16 v[76:79], v[32:35], a[36:39], v[76:79]
    ds_read_b64_tr_b16 v[28:29], v3 offset:1168
    ds_read_b64_tr_b16 v[30:31], v3 offset:1424
    v_mfma_f32_16x16x32_bf16 v[76:79], v[36:39], a[44:47], v[76:79]
    s_waitcnt lgkmcnt(8)
    s_add_u32 s36, s44, 0
    v_mfma_f32_16x16x32_bf16 v[80:83], v[40:43], a[32:35], v[80:83]
    ds_read_b64_tr_b16 v[32:33], v3 offset:160
    ds_read_b64_tr_b16 v[34:35], v3 offset:416
    v_mfma_f32_16x16x32_bf16 v[80:83], v[44:47], a[40:43], v[80:83]
    buffer_load_dwordx4 v15, s[4:7], s36 offen offset:0 nt lds
    v_mfma_f32_16x16x32_bf16 v[84:87], v[40:43], a[36:39], v[84:87]
    ds_read_b64_tr_b16 v[36:37], v3 offset:1200
    ds_read_b64_tr_b16 v[38:39], v3 offset:1456
    v_mfma_f32_16x16x32_bf16 v[84:87], v[44:47], a[44:47], v[84:87]
    s_waitcnt lgkmcnt(8)
    s_add_u32 s36, s44, 6128
    v_mfma_f32_16x16x32_bf16 v[88:91], v[48:51], a[32:35], v[88:91]
    ds_read_b64_tr_b16 v[40:41], v3 offset:192
    ds_read_b64_tr_b16 v[42:43], v3 offset:448
    buffer_load_dwordx4 v15, s[4:7], s36 offen offset:1040 nt lds
    s_add_u32 s36, s44, 12256
    buffer_load_dwordx4 v15, s[4:7], s36 offen offset:2080 nt lds
    s_add_u32 s36, s44, 18384
    buffer_load_dwordx4 v15, s[4:7], s36 offen offset:3120 nt lds
    v_mfma_f32_16x16x32_bf16 v[88:91], v[52:55], a[40:43], v[88:91]
    v_mfma_f32_16x16x32_bf16 v[92:95], v[48:51], a[36:39], v[92:95]
    ds_read_b64_tr_b16 v[44:45], v3 offset:1232
    ds_read_b64_tr_b16 v[46:47], v3 offset:1488
    v_mfma_f32_16x16x32_bf16 v[92:95], v[52:55], a[44:47], v[92:95]
    s_waitcnt lgkmcnt(8)
    s_add_u32 m0, s29, 83200
    v_mfma_f32_16x16x32_bf16 v[96:99], v[24:27], a[32:35], v[96:99]
    ds_read_b64_tr_b16 v[48:49], v3 offset:224
    ds_read_b64_tr_b16 v[50:51], v3 offset:480
    v_mfma_f32_16x16x32_bf16 v[96:99], v[28:31], a[40:43], v[96:99]
    s_add_u32 s36, s80, 0
    v_mfma_f32_16x16x32_bf16 v[100:103], v[24:27], a[36:39], v[100:103]
    ds_read_b64_tr_b16 v[52:53], v3 offset:1264
    ds_read_b64_tr_b16 v[54:55], v3 offset:1520
    v_mfma_f32_16x16x32_bf16 v[100:103], v[28:31], a[44:47], v[100:103]
    s_waitcnt lgkmcnt(8)
    v_add_u32 v3, 116480, v1
    v_mfma_f32_16x16x32_bf16 v[104:107], v[32:35], a[32:35], v[104:107]
    ds_read_b64_tr_b16 v[24:25], v3 offset:0
    ds_read_b64_tr_b16 v[26:27], v3 offset:256
    v_mfma_f32_16x16x32_bf16 v[104:107], v[36:39], a[40:43], v[104:107]
    buffer_load_dwordx4 v14, s[8:11], s36 offen offset:0 nt lds
    v_mfma_f32_16x16x32_bf16 v[108:111], v[32:35], a[36:39], v[108:111]
    ds_read_b64_tr_b16 v[28:29], v3 offset:1040
    ds_read_b64_tr_b16 v[30:31], v3 offset:1296
    v_mfma_f32_16x16x32_bf16 v[108:111], v[36:39], a[44:47], v[108:111]
    s_waitcnt lgkmcnt(8)
    s_add_u32 s36, s80, 261104
    v_mfma_f32_16x16x32_bf16 v[112:115], v[40:43], a[32:35], v[112:115]
    ds_read_b64_tr_b16 v[32:33], v3 offset:32
    ds_read_b64_tr_b16 v[34:35], v3 offset:288
    v_mfma_f32_16x16x32_bf16 v[112:115], v[44:47], a[40:43], v[112:115]
    v_mfma_f32_16x16x32_bf16 v[116:119], v[40:43], a[36:39], v[116:119]
    ds_read_b64_tr_b16 v[36:37], v3 offset:1072
    ds_read_b64_tr_b16 v[38:39], v3 offset:1328
    v_mfma_f32_16x16x32_bf16 v[116:119], v[44:47], a[44:47], v[116:119]
    s_waitcnt lgkmcnt(8)
    buffer_load_dwordx4 v14, s[8:11], s36 offen offset:1040 nt lds
    v_mfma_f32_16x16x32_bf16 v[120:123], v[48:51], a[32:35], v[120:123]
    ds_read_b64_tr_b16 v[40:41], v3 offset:64
    ds_read_b64_tr_b16 v[42:43], v3 offset:320
    v_mfma_f32_16x16x32_bf16 v[120:123], v[52:55], a[40:43], v[120:123]
    v_mfma_f32_16x16x32_bf16 v[124:127], v[48:51], a[36:39], v[124:127]
    ds_read_b64_tr_b16 v[44:45], v3 offset:1104
    ds_read_b64_tr_b16 v[46:47], v3 offset:1360
    v_mfma_f32_16x16x32_bf16 v[124:127], v[52:55], a[44:47], v[124:127]
    s_waitcnt lgkmcnt(8)
    s_add_u32 s36, s80, 6112
    v_mfma_f32_16x16x32_bf16 v[192:195], v[24:27], a[32:35], v[192:195]
    ds_read_b64_tr_b16 v[48:49], v3 offset:96
    ds_read_b64_tr_b16 v[50:51], v3 offset:352
    v_mfma_f32_16x16x32_bf16 v[192:195], v[28:31], a[40:43], v[192:195]
    v_add_u32 v2, 33280, v16
    v_mfma_f32_16x16x32_bf16 v[196:199], v[24:27], a[36:39], v[196:199]
    ds_read_b64_tr_b16 v[52:53], v3 offset:1136
    ds_read_b64_tr_b16 v[54:55], v3 offset:1392
    v_mfma_f32_16x16x32_bf16 v[196:199], v[28:31], a[44:47], v[196:199]
    s_waitcnt lgkmcnt(8)
    buffer_load_dwordx4 v14, s[8:11], s36 offen offset:2080 nt lds
    v_mfma_f32_16x16x32_bf16 v[200:203], v[32:35], a[32:35], v[200:203]
    ds_read_b64_tr_b16 v[24:25], v3 offset:128
    ds_read_b64_tr_b16 v[26:27], v3 offset:384
    v_mfma_f32_16x16x32_bf16 v[200:203], v[36:39], a[40:43], v[200:203]
    s_add_u32 s36, s80, 267216
    v_mfma_f32_16x16x32_bf16 v[204:207], v[32:35], a[36:39], v[204:207]
    ds_read_b64_tr_b16 v[28:29], v3 offset:1168
    ds_read_b64_tr_b16 v[30:31], v3 offset:1424
    v_mfma_f32_16x16x32_bf16 v[204:207], v[36:39], a[44:47], v[204:207]
    s_waitcnt lgkmcnt(8)
    buffer_load_dwordx4 v14, s[8:11], s36 offen offset:3120 nt lds
    v_mfma_f32_16x16x32_bf16 v[208:211], v[40:43], a[32:35], v[208:211]
    ds_read_b64_tr_b16 v[32:33], v3 offset:160
    ds_read_b64_tr_b16 v[34:35], v3 offset:416
    v_mfma_f32_16x16x32_bf16 v[208:211], v[44:47], a[40:43], v[208:211]
    v_mfma_f32_16x16x32_bf16 v[212:215], v[40:43], a[36:39], v[212:215]
    ds_read_b64_tr_b16 v[36:37], v3 offset:1200
    ds_read_b64_tr_b16 v[38:39], v3 offset:1456
    v_mfma_f32_16x16x32_bf16 v[212:215], v[44:47], a[44:47], v[212:215]
    s_waitcnt lgkmcnt(8)
    v_mfma_f32_16x16x32_bf16 v[216:219], v[48:51], a[32:35], v[216:219]
    ds_read_b64_tr_b16 v[40:41], v3 offset:192
    ds_read_b64_tr_b16 v[42:43], v3 offset:448
    v_mfma_f32_16x16x32_bf16 v[216:219], v[52:55], a[40:43], v[216:219]
    s_waitcnt vmcnt(8)
    s_barrier
    v_mfma_f32_16x16x32_bf16 v[220:223], v[48:51], a[36:39], v[220:223]
    ds_read_b64_tr_b16 v[44:45], v3 offset:1232
    ds_read_b64_tr_b16 v[46:47], v3 offset:1488
    v_mfma_f32_16x16x32_bf16 v[220:223], v[52:55], a[44:47], v[220:223]
    s_waitcnt lgkmcnt(8)
    s_add_u32 m0, s29, 0
    v_mfma_f32_16x16x32_bf16 v[224:227], v[24:27], a[32:35], v[224:227]
    ds_read_b64_tr_b16 v[48:49], v3 offset:224
    ds_read_b64_tr_b16 v[50:51], v3 offset:480
    v_mfma_f32_16x16x32_bf16 v[224:227], v[28:31], a[40:43], v[224:227]
    ds_read_b128 a[48:51], v2 offset:0
    v_mfma_f32_16x16x32_bf16 v[228:231], v[24:27], a[36:39], v[228:231]
    ds_read_b64_tr_b16 v[52:53], v3 offset:1264
    ds_read_b64_tr_b16 v[54:55], v3 offset:1520
    v_mfma_f32_16x16x32_bf16 v[228:231], v[28:31], a[44:47], v[228:231]
    s_waitcnt lgkmcnt(9)
    s_add_u32 s36, s80, 256
    v_add_u32 v3, 133120, v1
    v_mfma_f32_16x16x32_bf16 v[232:235], v[32:35], a[32:35], v[232:235]
    ds_read_b64_tr_b16 v[24:25], v3 offset:0
    ds_read_b64_tr_b16 v[26:27], v3 offset:256
    v_mfma_f32_16x16x32_bf16 v[232:235], v[36:39], a[40:43], v[232:235]
    ds_read_b128 a[52:55], v2 offset:2080
    v_mfma_f32_16x16x32_bf16 v[236:239], v[32:35], a[36:39], v[236:239]
    ds_read_b64_tr_b16 v[28:29], v3 offset:1040
    ds_read_b64_tr_b16 v[30:31], v3 offset:1296
    v_mfma_f32_16x16x32_bf16 v[236:239], v[36:39], a[44:47], v[236:239]
    s_waitcnt lgkmcnt(10)
    buffer_load_dwordx4 v14, s[8:11], s36 offen offset:0 nt lds
    v_mfma_f32_16x16x32_bf16 v[240:243], v[40:43], a[32:35], v[240:243]
    ds_read_b64_tr_b16 v[32:33], v3 offset:32
    ds_read_b64_tr_b16 v[34:35], v3 offset:288
    v_mfma_f32_16x16x32_bf16 v[240:243], v[44:47], a[40:43], v[240:243]
    ds_read_b128 a[56:59], v2 offset:64
    v_mfma_f32_16x16x32_bf16 v[244:247], v[40:43], a[36:39], v[244:247]
    ds_read_b64_tr_b16 v[36:37], v3 offset:1072
    ds_read_b64_tr_b16 v[38:39], v3 offset:1328
    v_mfma_f32_16x16x32_bf16 v[244:247], v[44:47], a[44:47], v[244:247]
    s_waitcnt lgkmcnt(10)
    s_add_u32 s36, s80, 261360
    v_mfma_f32_16x16x32_bf16 v[248:251], v[48:51], a[32:35], v[248:251]
    ds_read_b64_tr_b16 v[40:41], v3 offset:64
    ds_read_b64_tr_b16 v[42:43], v3 offset:320
    v_mfma_f32_16x16x32_bf16 v[248:251], v[52:55], a[40:43], v[248:251]
    ds_read_b128 a[60:63], v2 offset:2144
    v_mfma_f32_16x16x32_bf16 v[252:255], v[48:51], a[36:39], v[252:255]
    ds_read_b64_tr_b16 v[44:45], v3 offset:1104
    ds_read_b64_tr_b16 v[46:47], v3 offset:1360
    v_mfma_f32_16x16x32_bf16 v[252:255], v[52:55], a[44:47], v[252:255]
    s_waitcnt lgkmcnt(2)
    buffer_load_dwordx4 v14, s[8:11], s36 offen offset:1040 nt lds
    v_mfma_f32_16x16x32_bf16 v[64:67], v[24:27], a[48:51], v[64:67]
    ds_read_b64_tr_b16 v[48:49], v3 offset:96
    ds_read_b64_tr_b16 v[50:51], v3 offset:352
    v_mfma_f32_16x16x32_bf16 v[64:67], v[28:31], a[56:59], v[64:67]
    s_add_u32 s36, s80, 6368
    buffer_load_dwordx4 v14, s[8:11], s36 offen offset:2080 nt lds
    v_mfma_f32_16x16x32_bf16 v[68:71], v[24:27], a[52:55], v[68:71]
    ds_read_b64_tr_b16 v[52:53], v3 offset:1136
    ds_read_b64_tr_b16 v[54:55], v3 offset:1392
    v_mfma_f32_16x16x32_bf16 v[68:71], v[28:31], a[60:63], v[68:71]
    s_add_u32 s36, s80, 267472
    buffer_load_dwordx4 v14, s[8:11], s36 offen offset:3120 nt lds
    v_mfma_f32_16x16x32_bf16 v[72:75], v[32:35], a[48:51], v[72:75]
    ds_read_b64_tr_b16 v[24:25], v3 offset:128
    ds_read_b64_tr_b16 v[26:27], v3 offset:384
    v_mfma_f32_16x16x32_bf16 v[72:75], v[36:39], a[56:59], v[72:75]
    s_add_u32 m0, s29, 99840
    s_lshr_b32 s44, s81, 12
    v_mfma_f32_16x16x32_bf16 v[76:79], v[32:35], a[52:55], v[76:79]
    ds_read_b64_tr_b16 v[28:29], v3 offset:1168
    ds_read_b64_tr_b16 v[30:31], v3 offset:1424
    v_mfma_f32_16x16x32_bf16 v[76:79], v[36:39], a[60:63], v[76:79]
    s_waitcnt lgkmcnt(8)
    s_add_u32 s36, s44, 0
    v_mfma_f32_16x16x32_bf16 v[80:83], v[40:43], a[48:51], v[80:83]
    ds_read_b64_tr_b16 v[32:33], v3 offset:160
    ds_read_b64_tr_b16 v[34:35], v3 offset:416
    v_mfma_f32_16x16x32_bf16 v[80:83], v[44:47], a[56:59], v[80:83]
    buffer_load_dwordx4 v15, s[4:7], s36 offen offset:0 nt lds
    v_mfma_f32_16x16x32_bf16 v[84:87], v[40:43], a[52:55], v[84:87]
    ds_read_b64_tr_b16 v[36:37], v3 offset:1200
    ds_read_b64_tr_b16 v[38:39], v3 offset:1456
    v_mfma_f32_16x16x32_bf16 v[84:87], v[44:47], a[60:63], v[84:87]
    s_waitcnt lgkmcnt(8)
    s_add_u32 s36, s44, 6128
    v_mfma_f32_16x16x32_bf16 v[88:91], v[48:51], a[48:51], v[88:91]
    ds_read_b64_tr_b16 v[40:41], v3 offset:192
    ds_read_b64_tr_b16 v[42:43], v3 offset:448
    buffer_load_dwordx4 v15, s[4:7], s36 offen offset:1040 nt lds
    s_add_u32 s36, s44, 12256
    buffer_load_dwordx4 v15, s[4:7], s36 offen offset:2080 nt lds
    s_add_u32 s36, s44, 18384
    buffer_load_dwordx4 v15, s[4:7], s36 offen offset:3120 nt lds
    v_mfma_f32_16x16x32_bf16 v[88:91], v[52:55], a[56:59], v[88:91]
    v_mfma_f32_16x16x32_bf16 v[92:95], v[48:51], a[52:55], v[92:95]
    ds_read_b64_tr_b16 v[44:45], v3 offset:1232
    ds_read_b64_tr_b16 v[46:47], v3 offset:1488
    v_mfma_f32_16x16x32_bf16 v[92:95], v[52:55], a[60:63], v[92:95]
    s_waitcnt lgkmcnt(8)
    s_add_u32 m0, s29, 16640
    v_mfma_f32_16x16x32_bf16 v[96:99], v[24:27], a[48:51], v[96:99]
    ds_read_b64_tr_b16 v[48:49], v3 offset:224
    ds_read_b64_tr_b16 v[50:51], v3 offset:480
    v_mfma_f32_16x16x32_bf16 v[96:99], v[28:31], a[56:59], v[96:99]
    s_add_u32 s36, s81, 0
    v_mfma_f32_16x16x32_bf16 v[100:103], v[24:27], a[52:55], v[100:103]
    ds_read_b64_tr_b16 v[52:53], v3 offset:1264
    ds_read_b64_tr_b16 v[54:55], v3 offset:1520
    v_mfma_f32_16x16x32_bf16 v[100:103], v[28:31], a[60:63], v[100:103]
    s_waitcnt lgkmcnt(8)
    v_add_u32 v3, 49920, v1
    v_mfma_f32_16x16x32_bf16 v[104:107], v[32:35], a[48:51], v[104:107]
    ds_read_b64_tr_b16 v[24:25], v3 offset:0
    ds_read_b64_tr_b16 v[26:27], v3 offset:256
    v_mfma_f32_16x16x32_bf16 v[104:107], v[36:39], a[56:59], v[104:107]
    buffer_load_dwordx4 v14, s[8:11], s36 offen offset:0 nt lds
    v_mfma_f32_16x16x32_bf16 v[108:111], v[32:35], a[52:55], v[108:111]
    ds_read_b64_tr_b16 v[28:29], v3 offset:1040
    ds_read_b64_tr_b16 v[30:31], v3 offset:1296
    v_mfma_f32_16x16x32_bf16 v[108:111], v[36:39], a[60:63], v[108:111]
    s_waitcnt lgkmcnt(8)
    s_add_u32 s36, s81, 261104
    v_mfma_f32_16x16x32_bf16 v[112:115], v[40:43], a[48:51], v[112:115]
    ds_read_b64_tr_b16 v[32:33], v3 offset:32
    ds_read_b64_tr_b16 v[34:35], v3 offset:288
    v_mfma_f32_16x16x32_bf16 v[112:115], v[44:47], a[56:59], v[112:115]
    v_mfma_f32_16x16x32_bf16 v[116:119], v[40:43], a[52:55], v[116:119]
    ds_read_b64_tr_b16 v[36:37], v3 offset:1072
    ds_read_b64_tr_b16 v[38:39], v3 offset:1328
    v_mfma_f32_16x16x32_bf16 v[116:119], v[44:47], a[60:63], v[116:119]
    s_waitcnt lgkmcnt(8)
    buffer_load_dwordx4 v14, s[8:11], s36 offen offset:1040 nt lds
    v_mfma_f32_16x16x32_bf16 v[120:123], v[48:51], a[48:51], v[120:123]
    ds_read_b64_tr_b16 v[40:41], v3 offset:64
    ds_read_b64_tr_b16 v[42:43], v3 offset:320
    v_mfma_f32_16x16x32_bf16 v[120:123], v[52:55], a[56:59], v[120:123]
    v_mfma_f32_16x16x32_bf16 v[124:127], v[48:51], a[52:55], v[124:127]
    ds_read_b64_tr_b16 v[44:45], v3 offset:1104
    ds_read_b64_tr_b16 v[46:47], v3 offset:1360
    v_mfma_f32_16x16x32_bf16 v[124:127], v[52:55], a[60:63], v[124:127]
    s_waitcnt lgkmcnt(8)
    s_add_u32 s36, s81, 6112
    v_mfma_f32_16x16x32_bf16 v[192:195], v[24:27], a[48:51], v[192:195]
    ds_read_b64_tr_b16 v[48:49], v3 offset:96
    ds_read_b64_tr_b16 v[50:51], v3 offset:352
    v_mfma_f32_16x16x32_bf16 v[192:195], v[28:31], a[56:59], v[192:195]
    v_add_u32 v2, 66560, v16
    v_mfma_f32_16x16x32_bf16 v[196:199], v[24:27], a[52:55], v[196:199]
    ds_read_b64_tr_b16 v[52:53], v3 offset:1136
    ds_read_b64_tr_b16 v[54:55], v3 offset:1392
    v_mfma_f32_16x16x32_bf16 v[196:199], v[28:31], a[60:63], v[196:199]
    s_waitcnt lgkmcnt(8)
    buffer_load_dwordx4 v14, s[8:11], s36 offen offset:2080 nt lds
    v_mfma_f32_16x16x32_bf16 v[200:203], v[32:35], a[48:51], v[200:203]
    ds_read_b64_tr_b16 v[24:25], v3 offset:128
    ds_read_b64_tr_b16 v[26:27], v3 offset:384
    v_mfma_f32_16x16x32_bf16 v[200:203], v[36:39], a[56:59], v[200:203]
    s_add_u32 s36, s81, 267216
    v_mfma_f32_16x16x32_bf16 v[204:207], v[32:35], a[52:55], v[204:207]
    ds_read_b64_tr_b16 v[28:29], v3 offset:1168
    ds_read_b64_tr_b16 v[30:31], v3 offset:1424
    v_mfma_f32_16x16x32_bf16 v[204:207], v[36:39], a[60:63], v[204:207]
    s_waitcnt lgkmcnt(8)
    buffer_load_dwordx4 v14, s[8:11], s36 offen offset:3120 nt lds
    v_mfma_f32_16x16x32_bf16 v[208:211], v[40:43], a[48:51], v[208:211]
    ds_read_b64_tr_b16 v[32:33], v3 offset:160
    ds_read_b64_tr_b16 v[34:35], v3 offset:416
    v_mfma_f32_16x16x32_bf16 v[208:211], v[44:47], a[56:59], v[208:211]
    v_mfma_f32_16x16x32_bf16 v[212:215], v[40:43], a[52:55], v[212:215]
    ds_read_b64_tr_b16 v[36:37], v3 offset:1200
    ds_read_b64_tr_b16 v[38:39], v3 offset:1456
    v_mfma_f32_16x16x32_bf16 v[212:215], v[44:47], a[60:63], v[212:215]
    s_waitcnt lgkmcnt(8)
    v_mfma_f32_16x16x32_bf16 v[216:219], v[48:51], a[48:51], v[216:219]
    ds_read_b64_tr_b16 v[40:41], v3 offset:192
    ds_read_b64_tr_b16 v[42:43], v3 offset:448
    v_mfma_f32_16x16x32_bf16 v[216:219], v[52:55], a[56:59], v[216:219]
    s_waitcnt vmcnt(8)
    s_barrier
    v_mfma_f32_16x16x32_bf16 v[220:223], v[48:51], a[52:55], v[220:223]
    ds_read_b64_tr_b16 v[44:45], v3 offset:1232
    ds_read_b64_tr_b16 v[46:47], v3 offset:1488
    v_mfma_f32_16x16x32_bf16 v[220:223], v[52:55], a[60:63], v[220:223]
    s_waitcnt lgkmcnt(8)
    s_add_u32 m0, s29, 116480
    v_mfma_f32_16x16x32_bf16 v[224:227], v[24:27], a[48:51], v[224:227]
    ds_read_b64_tr_b16 v[48:49], v3 offset:224
    ds_read_b64_tr_b16 v[50:51], v3 offset:480
    v_mfma_f32_16x16x32_bf16 v[224:227], v[28:31], a[56:59], v[224:227]
    ds_read_b128 a[64:67], v2 offset:0
    v_mfma_f32_16x16x32_bf16 v[228:231], v[24:27], a[52:55], v[228:231]
    ds_read_b64_tr_b16 v[52:53], v3 offset:1264
    ds_read_b64_tr_b16 v[54:55], v3 offset:1520
    v_mfma_f32_16x16x32_bf16 v[228:231], v[28:31], a[60:63], v[228:231]
    s_waitcnt lgkmcnt(9)
    s_add_u32 s36, s81, 256
    v_add_u32 v3, 83200, v1
    v_mfma_f32_16x16x32_bf16 v[232:235], v[32:35], a[48:51], v[232:235]
    ds_read_b64_tr_b16 v[24:25], v3 offset:0
    ds_read_b64_tr_b16 v[26:27], v3 offset:256
    v_mfma_f32_16x16x32_bf16 v[232:235], v[36:39], a[56:59], v[232:235]
    ds_read_b128 a[68:71], v2 offset:2080
    v_mfma_f32_16x16x32_bf16 v[236:239], v[32:35], a[52:55], v[236:239]
    ds_read_b64_tr_b16 v[28:29], v3 offset:1040
    ds_read_b64_tr_b16 v[30:31], v3 offset:1296
    v_mfma_f32_16x16x32_bf16 v[236:239], v[36:39], a[60:63], v[236:239]
    s_waitcnt lgkmcnt(10)
    buffer_load_dwordx4 v14, s[8:11], s36 offen offset:0 nt lds
    v_mfma_f32_16x16x32_bf16 v[240:243], v[40:43], a[48:51], v[240:243]
    ds_read_b64_tr_b16 v[32:33], v3 offset:32
    ds_read_b64_tr_b16 v[34:35], v3 offset:288
    v_mfma_f32_16x16x32_bf16 v[240:243], v[44:47], a[56:59], v[240:243]
    ds_read_b128 a[72:75], v2 offset:64
    v_mfma_f32_16x16x32_bf16 v[244:247], v[40:43], a[52:55], v[244:247]
    ds_read_b64_tr_b16 v[36:37], v3 offset:1072
    ds_read_b64_tr_b16 v[38:39], v3 offset:1328
    v_mfma_f32_16x16x32_bf16 v[244:247], v[44:47], a[60:63], v[244:247]
    s_waitcnt lgkmcnt(10)
    s_add_u32 s36, s81, 261360
    v_mfma_f32_16x16x32_bf16 v[248:251], v[48:51], a[48:51], v[248:251]
    ds_read_b64_tr_b16 v[40:41], v3 offset:64
    ds_read_b64_tr_b16 v[42:43], v3 offset:320
    v_mfma_f32_16x16x32_bf16 v[248:251], v[52:55], a[56:59], v[248:251]
    ds_read_b128 a[76:79], v2 offset:2144
    v_mfma_f32_16x16x32_bf16 v[252:255], v[48:51], a[52:55], v[252:255]
    ds_read_b64_tr_b16 v[44:45], v3 offset:1104
    ds_read_b64_tr_b16 v[46:47], v3 offset:1360
    v_mfma_f32_16x16x32_bf16 v[252:255], v[52:55], a[60:63], v[252:255]
    s_waitcnt lgkmcnt(2)
    buffer_load_dwordx4 v14, s[8:11], s36 offen offset:1040 nt lds
    v_mfma_f32_16x16x32_bf16 v[64:67], v[24:27], a[64:67], v[64:67]
    ds_read_b64_tr_b16 v[48:49], v3 offset:96
    ds_read_b64_tr_b16 v[50:51], v3 offset:352
    v_mfma_f32_16x16x32_bf16 v[64:67], v[28:31], a[72:75], v[64:67]
    s_add_u32 s36, s81, 6368
    buffer_load_dwordx4 v14, s[8:11], s36 offen offset:2080 nt lds
    v_mfma_f32_16x16x32_bf16 v[68:71], v[24:27], a[68:71], v[68:71]
    ds_read_b64_tr_b16 v[52:53], v3 offset:1136
    ds_read_b64_tr_b16 v[54:55], v3 offset:1392
    v_mfma_f32_16x16x32_bf16 v[68:71], v[28:31], a[76:79], v[68:71]
    s_add_u32 s36, s81, 267472
    buffer_load_dwordx4 v14, s[8:11], s36 offen offset:3120 nt lds
    v_mfma_f32_16x16x32_bf16 v[72:75], v[32:35], a[64:67], v[72:75]
    ds_read_b64_tr_b16 v[24:25], v3 offset:128
    ds_read_b64_tr_b16 v[26:27], v3 offset:384
    v_mfma_f32_16x16x32_bf16 v[72:75], v[36:39], a[72:75], v[72:75]
    s_add_u32 m0, s29, 33280
    s_lshr_b32 s44, s79, 12
    v_mfma_f32_16x16x32_bf16 v[76:79], v[32:35], a[68:71], v[76:79]
    ds_read_b64_tr_b16 v[28:29], v3 offset:1168
    ds_read_b64_tr_b16 v[30:31], v3 offset:1424
    v_mfma_f32_16x16x32_bf16 v[76:79], v[36:39], a[76:79], v[76:79]
    s_waitcnt lgkmcnt(8)
    s_add_u32 s36, s44, 0
    v_mfma_f32_16x16x32_bf16 v[80:83], v[40:43], a[64:67], v[80:83]
    ds_read_b64_tr_b16 v[32:33], v3 offset:160
    ds_read_b64_tr_b16 v[34:35], v3 offset:416
    v_mfma_f32_16x16x32_bf16 v[80:83], v[44:47], a[72:75], v[80:83]
    buffer_load_dwordx4 v15, s[4:7], s36 offen offset:0 nt lds
    v_mfma_f32_16x16x32_bf16 v[84:87], v[40:43], a[68:71], v[84:87]
    ds_read_b64_tr_b16 v[36:37], v3 offset:1200
    ds_read_b64_tr_b16 v[38:39], v3 offset:1456
    v_mfma_f32_16x16x32_bf16 v[84:87], v[44:47], a[76:79], v[84:87]
    s_waitcnt lgkmcnt(8)
    s_add_u32 s36, s44, 6128
    v_mfma_f32_16x16x32_bf16 v[88:91], v[48:51], a[64:67], v[88:91]
    ds_read_b64_tr_b16 v[40:41], v3 offset:192
    ds_read_b64_tr_b16 v[42:43], v3 offset:448
    buffer_load_dwordx4 v15, s[4:7], s36 offen offset:1040 nt lds
    s_add_u32 s36, s44, 12256
    buffer_load_dwordx4 v15, s[4:7], s36 offen offset:2080 nt lds
    s_add_u32 s36, s44, 18384
    buffer_load_dwordx4 v15, s[4:7], s36 offen offset:3120 nt lds
    v_mfma_f32_16x16x32_bf16 v[88:91], v[52:55], a[72:75], v[88:91]
    v_mfma_f32_16x16x32_bf16 v[92:95], v[48:51], a[68:71], v[92:95]
    ds_read_b64_tr_b16 v[44:45], v3 offset:1232
    ds_read_b64_tr_b16 v[46:47], v3 offset:1488
    v_mfma_f32_16x16x32_bf16 v[92:95], v[52:55], a[76:79], v[92:95]
    s_waitcnt lgkmcnt(8)
    s_add_u32 m0, s29, 133120
    v_mfma_f32_16x16x32_bf16 v[96:99], v[24:27], a[64:67], v[96:99]
    ds_read_b64_tr_b16 v[48:49], v3 offset:224
    ds_read_b64_tr_b16 v[50:51], v3 offset:480
    v_mfma_f32_16x16x32_bf16 v[96:99], v[28:31], a[72:75], v[96:99]
    s_add_u32 s36, s79, 0
    v_mfma_f32_16x16x32_bf16 v[100:103], v[24:27], a[68:71], v[100:103]
    ds_read_b64_tr_b16 v[52:53], v3 offset:1264
    ds_read_b64_tr_b16 v[54:55], v3 offset:1520
    v_mfma_f32_16x16x32_bf16 v[100:103], v[28:31], a[76:79], v[100:103]
    s_waitcnt lgkmcnt(8)
    v_add_u32 v3, 0, v1
    v_mfma_f32_16x16x32_bf16 v[104:107], v[32:35], a[64:67], v[104:107]
    ds_read_b64_tr_b16 v[24:25], v3 offset:0
    ds_read_b64_tr_b16 v[26:27], v3 offset:256
    v_mfma_f32_16x16x32_bf16 v[104:107], v[36:39], a[72:75], v[104:107]
    buffer_load_dwordx4 v14, s[8:11], s36 offen offset:0 nt lds
    v_mfma_f32_16x16x32_bf16 v[108:111], v[32:35], a[68:71], v[108:111]
    ds_read_b64_tr_b16 v[28:29], v3 offset:1040
    ds_read_b64_tr_b16 v[30:31], v3 offset:1296
    v_mfma_f32_16x16x32_bf16 v[108:111], v[36:39], a[76:79], v[108:111]
    s_waitcnt lgkmcnt(8)
    s_add_u32 s36, s79, 261104
    v_mfma_f32_16x16x32_bf16 v[112:115], v[40:43], a[64:67], v[112:115]
    ds_read_b64_tr_b16 v[32:33], v3 offset:32
    ds_read_b64_tr_b16 v[34:35], v3 offset:288
    v_mfma_f32_16x16x32_bf16 v[112:115], v[44:47], a[72:75], v[112:115]
    v_mfma_f32_16x16x32_bf16 v[116:119], v[40:43], a[68:71], v[116:119]
    ds_read_b64_tr_b16 v[36:37], v3 offset:1072
    ds_read_b64_tr_b16 v[38:39], v3 offset:1328
    v_mfma_f32_16x16x32_bf16 v[116:119], v[44:47], a[76:79], v[116:119]
    s_waitcnt lgkmcnt(8)
    buffer_load_dwordx4 v14, s[8:11], s36 offen offset:1040 nt lds
    v_mfma_f32_16x16x32_bf16 v[120:123], v[48:51], a[64:67], v[120:123]
    ds_read_b64_tr_b16 v[40:41], v3 offset:64
    ds_read_b64_tr_b16 v[42:43], v3 offset:320
    v_mfma_f32_16x16x32_bf16 v[120:123], v[52:55], a[72:75], v[120:123]
    v_mfma_f32_16x16x32_bf16 v[124:127], v[48:51], a[68:71], v[124:127]
    ds_read_b64_tr_b16 v[44:45], v3 offset:1104
    ds_read_b64_tr_b16 v[46:47], v3 offset:1360
    v_mfma_f32_16x16x32_bf16 v[124:127], v[52:55], a[76:79], v[124:127]
    s_waitcnt lgkmcnt(8)
    s_add_u32 s36, s79, 6112
    v_mfma_f32_16x16x32_bf16 v[192:195], v[24:27], a[64:67], v[192:195]
    ds_read_b64_tr_b16 v[48:49], v3 offset:96
    ds_read_b64_tr_b16 v[50:51], v3 offset:352
    v_mfma_f32_16x16x32_bf16 v[192:195], v[28:31], a[72:75], v[192:195]
    v_add_u32 v2, 99840, v16
    v_mfma_f32_16x16x32_bf16 v[196:199], v[24:27], a[68:71], v[196:199]
    ds_read_b64_tr_b16 v[52:53], v3 offset:1136
    ds_read_b64_tr_b16 v[54:55], v3 offset:1392
    v_mfma_f32_16x16x32_bf16 v[196:199], v[28:31], a[76:79], v[196:199]
    s_waitcnt lgkmcnt(8)
    buffer_load_dwordx4 v14, s[8:11], s36 offen offset:2080 nt lds
    v_mfma_f32_16x16x32_bf16 v[200:203], v[32:35], a[64:67], v[200:203]
    ds_read_b64_tr_b16 v[24:25], v3 offset:128
    ds_read_b64_tr_b16 v[26:27], v3 offset:384
    v_mfma_f32_16x16x32_bf16 v[200:203], v[36:39], a[72:75], v[200:203]
    s_add_u32 s36, s79, 267216
    v_mfma_f32_16x16x32_bf16 v[204:207], v[32:35], a[68:71], v[204:207]
    ds_read_b64_tr_b16 v[28:29], v3 offset:1168
    ds_read_b64_tr_b16 v[30:31], v3 offset:1424
    v_mfma_f32_16x16x32_bf16 v[204:207], v[36:39], a[76:79], v[204:207]
    s_waitcnt lgkmcnt(8)
    buffer_load_dwordx4 v14, s[8:11], s36 offen offset:3120 nt lds
    v_mfma_f32_16x16x32_bf16 v[208:211], v[40:43], a[64:67], v[208:211]
    ds_read_b64_tr_b16 v[32:33], v3 offset:160
    ds_read_b64_tr_b16 v[34:35], v3 offset:416
    v_mfma_f32_16x16x32_bf16 v[208:211], v[44:47], a[72:75], v[208:211]
    v_mfma_f32_16x16x32_bf16 v[212:215], v[40:43], a[68:71], v[212:215]
    ds_read_b64_tr_b16 v[36:37], v3 offset:1200
    ds_read_b64_tr_b16 v[38:39], v3 offset:1456
    v_mfma_f32_16x16x32_bf16 v[212:215], v[44:47], a[76:79], v[212:215]
    s_waitcnt lgkmcnt(8)
    v_mfma_f32_16x16x32_bf16 v[216:219], v[48:51], a[64:67], v[216:219]
    ds_read_b64_tr_b16 v[40:41], v3 offset:192
    ds_read_b64_tr_b16 v[42:43], v3 offset:448
    v_mfma_f32_16x16x32_bf16 v[216:219], v[52:55], a[72:75], v[216:219]
    s_waitcnt vmcnt(8)
    s_barrier
    v_mfma_f32_16x16x32_bf16 v[220:223], v[48:51], a[68:71], v[220:223]
    ds_read_b64_tr_b16 v[44:45], v3 offset:1232
    ds_read_b64_tr_b16 v[46:47], v3 offset:1488
    v_mfma_f32_16x16x32_bf16 v[220:223], v[52:55], a[76:79], v[220:223]
    s_waitcnt lgkmcnt(8)
    s_add_u32 m0, s29, 49920
    v_mfma_f32_16x16x32_bf16 v[224:227], v[24:27], a[64:67], v[224:227]
    ds_read_b64_tr_b16 v[48:49], v3 offset:224
    ds_read_b64_tr_b16 v[50:51], v3 offset:480
    v_mfma_f32_16x16x32_bf16 v[224:227], v[28:31], a[72:75], v[224:227]
    ds_read_b128 a[80:83], v2 offset:0
    v_mfma_f32_16x16x32_bf16 v[228:231], v[24:27], a[68:71], v[228:231]
    ds_read_b64_tr_b16 v[52:53], v3 offset:1264
    ds_read_b64_tr_b16 v[54:55], v3 offset:1520
    v_mfma_f32_16x16x32_bf16 v[228:231], v[28:31], a[76:79], v[228:231]
    s_waitcnt lgkmcnt(9)
    s_add_u32 s36, s79, 256
    v_add_u32 v3, 16640, v1
    v_mfma_f32_16x16x32_bf16 v[232:235], v[32:35], a[64:67], v[232:235]
    ds_read_b64_tr_b16 v[24:25], v3 offset:0
    ds_read_b64_tr_b16 v[26:27], v3 offset:256
    v_mfma_f32_16x16x32_bf16 v[232:235], v[36:39], a[72:75], v[232:235]
    ds_read_b128 a[84:87], v2 offset:2080
    v_mfma_f32_16x16x32_bf16 v[236:239], v[32:35], a[68:71], v[236:239]
    ds_read_b64_tr_b16 v[28:29], v3 offset:1040
    ds_read_b64_tr_b16 v[30:31], v3 offset:1296
    v_mfma_f32_16x16x32_bf16 v[236:239], v[36:39], a[76:79], v[236:239]
    s_waitcnt lgkmcnt(10)
    buffer_load_dwordx4 v14, s[8:11], s36 offen offset:0 nt lds
    v_mfma_f32_16x16x32_bf16 v[240:243], v[40:43], a[64:67], v[240:243]
    ds_read_b64_tr_b16 v[32:33], v3 offset:32
    ds_read_b64_tr_b16 v[34:35], v3 offset:288
    v_mfma_f32_16x16x32_bf16 v[240:243], v[44:47], a[72:75], v[240:243]
    ds_read_b128 a[88:91], v2 offset:64
    v_mfma_f32_16x16x32_bf16 v[244:247], v[40:43], a[68:71], v[244:247]
    ds_read_b64_tr_b16 v[36:37], v3 offset:1072
    ds_read_b64_tr_b16 v[38:39], v3 offset:1328
    v_mfma_f32_16x16x32_bf16 v[244:247], v[44:47], a[76:79], v[244:247]
    s_waitcnt lgkmcnt(10)
    s_add_u32 s36, s79, 261360
    v_mfma_f32_16x16x32_bf16 v[248:251], v[48:51], a[64:67], v[248:251]
    ds_read_b64_tr_b16 v[40:41], v3 offset:64
    ds_read_b64_tr_b16 v[42:43], v3 offset:320
    v_mfma_f32_16x16x32_bf16 v[248:251], v[52:55], a[72:75], v[248:251]
    ds_read_b128 a[92:95], v2 offset:2144
    v_mfma_f32_16x16x32_bf16 v[252:255], v[48:51], a[68:71], v[252:255]
    ds_read_b64_tr_b16 v[44:45], v3 offset:1104
    ds_read_b64_tr_b16 v[46:47], v3 offset:1360
    v_mfma_f32_16x16x32_bf16 v[252:255], v[52:55], a[76:79], v[252:255]
    s_waitcnt lgkmcnt(2)
    buffer_load_dwordx4 v14, s[8:11], s36 offen offset:1040 nt lds
    v_mfma_f32_16x16x32_bf16 v[64:67], v[24:27], a[80:83], v[64:67]
    ds_read_b64_tr_b16 v[48:49], v3 offset:96
    ds_read_b64_tr_b16 v[50:51], v3 offset:352
    v_mfma_f32_16x16x32_bf16 v[64:67], v[28:31], a[88:91], v[64:67]
    s_add_u32 s36, s79, 6368
    buffer_load_dwordx4 v14, s[8:11], s36 offen offset:2080 nt lds
    v_mfma_f32_16x16x32_bf16 v[68:71], v[24:27], a[84:87], v[68:71]
    ds_read_b64_tr_b16 v[52:53], v3 offset:1136
    ds_read_b64_tr_b16 v[54:55], v3 offset:1392
    v_mfma_f32_16x16x32_bf16 v[68:71], v[28:31], a[92:95], v[68:71]
    s_add_u32 s36, s79, 267472
    buffer_load_dwordx4 v14, s[8:11], s36 offen offset:3120 nt lds
    v_mfma_f32_16x16x32_bf16 v[72:75], v[32:35], a[80:83], v[72:75]
    ds_read_b64_tr_b16 v[24:25], v3 offset:128
    ds_read_b64_tr_b16 v[26:27], v3 offset:384
    v_mfma_f32_16x16x32_bf16 v[72:75], v[36:39], a[88:91], v[72:75]
    s_add_u32 m0, s29, 66560
    s_add_u32 s36, s62, 512
    v_mfma_f32_16x16x32_bf16 v[76:79], v[32:35], a[84:87], v[76:79]
    ds_read_b64_tr_b16 v[28:29], v3 offset:1168
    ds_read_b64_tr_b16 v[30:31], v3 offset:1424
    v_mfma_f32_16x16x32_bf16 v[76:79], v[36:39], a[92:95], v[76:79]
    s_waitcnt lgkmcnt(8)
    buffer_load_dwordx4 v14, s[8:11], s36 offen offset:0 nt lds
    v_mfma_f32_16x16x32_bf16 v[80:83], v[40:43], a[80:83], v[80:83]
    ds_read_b64_tr_b16 v[32:33], v3 offset:160
    ds_read_b64_tr_b16 v[34:35], v3 offset:416
    v_mfma_f32_16x16x32_bf16 v[80:83], v[44:47], a[88:91], v[80:83]
    s_add_u32 s36, s62, 261616
    buffer_load_dwordx4 v14, s[8:11], s36 offen offset:1040 nt lds
    v_mfma_f32_16x16x32_bf16 v[84:87], v[40:43], a[84:87], v[84:87]
    ds_read_b64_tr_b16 v[36:37], v3 offset:1200
    ds_read_b64_tr_b16 v[38:39], v3 offset:1456
    v_mfma_f32_16x16x32_bf16 v[84:87], v[44:47], a[92:95], v[84:87]
    s_waitcnt lgkmcnt(8)
    s_add_u32 s36, s62, 6624
    v_mfma_f32_16x16x32_bf16 v[88:91], v[48:51], a[80:83], v[88:91]
    ds_read_b64_tr_b16 v[40:41], v3 offset:192
    ds_read_b64_tr_b16 v[42:43], v3 offset:448
    buffer_load_dwordx4 v14, s[8:11], s36 offen offset:2080 nt lds
    s_add_u32 s36, s62, 267728
    buffer_load_dwordx4 v14, s[8:11], s36 offen offset:3120 nt lds
    v_mfma_f32_16x16x32_bf16 v[88:91], v[52:55], a[88:91], v[88:91]
    v_mfma_f32_16x16x32_bf16 v[92:95], v[48:51], a[84:87], v[92:95]
    ds_read_b64_tr_b16 v[44:45], v3 offset:1232
    ds_read_b64_tr_b16 v[46:47], v3 offset:1488
    v_mfma_f32_16x16x32_bf16 v[92:95], v[52:55], a[92:95], v[92:95]
    s_waitcnt lgkmcnt(8)
    s_add_u32 m0, s29, 83200
    v_mfma_f32_16x16x32_bf16 v[96:99], v[24:27], a[80:83], v[96:99]
    ds_read_b64_tr_b16 v[48:49], v3 offset:224
    ds_read_b64_tr_b16 v[50:51], v3 offset:480
    v_mfma_f32_16x16x32_bf16 v[96:99], v[28:31], a[88:91], v[96:99]
    s_add_u32 s36, s63, 512
    v_mfma_f32_16x16x32_bf16 v[100:103], v[24:27], a[84:87], v[100:103]
    ds_read_b64_tr_b16 v[52:53], v3 offset:1264
    ds_read_b64_tr_b16 v[54:55], v3 offset:1520
    v_mfma_f32_16x16x32_bf16 v[100:103], v[28:31], a[92:95], v[100:103]
    s_waitcnt lgkmcnt(8)
    v_add_u32 v3, 116480, v1
    v_mfma_f32_16x16x32_bf16 v[104:107], v[32:35], a[80:83], v[104:107]
    ds_read_b64_tr_b16 v[24:25], v3 offset:0
    ds_read_b64_tr_b16 v[26:27], v3 offset:256
    v_mfma_f32_16x16x32_bf16 v[104:107], v[36:39], a[88:91], v[104:107]
    buffer_load_dwordx4 v14, s[8:11], s36 offen offset:0 nt lds
    v_mfma_f32_16x16x32_bf16 v[108:111], v[32:35], a[84:87], v[108:111]
    ds_read_b64_tr_b16 v[28:29], v3 offset:1040
    ds_read_b64_tr_b16 v[30:31], v3 offset:1296
    v_mfma_f32_16x16x32_bf16 v[108:111], v[36:39], a[92:95], v[108:111]
    s_waitcnt lgkmcnt(8)
    s_add_u32 s36, s63, 261616
    v_mfma_f32_16x16x32_bf16 v[112:115], v[40:43], a[80:83], v[112:115]
    ds_read_b64_tr_b16 v[32:33], v3 offset:32
    ds_read_b64_tr_b16 v[34:35], v3 offset:288
    v_mfma_f32_16x16x32_bf16 v[112:115], v[44:47], a[88:91], v[112:115]
    v_mfma_f32_16x16x32_bf16 v[116:119], v[40:43], a[84:87], v[116:119]
    ds_read_b64_tr_b16 v[36:37], v3 offset:1072
    ds_read_b64_tr_b16 v[38:39], v3 offset:1328
    v_mfma_f32_16x16x32_bf16 v[116:119], v[44:47], a[92:95], v[116:119]
    s_waitcnt lgkmcnt(8)
    buffer_load_dwordx4 v14, s[8:11], s36 offen offset:1040 nt lds
    v_mfma_f32_16x16x32_bf16 v[120:123], v[48:51], a[80:83], v[120:123]
    ds_read_b64_tr_b16 v[40:41], v3 offset:64
    ds_read_b64_tr_b16 v[42:43], v3 offset:320
    v_mfma_f32_16x16x32_bf16 v[120:123], v[52:55], a[88:91], v[120:123]
    v_mfma_f32_16x16x32_bf16 v[124:127], v[48:51], a[84:87], v[124:127]
    ds_read_b64_tr_b16 v[44:45], v3 offset:1104
    ds_read_b64_tr_b16 v[46:47], v3 offset:1360
    v_mfma_f32_16x16x32_bf16 v[124:127], v[52:55], a[92:95], v[124:127]
    s_waitcnt lgkmcnt(8)
    s_add_u32 s36, s63, 6624
    v_mfma_f32_16x16x32_bf16 v[192:195], v[24:27], a[80:83], v[192:195]
    ds_read_b64_tr_b16 v[48:49], v3 offset:96
    ds_read_b64_tr_b16 v[50:51], v3 offset:352
    v_mfma_f32_16x16x32_bf16 v[192:195], v[28:31], a[88:91], v[192:195]
    v_add_u32 v2, 33280, v16
    v_mfma_f32_16x16x32_bf16 v[196:199], v[24:27], a[84:87], v[196:199]
    ds_read_b64_tr_b16 v[52:53], v3 offset:1136
    ds_read_b64_tr_b16 v[54:55], v3 offset:1392
    v_mfma_f32_16x16x32_bf16 v[196:199], v[28:31], a[92:95], v[196:199]
    s_waitcnt lgkmcnt(8)
    buffer_load_dwordx4 v14, s[8:11], s36 offen offset:2080 nt lds
    v_mfma_f32_16x16x32_bf16 v[200:203], v[32:35], a[80:83], v[200:203]
    ds_read_b64_tr_b16 v[24:25], v3 offset:128
    ds_read_b64_tr_b16 v[26:27], v3 offset:384
    v_mfma_f32_16x16x32_bf16 v[200:203], v[36:39], a[88:91], v[200:203]
    s_add_u32 s36, s63, 267728
    v_mfma_f32_16x16x32_bf16 v[204:207], v[32:35], a[84:87], v[204:207]
    ds_read_b64_tr_b16 v[28:29], v3 offset:1168
    ds_read_b64_tr_b16 v[30:31], v3 offset:1424
    v_mfma_f32_16x16x32_bf16 v[204:207], v[36:39], a[92:95], v[204:207]
    s_waitcnt lgkmcnt(8)
    buffer_load_dwordx4 v14, s[8:11], s36 offen offset:3120 nt lds
    v_mfma_f32_16x16x32_bf16 v[208:211], v[40:43], a[80:83], v[208:211]
    ds_read_b64_tr_b16 v[32:33], v3 offset:160
    ds_read_b64_tr_b16 v[34:35], v3 offset:416
    v_mfma_f32_16x16x32_bf16 v[208:211], v[44:47], a[88:91], v[208:211]
    v_mfma_f32_16x16x32_bf16 v[212:215], v[40:43], a[84:87], v[212:215]
    ds_read_b64_tr_b16 v[36:37], v3 offset:1200
    ds_read_b64_tr_b16 v[38:39], v3 offset:1456
    v_mfma_f32_16x16x32_bf16 v[212:215], v[44:47], a[92:95], v[212:215]
    s_waitcnt lgkmcnt(8)
    v_mfma_f32_16x16x32_bf16 v[216:219], v[48:51], a[80:83], v[216:219]
    ds_read_b64_tr_b16 v[40:41], v3 offset:192
    ds_read_b64_tr_b16 v[42:43], v3 offset:448
    v_mfma_f32_16x16x32_bf16 v[216:219], v[52:55], a[88:91], v[216:219]
    s_waitcnt vmcnt(8)
    s_barrier
    v_mfma_f32_16x16x32_bf16 v[220:223], v[48:51], a[84:87], v[220:223]
    ds_read_b64_tr_b16 v[44:45], v3 offset:1232
    ds_read_b64_tr_b16 v[46:47], v3 offset:1488
    v_mfma_f32_16x16x32_bf16 v[220:223], v[52:55], a[92:95], v[220:223]
    s_waitcnt lgkmcnt(8)
    s_add_u32 m0, s29, 0
    v_mfma_f32_16x16x32_bf16 v[224:227], v[24:27], a[80:83], v[224:227]
    ds_read_b64_tr_b16 v[48:49], v3 offset:224
    ds_read_b64_tr_b16 v[50:51], v3 offset:480
    v_mfma_f32_16x16x32_bf16 v[224:227], v[28:31], a[88:91], v[224:227]
    ds_read_b128 a[96:99], v2 offset:0
    v_mfma_f32_16x16x32_bf16 v[228:231], v[24:27], a[84:87], v[228:231]
    ds_read_b64_tr_b16 v[52:53], v3 offset:1264
    ds_read_b64_tr_b16 v[54:55], v3 offset:1520
    v_mfma_f32_16x16x32_bf16 v[228:231], v[28:31], a[92:95], v[228:231]
    s_waitcnt lgkmcnt(9)
    s_add_u32 s36, s82, 512
    v_add_u32 v3, 133120, v1
    v_mfma_f32_16x16x32_bf16 v[232:235], v[32:35], a[80:83], v[232:235]
    ds_read_b64_tr_b16 v[24:25], v3 offset:0
    ds_read_b64_tr_b16 v[26:27], v3 offset:256
    v_mfma_f32_16x16x32_bf16 v[232:235], v[36:39], a[88:91], v[232:235]
    ds_read_b128 a[100:103], v2 offset:2080
    v_mfma_f32_16x16x32_bf16 v[236:239], v[32:35], a[84:87], v[236:239]
    ds_read_b64_tr_b16 v[28:29], v3 offset:1040
    ds_read_b64_tr_b16 v[30:31], v3 offset:1296
    v_mfma_f32_16x16x32_bf16 v[236:239], v[36:39], a[92:95], v[236:239]
    s_waitcnt lgkmcnt(10)
    buffer_load_dwordx4 v14, s[8:11], s36 offen offset:0 nt lds
    v_mfma_f32_16x16x32_bf16 v[240:243], v[40:43], a[80:83], v[240:243]
    ds_read_b64_tr_b16 v[32:33], v3 offset:32
    ds_read_b64_tr_b16 v[34:35], v3 offset:288
    v_mfma_f32_16x16x32_bf16 v[240:243], v[44:47], a[88:91], v[240:243]
    ds_read_b128 a[104:107], v2 offset:64
    v_mfma_f32_16x16x32_bf16 v[244:247], v[40:43], a[84:87], v[244:247]
    ds_read_b64_tr_b16 v[36:37], v3 offset:1072
    ds_read_b64_tr_b16 v[38:39], v3 offset:1328
    v_mfma_f32_16x16x32_bf16 v[244:247], v[44:47], a[92:95], v[244:247]
    s_waitcnt lgkmcnt(10)
    s_add_u32 s36, s82, 261616
    v_mfma_f32_16x16x32_bf16 v[248:251], v[48:51], a[80:83], v[248:251]
    ds_read_b64_tr_b16 v[40:41], v3 offset:64
    ds_read_b64_tr_b16 v[42:43], v3 offset:320
    v_mfma_f32_16x16x32_bf16 v[248:251], v[52:55], a[88:91], v[248:251]
    ds_read_b128 a[108:111], v2 offset:2144
    v_mfma_f32_16x16x32_bf16 v[252:255], v[48:51], a[84:87], v[252:255]
    ds_read_b64_tr_b16 v[44:45], v3 offset:1104
    ds_read_b64_tr_b16 v[46:47], v3 offset:1360
    v_mfma_f32_16x16x32_bf16 v[252:255], v[52:55], a[92:95], v[252:255]
    s_waitcnt lgkmcnt(2)
    buffer_load_dwordx4 v14, s[8:11], s36 offen offset:1040 nt lds
    v_mfma_f32_16x16x32_bf16 v[64:67], v[24:27], a[96:99], v[64:67]
    ds_read_b64_tr_b16 v[48:49], v3 offset:96
    ds_read_b64_tr_b16 v[50:51], v3 offset:352
    v_mfma_f32_16x16x32_bf16 v[64:67], v[28:31], a[104:107], v[64:67]
    s_add_u32 s36, s82, 6624
    buffer_load_dwordx4 v14, s[8:11], s36 offen offset:2080 nt lds
    v_mfma_f32_16x16x32_bf16 v[68:71], v[24:27], a[100:103], v[68:71]
    ds_read_b64_tr_b16 v[52:53], v3 offset:1136
    ds_read_b64_tr_b16 v[54:55], v3 offset:1392
    v_mfma_f32_16x16x32_bf16 v[68:71], v[28:31], a[108:111], v[68:71]
    s_add_u32 s36, s82, 267728
    buffer_load_dwordx4 v14, s[8:11], s36 offen offset:3120 nt lds
    v_mfma_f32_16x16x32_bf16 v[72:75], v[32:35], a[96:99], v[72:75]
    ds_read_b64_tr_b16 v[24:25], v3 offset:128
    ds_read_b64_tr_b16 v[26:27], v3 offset:384
    v_mfma_f32_16x16x32_bf16 v[72:75], v[36:39], a[104:107], v[72:75]
    s_add_u32 m0, s29, 99840
    s_add_u32 s36, s83, 512
    v_cvt_pk_bf16_f32 v128, v64, v65
    v_mfma_f32_16x16x32_bf16 v[76:79], v[32:35], a[100:103], v[76:79]
    ds_read_b64_tr_b16 v[28:29], v3 offset:1168
    ds_read_b64_tr_b16 v[30:31], v3 offset:1424
    v_mfma_f32_16x16x32_bf16 v[76:79], v[36:39], a[108:111], v[76:79]
    s_waitcnt lgkmcnt(8)
    buffer_load_dwordx4 v14, s[8:11], s36 offen offset:0 nt lds
    v_mfma_f32_16x16x32_bf16 v[80:83], v[40:43], a[96:99], v[80:83]
    ds_read_b64_tr_b16 v[32:33], v3 offset:160
    ds_read_b64_tr_b16 v[34:35], v3 offset:416
    v_mfma_f32_16x16x32_bf16 v[80:83], v[44:47], a[104:107], v[80:83]
    s_add_u32 s36, s83, 261616
    buffer_load_dwordx4 v14, s[8:11], s36 offen offset:1040 nt lds
    v_mfma_f32_16x16x32_bf16 v[84:87], v[40:43], a[100:103], v[84:87]
    ds_read_b64_tr_b16 v[36:37], v3 offset:1200
    ds_read_b64_tr_b16 v[38:39], v3 offset:1456
    v_mfma_f32_16x16x32_bf16 v[84:87], v[44:47], a[108:111], v[84:87]
    s_waitcnt lgkmcnt(8)
    s_add_u32 s36, s83, 6624
    v_cvt_pk_bf16_f32 v129, v66, v67
    v_mfma_f32_16x16x32_bf16 v[88:91], v[48:51], a[96:99], v[88:91]
    ds_read_b64_tr_b16 v[40:41], v3 offset:192
    ds_read_b64_tr_b16 v[42:43], v3 offset:448
    buffer_load_dwordx4 v14, s[8:11], s36 offen offset:2080 nt lds
    s_add_u32 s36, s83, 267728
    buffer_load_dwordx4 v14, s[8:11], s36 offen offset:3120 nt lds
    v_mfma_f32_16x16x32_bf16 v[88:91], v[52:55], a[104:107], v[88:91]
    v_cvt_pk_bf16_f32 v130, v72, v73
    v_cvt_pk_bf16_f32 v131, v74, v75
    v_mfma_f32_16x16x32_bf16 v[92:95], v[48:51], a[100:103], v[92:95]
    ds_read_b64_tr_b16 v[44:45], v3 offset:1232
    ds_read_b64_tr_b16 v[46:47], v3 offset:1488
    v_mfma_f32_16x16x32_bf16 v[92:95], v[52:55], a[108:111], v[92:95]
    s_waitcnt lgkmcnt(8)
    s_add_u32 m0, s29, 16640
    v_cvt_pk_bf16_f32 v132, v68, v69
    v_mfma_f32_16x16x32_bf16 v[96:99], v[24:27], a[96:99], v[96:99]
    ds_read_b64_tr_b16 v[48:49], v3 offset:224
    ds_read_b64_tr_b16 v[50:51], v3 offset:480
    v_mfma_f32_16x16x32_bf16 v[96:99], v[28:31], a[104:107], v[96:99]
    s_add_u32 s36, s80, 512
    v_cvt_pk_bf16_f32 v133, v70, v71
    v_cvt_pk_bf16_f32 v134, v76, v77
    v_mfma_f32_16x16x32_bf16 v[100:103], v[24:27], a[100:103], v[100:103]
    ds_read_b64_tr_b16 v[52:53], v3 offset:1264
    ds_read_b64_tr_b16 v[54:55], v3 offset:1520
    v_mfma_f32_16x16x32_bf16 v[100:103], v[28:31], a[108:111], v[100:103]
    s_waitcnt lgkmcnt(8)
    v_add_u32 v3, 49920, v1
    v_cvt_pk_bf16_f32 v135, v78, v79
    v_mfma_f32_16x16x32_bf16 v[104:107], v[32:35], a[96:99], v[104:107]
    ds_read_b64_tr_b16 v[24:25], v3 offset:0
    ds_read_b64_tr_b16 v[26:27], v3 offset:256
    v_mfma_f32_16x16x32_bf16 v[104:107], v[36:39], a[104:107], v[104:107]
    buffer_load_dwordx4 v14, s[8:11], s36 offen offset:0 nt lds
    v_mfma_f32_16x16x32_bf16 v[108:111], v[32:35], a[100:103], v[108:111]
    ds_read_b64_tr_b16 v[28:29], v3 offset:1040
    ds_read_b64_tr_b16 v[30:31], v3 offset:1296
    v_mfma_f32_16x16x32_bf16 v[108:111], v[36:39], a[108:111], v[108:111]
    s_waitcnt lgkmcnt(8)
    s_add_u32 s36, s80, 261616
    v_cvt_pk_bf16_f32 v136, v80, v81
    v_mfma_f32_16x16x32_bf16 v[112:115], v[40:43], a[96:99], v[112:115]
    ds_read_b64_tr_b16 v[32:33], v3 offset:32
    ds_read_b64_tr_b16 v[34:35], v3 offset:288
    v_mfma_f32_16x16x32_bf16 v[112:115], v[44:47], a[104:107], v[112:115]
    v_cvt_pk_bf16_f32 v137, v82, v83
    v_cvt_pk_bf16_f32 v138, v88, v89
    v_mfma_f32_16x16x32_bf16 v[116:119], v[40:43], a[100:103], v[116:119]
    ds_read_b64_tr_b16 v[36:37], v3 offset:1072
    ds_read_b64_tr_b16 v[38:39], v3 offset:1328
    v_mfma_f32_16x16x32_bf16 v[116:119], v[44:47], a[108:111], v[116:119]
    s_waitcnt lgkmcnt(8)
    buffer_load_dwordx4 v14, s[8:11], s36 offen offset:1040 nt lds
    v_mfma_f32_16x16x32_bf16 v[120:123], v[48:51], a[96:99], v[120:123]
    ds_read_b64_tr_b16 v[40:41], v3 offset:64
    ds_read_b64_tr_b16 v[42:43], v3 offset:320
    v_mfma_f32_16x16x32_bf16 v[120:123], v[52:55], a[104:107], v[120:123]
    v_cvt_pk_bf16_f32 v139, v90, v91
    v_cvt_pk_bf16_f32 v140, v84, v85
    v_mfma_f32_16x16x32_bf16 v[124:127], v[48:51], a[100:103], v[124:127]
    ds_read_b64_tr_b16 v[44:45], v3 offset:1104
    ds_read_b64_tr_b16 v[46:47], v3 offset:1360
    v_mfma_f32_16x16x32_bf16 v[124:127], v[52:55], a[108:111], v[124:127]
    s_waitcnt lgkmcnt(8)
    s_add_u32 s36, s80, 6624
    v_cvt_pk_bf16_f32 v141, v86, v87
    v_mfma_f32_16x16x32_bf16 v[192:195], v[24:27], a[96:99], v[192:195]
    ds_read_b64_tr_b16 v[48:49], v3 offset:96
    ds_read_b64_tr_b16 v[50:51], v3 offset:352
    v_mfma_f32_16x16x32_bf16 v[192:195], v[28:31], a[104:107], v[192:195]
    buffer_load_dwordx4 v14, s[8:11], s36 offen offset:2080 nt lds
    v_mfma_f32_16x16x32_bf16 v[196:199], v[24:27], a[100:103], v[196:199]
    ds_read_b64_tr_b16 v[52:53], v3 offset:1136
    ds_read_b64_tr_b16 v[54:55], v3 offset:1392
    v_mfma_f32_16x16x32_bf16 v[196:199], v[28:31], a[108:111], v[196:199]
    s_waitcnt lgkmcnt(8)
    v_cvt_pk_bf16_f32 v142, v92, v93
    v_cvt_pk_bf16_f32 v143, v94, v95
    v_mfma_f32_16x16x32_bf16 v[200:203], v[32:35], a[96:99], v[200:203]
    ds_read_b64_tr_b16 v[24:25], v3 offset:128
    ds_read_b64_tr_b16 v[26:27], v3 offset:384
    v_mfma_f32_16x16x32_bf16 v[200:203], v[36:39], a[104:107], v[200:203]
    s_add_u32 s36, s80, 267728
    v_cvt_pk_bf16_f32 v144, v96, v97
    v_cvt_pk_bf16_f32 v145, v98, v99
    v_mfma_f32_16x16x32_bf16 v[204:207], v[32:35], a[100:103], v[204:207]
    ds_read_b64_tr_b16 v[28:29], v3 offset:1168
    ds_read_b64_tr_b16 v[30:31], v3 offset:1424
    v_mfma_f32_16x16x32_bf16 v[204:207], v[36:39], a[108:111], v[204:207]
    s_waitcnt lgkmcnt(8)
    buffer_load_dwordx4 v14, s[8:11], s36 offen offset:3120 nt lds
    v_mfma_f32_16x16x32_bf16 v[208:211], v[40:43], a[96:99], v[208:211]
    ds_read_b64_tr_b16 v[32:33], v3 offset:160
    ds_read_b64_tr_b16 v[34:35], v3 offset:416
    v_mfma_f32_16x16x32_bf16 v[208:211], v[44:47], a[104:107], v[208:211]
    v_cvt_pk_bf16_f32 v146, v104, v105
    v_cvt_pk_bf16_f32 v147, v106, v107
    v_mfma_f32_16x16x32_bf16 v[212:215], v[40:43], a[100:103], v[212:215]
    ds_read_b64_tr_b16 v[36:37], v3 offset:1200
    ds_read_b64_tr_b16 v[38:39], v3 offset:1456
    v_mfma_f32_16x16x32_bf16 v[212:215], v[44:47], a[108:111], v[212:215]
    s_waitcnt lgkmcnt(8)
    v_cvt_pk_bf16_f32 v148, v100, v101
    v_cvt_pk_bf16_f32 v149, v102, v103
    v_mfma_f32_16x16x32_bf16 v[216:219], v[48:51], a[96:99], v[216:219]
    ds_read_b64_tr_b16 v[40:41], v3 offset:192
    ds_read_b64_tr_b16 v[42:43], v3 offset:448
    v_mfma_f32_16x16x32_bf16 v[216:219], v[52:55], a[104:107], v[216:219]
    s_waitcnt vmcnt(12)
    s_barrier
    v_cvt_pk_bf16_f32 v150, v108, v109
    v_mfma_f32_16x16x32_bf16 v[220:223], v[48:51], a[100:103], v[220:223]
    ds_read_b64_tr_b16 v[44:45], v3 offset:1232
    ds_read_b64_tr_b16 v[46:47], v3 offset:1488
    v_mfma_f32_16x16x32_bf16 v[220:223], v[52:55], a[108:111], v[220:223]
    s_waitcnt lgkmcnt(8)
    s_add_u32 m0, s29, 116480
    v_cvt_pk_bf16_f32 v151, v110, v111
    v_mfma_f32_16x16x32_bf16 v[224:227], v[24:27], a[96:99], v[224:227]
    ds_read_b64_tr_b16 v[48:49], v3 offset:224
    ds_read_b64_tr_b16 v[50:51], v3 offset:480
    v_mfma_f32_16x16x32_bf16 v[224:227], v[28:31], a[104:107], v[224:227]
    s_add_u32 s36, s81, 512
    buffer_load_dwordx4 v14, s[8:11], s36 offen offset:0 nt lds
    v_mfma_f32_16x16x32_bf16 v[228:231], v[24:27], a[100:103], v[228:231]
    ds_read_b64_tr_b16 v[52:53], v3 offset:1264
    ds_read_b64_tr_b16 v[54:55], v3 offset:1520
    v_mfma_f32_16x16x32_bf16 v[228:231], v[28:31], a[108:111], v[228:231]
    s_waitcnt lgkmcnt(8)
    s_add_u32 s36, s81, 261616
    v_add_u32 v3, 66560, v1
    v_mfma_f32_16x16x32_bf16 v[232:235], v[32:35], a[96:99], v[232:235]
    ds_read_b64_tr_b16 v[24:25], v3 offset:0
    ds_read_b64_tr_b16 v[26:27], v3 offset:256
    v_mfma_f32_16x16x32_bf16 v[232:235], v[36:39], a[104:107], v[232:235]
    buffer_load_dwordx4 v14, s[8:11], s36 offen offset:1040 nt lds
    v_mfma_f32_16x16x32_bf16 v[236:239], v[32:35], a[100:103], v[236:239]
    ds_read_b64_tr_b16 v[28:29], v3 offset:1040
    ds_read_b64_tr_b16 v[30:31], v3 offset:1296
    v_mfma_f32_16x16x32_bf16 v[236:239], v[36:39], a[108:111], v[236:239]
    s_waitcnt lgkmcnt(8)
    s_add_u32 s36, s81, 6624
    v_cvt_pk_bf16_f32 v152, v112, v113
    v_mfma_f32_16x16x32_bf16 v[240:243], v[40:43], a[96:99], v[240:243]
    ds_read_b64_tr_b16 v[32:33], v3 offset:32
    ds_read_b64_tr_b16 v[34:35], v3 offset:288
    v_mfma_f32_16x16x32_bf16 v[240:243], v[44:47], a[104:107], v[240:243]
    buffer_load_dwordx4 v14, s[8:11], s36 offen offset:2080 nt lds
    v_mfma_f32_16x16x32_bf16 v[244:247], v[40:43], a[100:103], v[244:247]
    ds_read_b64_tr_b16 v[36:37], v3 offset:1072
    ds_read_b64_tr_b16 v[38:39], v3 offset:1328
    v_mfma_f32_16x16x32_bf16 v[244:247], v[44:47], a[108:111], v[244:247]
    s_waitcnt lgkmcnt(8)
    s_add_u32 s36, s81, 267728
    v_cvt_pk_bf16_f32 v153, v114, v115
    v_mfma_f32_16x16x32_bf16 v[248:251], v[48:51], a[96:99], v[248:251]
    ds_read_b64_tr_b16 v[40:41], v3 offset:64
    ds_read_b64_tr_b16 v[42:43], v3 offset:320
    v_mfma_f32_16x16x32_bf16 v[248:251], v[52:55], a[104:107], v[248:251]
    buffer_load_dwordx4 v14, s[8:11], s36 offen offset:3120 nt lds
    v_mfma_f32_16x16x32_bf16 v[252:255], v[48:51], a[100:103], v[252:255]
    ds_read_b64_tr_b16 v[44:45], v3 offset:1104
    ds_read_b64_tr_b16 v[46:47], v3 offset:1360
    v_mfma_f32_16x16x32_bf16 v[252:255], v[52:55], a[108:111], v[252:255]
    s_waitcnt lgkmcnt(8)
    s_add_u32 m0, s29, 33280
    v_cvt_pk_bf16_f32 v154, v120, v121
    v_mfma_f32_16x16x32_bf16 v[64:67], v[24:27], a[0:3], 0
    ds_read_b64_tr_b16 v[48:49], v3 offset:96
    ds_read_b64_tr_b16 v[50:51], v3 offset:352
    v_mfma_f32_16x16x32_bf16 v[64:67], v[28:31], a[8:11], v[64:67]
    s_add_u32 s36, s79, 512
    buffer_load_dwordx4 v14, s[8:11], s36 offen offset:0 nt lds
    v_mfma_f32_16x16x32_bf16 v[68:71], v[24:27], a[4:7], 0
    ds_read_b64_tr_b16 v[52:53], v3 offset:1136
    ds_read_b64_tr_b16 v[54:55], v3 offset:1392
    v_mfma_f32_16x16x32_bf16 v[68:71], v[28:31], a[12:15], v[68:71]
    s_waitcnt lgkmcnt(8)
    s_add_u32 s36, s79, 261616
    v_cvt_pk_bf16_f32 v155, v122, v123
    v_mfma_f32_16x16x32_bf16 v[72:75], v[32:35], a[0:3], 0
    ds_read_b64_tr_b16 v[24:25], v3 offset:128
    ds_read_b64_tr_b16 v[26:27], v3 offset:384
    v_mfma_f32_16x16x32_bf16 v[72:75], v[36:39], a[8:11], v[72:75]
    buffer_load_dwordx4 v14, s[8:11], s36 offen offset:1040 nt lds
    v_mfma_f32_16x16x32_bf16 v[76:79], v[32:35], a[4:7], 0
    ds_read_b64_tr_b16 v[28:29], v3 offset:1168
    ds_read_b64_tr_b16 v[30:31], v3 offset:1424
    v_mfma_f32_16x16x32_bf16 v[76:79], v[36:39], a[12:15], v[76:79]
    s_waitcnt lgkmcnt(8)
    s_add_u32 s36, s79, 6624
    v_cvt_pk_bf16_f32 v156, v116, v117
    v_mfma_f32_16x16x32_bf16 v[80:83], v[40:43], a[0:3], 0
    ds_read_b64_tr_b16 v[32:33], v3 offset:160
    ds_read_b64_tr_b16 v[34:35], v3 offset:416
    v_mfma_f32_16x16x32_bf16 v[80:83], v[44:47], a[8:11], v[80:83]
    buffer_load_dwordx4 v14, s[8:11], s36 offen offset:2080 nt lds
    v_mfma_f32_16x16x32_bf16 v[84:87], v[40:43], a[4:7], 0
    ds_read_b64_tr_b16 v[36:37], v3 offset:1200
    ds_read_b64_tr_b16 v[38:39], v3 offset:1456
    v_mfma_f32_16x16x32_bf16 v[84:87], v[44:47], a[12:15], v[84:87]
    s_waitcnt lgkmcnt(8)
    s_add_u32 s36, s79, 267728
    v_cvt_pk_bf16_f32 v157, v118, v119
    v_mfma_f32_16x16x32_bf16 v[88:91], v[48:51], a[0:3], 0
    ds_read_b64_tr_b16 v[40:41], v3 offset:192
    ds_read_b64_tr_b16 v[42:43], v3 offset:448
    buffer_load_dwordx4 v14, s[8:11], s36 offen offset:3120 nt lds
    v_mfma_f32_16x16x32_bf16 v[88:91], v[52:55], a[8:11], v[88:91]
    v_cvt_pk_bf16_f32 v158, v124, v125
    v_cvt_pk_bf16_f32 v159, v126, v127
    v_mfma_f32_16x16x32_bf16 v[92:95], v[48:51], a[4:7], 0
    ds_read_b64_tr_b16 v[44:45], v3 offset:1232
    ds_read_b64_tr_b16 v[46:47], v3 offset:1488
    v_mfma_f32_16x16x32_bf16 v[92:95], v[52:55], a[12:15], v[92:95]
    s_waitcnt lgkmcnt(8)
    s_add_u32 m0, s29, 133120
    v_permlane32_swap_b32 v128, v130
    v_mfma_f32_16x16x32_bf16 v[96:99], v[24:27], a[0:3], 0
    ds_read_b64_tr_b16 v[48:49], v3 offset:224
    ds_read_b64_tr_b16 v[50:51], v3 offset:480
    v_mfma_f32_16x16x32_bf16 v[96:99], v[28:31], a[8:11], v[96:99]
    s_add_u32 s36, s62, 768
    v_permlane32_swap_b32 v129, v131
    v_permlane16_swap_b32 v128, v130
    v_mfma_f32_16x16x32_bf16 v[100:103], v[24:27], a[4:7], 0
    ds_read_b64_tr_b16 v[52:53], v3 offset:1264
    ds_read_b64_tr_b16 v[54:55], v3 offset:1520
    v_mfma_f32_16x16x32_bf16 v[100:103], v[28:31], a[12:15], v[100:103]
    s_waitcnt lgkmcnt(8)
    v_add_u32 v3, 83200, v1
    v_permlane16_swap_b32 v129, v131
    v_mfma_f32_16x16x32_bf16 v[104:107], v[32:35], a[0:3], 0
    ds_read_b64_tr_b16 v[24:25], v3 offset:0
    ds_read_b64_tr_b16 v[26:27], v3 offset:256
    v_mfma_f32_16x16x32_bf16 v[104:107], v[36:39], a[8:11], v[104:107]
    buffer_load_dwordx4 v14, s[8:11], s36 offen offset:0 nt lds
    v_mfma_f32_16x16x32_bf16 v[108:111], v[32:35], a[4:7], 0
    ds_read_b64_tr_b16 v[28:29], v3 offset:1040
    ds_read_b64_tr_b16 v[30:31], v3 offset:1296
    v_mfma_f32_16x16x32_bf16 v[108:111], v[36:39], a[12:15], v[108:111]
    s_waitcnt lgkmcnt(8)
    s_add_u32 s36, s62, 261872
    v_permlane32_swap_b32 v132, v134
    v_mfma_f32_16x16x32_bf16 v[112:115], v[40:43], a[0:3], 0
    ds_read_b64_tr_b16 v[32:33], v3 offset:32
    ds_read_b64_tr_b16 v[34:35], v3 offset:288
    v_mfma_f32_16x16x32_bf16 v[112:115], v[44:47], a[8:11], v[112:115]
    v_permlane32_swap_b32 v133, v135
    v_permlane16_swap_b32 v132, v134
    v_mfma_f32_16x16x32_bf16 v[116:119], v[40:43], a[4:7], 0
    ds_read_b64_tr_b16 v[36:37], v3 offset:1072
    ds_read_b64_tr_b16 v[38:39], v3 offset:1328
    v_mfma_f32_16x16x32_bf16 v[116:119], v[44:47], a[12:15], v[116:119]
    s_waitcnt lgkmcnt(8)
    buffer_load_dwordx4 v14, s[8:11], s36 offen offset:1040 nt lds
    v_mfma_f32_16x16x32_bf16 v[120:123], v[48:51], a[0:3], 0
    ds_read_b64_tr_b16 v[40:41], v3 offset:64
    ds_read_b64_tr_b16 v[42:43], v3 offset:320
    v_mfma_f32_16x16x32_bf16 v[120:123], v[52:55], a[8:11], v[120:123]
    v_permlane16_swap_b32 v133, v135
    v_permlane32_swap_b32 v136, v138
    v_mfma_f32_16x16x32_bf16 v[124:127], v[48:51], a[4:7], 0
    ds_read_b64_tr_b16 v[44:45], v3 offset:1104
    ds_read_b64_tr_b16 v[46:47], v3 offset:1360
    v_mfma_f32_16x16x32_bf16 v[124:127], v[52:55], a[12:15], v[124:127]
    s_waitcnt lgkmcnt(8)
    s_add_u32 s36, s62, 6880
    v_permlane32_swap_b32 v137, v139
    v_mfma_f32_16x16x32_bf16 v[64:67], v[24:27], a[16:19], v[64:67]
    ds_read_b64_tr_b16 v[48:49], v3 offset:96
    ds_read_b64_tr_b16 v[50:51], v3 offset:352
    v_mfma_f32_16x16x32_bf16 v[64:67], v[28:31], a[24:27], v[64:67]
    buffer_load_dwordx4 v14, s[8:11], s36 offen offset:2080 nt lds
    v_mfma_f32_16x16x32_bf16 v[68:71], v[24:27], a[20:23], v[68:71]
    ds_read_b64_tr_b16 v[52:53], v3 offset:1136
    ds_read_b64_tr_b16 v[54:55], v3 offset:1392
    v_mfma_f32_16x16x32_bf16 v[68:71], v[28:31], a[28:31], v[68:71]
    s_waitcnt lgkmcnt(8)
    v_permlane16_swap_b32 v136, v138
    v_permlane16_swap_b32 v137, v139
    v_mfma_f32_16x16x32_bf16 v[72:75], v[32:35], a[16:19], v[72:75]
    ds_read_b64_tr_b16 v[24:25], v3 offset:128
    ds_read_b64_tr_b16 v[26:27], v3 offset:384
    v_mfma_f32_16x16x32_bf16 v[72:75], v[36:39], a[24:27], v[72:75]
    s_add_u32 s36, s62, 267984
    v_permlane32_swap_b32 v140, v142
    v_permlane32_swap_b32 v141, v143
    v_mfma_f32_16x16x32_bf16 v[76:79], v[32:35], a[20:23], v[76:79]
    ds_read_b64_tr_b16 v[28:29], v3 offset:1168
    ds_read_b64_tr_b16 v[30:31], v3 offset:1424
    v_mfma_f32_16x16x32_bf16 v[76:79], v[36:39], a[28:31], v[76:79]
    s_waitcnt lgkmcnt(8)
    buffer_load_dwordx4 v14, s[8:11], s36 offen offset:3120 nt lds
    v_mfma_f32_16x16x32_bf16 v[80:83], v[40:43], a[16:19], v[80:83]
    ds_read_b64_tr_b16 v[32:33], v3 offset:160
    ds_read_b64_tr_b16 v[34:35], v3 offset:416
    v_mfma_f32_16x16x32_bf16 v[80:83], v[44:47], a[24:27], v[80:83]
    v_permlane16_swap_b32 v140, v142
    v_permlane16_swap_b32 v141, v143
    v_mfma_f32_16x16x32_bf16 v[84:87], v[40:43], a[20:23], v[84:87]
    ds_read_b64_tr_b16 v[36:37], v3 offset:1200
    ds_read_b64_tr_b16 v[38:39], v3 offset:1456
    v_mfma_f32_16x16x32_bf16 v[84:87], v[44:47], a[28:31], v[84:87]
    s_waitcnt lgkmcnt(8)
    v_permlane32_swap_b32 v144, v146
    v_permlane32_swap_b32 v145, v147
    v_mfma_f32_16x16x32_bf16 v[88:91], v[48:51], a[16:19], v[88:91]
    ds_read_b64_tr_b16 v[40:41], v3 offset:192
    ds_read_b64_tr_b16 v[42:43], v3 offset:448
    v_mfma_f32_16x16x32_bf16 v[88:91], v[52:55], a[24:27], v[88:91]
    s_waitcnt vmcnt(16)
    s_barrier
    v_permlane16_swap_b32 v144, v146
    v_mfma_f32_16x16x32_bf16 v[92:95], v[48:51], a[20:23], v[92:95]
    ds_read_b64_tr_b16 v[44:45], v3 offset:1232
    ds_read_b64_tr_b16 v[46:47], v3 offset:1488
    v_mfma_f32_16x16x32_bf16 v[92:95], v[52:55], a[28:31], v[92:95]
    s_waitcnt lgkmcnt(8)
    s_add_u32 m0, s29, 49920
    v_permlane16_swap_b32 v145, v147
    v_mfma_f32_16x16x32_bf16 v[96:99], v[24:27], a[16:19], v[96:99]
    ds_read_b64_tr_b16 v[48:49], v3 offset:224
    ds_read_b64_tr_b16 v[50:51], v3 offset:480
    v_mfma_f32_16x16x32_bf16 v[96:99], v[28:31], a[24:27], v[96:99]
    s_add_u32 s36, s63, 768
    v_permlane32_swap_b32 v148, v150
    v_permlane32_swap_b32 v149, v151
    v_mfma_f32_16x16x32_bf16 v[100:103], v[24:27], a[20:23], v[100:103]
    ds_read_b64_tr_b16 v[52:53], v3 offset:1264
    ds_read_b64_tr_b16 v[54:55], v3 offset:1520
    v_mfma_f32_16x16x32_bf16 v[100:103], v[28:31], a[28:31], v[100:103]
    s_waitcnt lgkmcnt(8)
    v_add_u32 v3, 0, v1
    v_permlane16_swap_b32 v148, v150
    v_mfma_f32_16x16x32_bf16 v[104:107], v[32:35], a[16:19], v[104:107]
    ds_read_b64_tr_b16 v[24:25], v3 offset:0
    ds_read_b64_tr_b16 v[26:27], v3 offset:256
    v_mfma_f32_16x16x32_bf16 v[104:107], v[36:39], a[24:27], v[104:107]
    buffer_load_dwordx4 v14, s[8:11], s36 offen offset:0 nt lds
    v_mfma_f32_16x16x32_bf16 v[108:111], v[32:35], a[20:23], v[108:111]
    ds_read_b64_tr_b16 v[28:29], v3 offset:1040
    ds_read_b64_tr_b16 v[30:31], v3 offset:1296
    v_mfma_f32_16x16x32_bf16 v[108:111], v[36:39], a[28:31], v[108:111]
    s_waitcnt lgkmcnt(8)
    s_add_u32 s36, s63, 261872
    v_permlane16_swap_b32 v149, v151
    v_mfma_f32_16x16x32_bf16 v[112:115], v[40:43], a[16:19], v[112:115]
    ds_read_b64_tr_b16 v[32:33], v3 offset:32
    ds_read_b64_tr_b16 v[34:35], v3 offset:288
    v_mfma_f32_16x16x32_bf16 v[112:115], v[44:47], a[24:27], v[112:115]
    v_permlane32_swap_b32 v152, v154
    v_permlane32_swap_b32 v153, v155
    v_mfma_f32_16x16x32_bf16 v[116:119], v[40:43], a[20:23], v[116:119]
    ds_read_b64_tr_b16 v[36:37], v3 offset:1072
    ds_read_b64_tr_b16 v[38:39], v3 offset:1328
    v_mfma_f32_16x16x32_bf16 v[116:119], v[44:47], a[28:31], v[116:119]
    s_waitcnt lgkmcnt(8)
    buffer_load_dwordx4 v14, s[8:11], s36 offen offset:1040 nt lds
    v_mfma_f32_16x16x32_bf16 v[120:123], v[48:51], a[16:19], v[120:123]
    ds_read_b64_tr_b16 v[40:41], v3 offset:64
    ds_read_b64_tr_b16 v[42:43], v3 offset:320
    v_mfma_f32_16x16x32_bf16 v[120:123], v[52:55], a[24:27], v[120:123]
    v_permlane16_swap_b32 v152, v154
    v_permlane16_swap_b32 v153, v155
    v_mfma_f32_16x16x32_bf16 v[124:127], v[48:51], a[20:23], v[124:127]
    ds_read_b64_tr_b16 v[44:45], v3 offset:1104
    ds_read_b64_tr_b16 v[46:47], v3 offset:1360
    v_mfma_f32_16x16x32_bf16 v[124:127], v[52:55], a[28:31], v[124:127]
    s_waitcnt lgkmcnt(8)
    s_add_u32 s36, s63, 6880
    v_permlane32_swap_b32 v156, v158
    v_mfma_f32_16x16x32_bf16 v[64:67], v[24:27], a[32:35], v[64:67]
    ds_read_b64_tr_b16 v[48:49], v3 offset:96
    ds_read_b64_tr_b16 v[50:51], v3 offset:352
    v_mfma_f32_16x16x32_bf16 v[64:67], v[28:31], a[40:43], v[64:67]
    buffer_load_dwordx4 v14, s[8:11], s36 offen offset:2080 nt lds
    v_mfma_f32_16x16x32_bf16 v[68:71], v[24:27], a[36:39], v[68:71]
    ds_read_b64_tr_b16 v[52:53], v3 offset:1136
    ds_read_b64_tr_b16 v[54:55], v3 offset:1392
    v_mfma_f32_16x16x32_bf16 v[68:71], v[28:31], a[44:47], v[68:71]
    s_waitcnt lgkmcnt(8)
    v_permlane32_swap_b32 v157, v159
    v_permlane16_swap_b32 v156, v158
    v_mfma_f32_16x16x32_bf16 v[72:75], v[32:35], a[32:35], v[72:75]
    ds_read_b64_tr_b16 v[24:25], v3 offset:128
    ds_read_b64_tr_b16 v[26:27], v3 offset:384
    v_mfma_f32_16x16x32_bf16 v[72:75], v[36:39], a[40:43], v[72:75]
    s_add_u32 s36, s63, 267984
    v_permlane16_swap_b32 v157, v159
    v_cvt_pk_bf16_f32 v160, v192, v193
    v_mfma_f32_16x16x32_bf16 v[76:79], v[32:35], a[36:39], v[76:79]
    ds_read_b64_tr_b16 v[28:29], v3 offset:1168
    ds_read_b64_tr_b16 v[30:31], v3 offset:1424
    v_mfma_f32_16x16x32_bf16 v[76:79], v[36:39], a[44:47], v[76:79]
    s_waitcnt lgkmcnt(8)
    buffer_load_dwordx4 v14, s[8:11], s36 offen offset:3120 nt lds
    v_mfma_f32_16x16x32_bf16 v[80:83], v[40:43], a[32:35], v[80:83]
    ds_read_b64_tr_b16 v[32:33], v3 offset:160
    ds_read_b64_tr_b16 v[34:35], v3 offset:416
    v_mfma_f32_16x16x32_bf16 v[80:83], v[44:47], a[40:43], v[80:83]
    v_cvt_pk_bf16_f32 v161, v194, v195
    v_cvt_pk_bf16_f32 v162, v200, v201
    v_mfma_f32_16x16x32_bf16 v[84:87], v[40:43], a[36:39], v[84:87]
    ds_read_b64_tr_b16 v[36:37], v3 offset:1200
    ds_read_b64_tr_b16 v[38:39], v3 offset:1456
    v_mfma_f32_16x16x32_bf16 v[84:87], v[44:47], a[44:47], v[84:87]
    s_waitcnt lgkmcnt(8)
    v_cvt_pk_bf16_f32 v163, v202, v203
    v_cvt_pk_bf16_f32 v164, v196, v197
    v_mfma_f32_16x16x32_bf16 v[88:91], v[48:51], a[32:35], v[88:91]
    ds_read_b64_tr_b16 v[40:41], v3 offset:192
    ds_read_b64_tr_b16 v[42:43], v3 offset:448
    v_mfma_f32_16x16x32_bf16 v[88:91], v[52:55], a[40:43], v[88:91]
    v_cvt_pk_bf16_f32 v165, v198, v199
    v_cvt_pk_bf16_f32 v166, v204, v205
    v_mfma_f32_16x16x32_bf16 v[92:95], v[48:51], a[36:39], v[92:95]
    ds_read_b64_tr_b16 v[44:45], v3 offset:1232
    ds_read_b64_tr_b16 v[46:47], v3 offset:1488
    v_mfma_f32_16x16x32_bf16 v[92:95], v[52:55], a[44:47], v[92:95]
    s_waitcnt lgkmcnt(8)
    s_add_u32 m0, s29, 66560
    v_cvt_pk_bf16_f32 v167, v206, v207
    v_mfma_f32_16x16x32_bf16 v[96:99], v[24:27], a[32:35], v[96:99]
    ds_read_b64_tr_b16 v[48:49], v3 offset:224
    ds_read_b64_tr_b16 v[50:51], v3 offset:480
    v_mfma_f32_16x16x32_bf16 v[96:99], v[28:31], a[40:43], v[96:99]
    s_add_u32 s36, s82, 768
    v_cvt_pk_bf16_f32 v168, v208, v209
    v_cvt_pk_bf16_f32 v169, v210, v211
    v_mfma_f32_16x16x32_bf16 v[100:103], v[24:27], a[36:39], v[100:103]
    ds_read_b64_tr_b16 v[52:53], v3 offset:1264
    ds_read_b64_tr_b16 v[54:55], v3 offset:1520
    v_mfma_f32_16x16x32_bf16 v[100:103], v[28:31], a[44:47], v[100:103]
    s_waitcnt lgkmcnt(8)
    v_add_u32 v3, 99840, v1
    v_cvt_pk_bf16_f32 v170, v216, v217
    v_mfma_f32_16x16x32_bf16 v[104:107], v[32:35], a[32:35], v[104:107]
    ds_read_b64_tr_b16 v[24:25], v3 offset:0
    ds_read_b64_tr_b16 v[26:27], v3 offset:256
    v_mfma_f32_16x16x32_bf16 v[104:107], v[36:39], a[40:43], v[104:107]
    buffer_load_dwordx4 v14, s[8:11], s36 offen offset:0 nt lds
    v_mfma_f32_16x16x32_bf16 v[108:111], v[32:35], a[36:39], v[108:111]
    ds_read_b64_tr_b16 v[28:29], v3 offset:1040
    ds_read_b64_tr_b16 v[30:31], v3 offset:1296
    v_mfma_f32_16x16x32_bf16 v[108:111], v[36:39], a[44:47], v[108:111]
    s_waitcnt lgkmcnt(8)
    s_add_u32 s36, s82, 261872
    v_cvt_pk_bf16_f32 v171, v218, v219
    v_mfma_f32_16x16x32_bf16 v[112:115], v[40:43], a[32:35], v[112:115]
    ds_read_b64_tr_b16 v[32:33], v3 offset:32
    ds_read_b64_tr_b16 v[34:35], v3 offset:288
    v_mfma_f32_16x16x32_bf16 v[112:115], v[44:47], a[40:43], v[112:115]
    v_cvt_pk_bf16_f32 v172, v212, v213
    v_cvt_pk_bf16_f32 v173, v214, v215
    v_mfma_f32_16x16x32_bf16 v[116:119], v[40:43], a[36:39], v[116:119]
    ds_read_b64_tr_b16 v[36:37], v3 offset:1072
    ds_read_b64_tr_b16 v[38:39], v3 offset:1328
    v_mfma_f32_16x16x32_bf16 v[116:119], v[44:47], a[44:47], v[116:119]
    s_waitcnt lgkmcnt(8)
    buffer_load_dwordx4 v14, s[8:11], s36 offen offset:1040 nt lds
    v_mfma_f32_16x16x32_bf16 v[120:123], v[48:51], a[32:35], v[120:123]
    ds_read_b64_tr_b16 v[40:41], v3 offset:64
    ds_read_b64_tr_b16 v[42:43], v3 offset:320
    v_mfma_f32_16x16x32_bf16 v[120:123], v[52:55], a[40:43], v[120:123]
    v_cvt_pk_bf16_f32 v174, v220, v221
    v_cvt_pk_bf16_f32 v175, v222, v223
    v_mfma_f32_16x16x32_bf16 v[124:127], v[48:51], a[36:39], v[124:127]
    ds_read_b64_tr_b16 v[44:45], v3 offset:1104
    ds_read_b64_tr_b16 v[46:47], v3 offset:1360
    v_mfma_f32_16x16x32_bf16 v[124:127], v[52:55], a[44:47], v[124:127]
    s_waitcnt lgkmcnt(8)
    s_add_u32 s36, s82, 6880
    v_cvt_pk_bf16_f32 v176, v224, v225
    v_mfma_f32_16x16x32_bf16 v[64:67], v[24:27], a[48:51], v[64:67]
    ds_read_b64_tr_b16 v[48:49], v3 offset:96
    ds_read_b64_tr_b16 v[50:51], v3 offset:352
    v_mfma_f32_16x16x32_bf16 v[64:67], v[28:31], a[56:59], v[64:67]
    buffer_load_dwordx4 v14, s[8:11], s36 offen offset:2080 nt lds
    v_mfma_f32_16x16x32_bf16 v[68:71], v[24:27], a[52:55], v[68:71]
    ds_read_b64_tr_b16 v[52:53], v3 offset:1136
    ds_read_b64_tr_b16 v[54:55], v3 offset:1392
    v_mfma_f32_16x16x32_bf16 v[68:71], v[28:31], a[60:63], v[68:71]
    s_waitcnt lgkmcnt(8)
    v_cvt_pk_bf16_f32 v177, v226, v227
    v_cvt_pk_bf16_f32 v178, v232, v233
    v_mfma_f32_16x16x32_bf16 v[72:75], v[32:35], a[48:51], v[72:75]
    ds_read_b64_tr_b16 v[24:25], v3 offset:128
    ds_read_b64_tr_b16 v[26:27], v3 offset:384
    v_mfma_f32_16x16x32_bf16 v[72:75], v[36:39], a[56:59], v[72:75]
    s_add_u32 s36, s82, 267984
    v_cvt_pk_bf16_f32 v179, v234, v235
    v_cvt_pk_bf16_f32 v180, v228, v229
    v_mfma_f32_16x16x32_bf16 v[76:79], v[32:35], a[52:55], v[76:79]
    ds_read_b64_tr_b16 v[28:29], v3 offset:1168
    ds_read_b64_tr_b16 v[30:31], v3 offset:1424
    v_mfma_f32_16x16x32_bf16 v[76:79], v[36:39], a[60:63], v[76:79]
    s_waitcnt lgkmcnt(8)
    buffer_load_dwordx4 v14, s[8:11], s36 offen offset:3120 nt lds
    v_mfma_f32_16x16x32_bf16 v[80:83], v[40:43], a[48:51], v[80:83]
    ds_read_b64_tr_b16 v[32:33], v3 offset:160
    ds_read_b64_tr_b16 v[34:35], v3 offset:416
    v_mfma_f32_16x16x32_bf16 v[80:83], v[44:47], a[56:59], v[80:83]
    v_cvt_pk_bf16_f32 v181, v230, v231
    v_cvt_pk_bf16_f32 v182, v236, v237
    v_mfma_f32_16x16x32_bf16 v[84:87], v[40:43], a[52:55], v[84:87]
    ds_read_b64_tr_b16 v[36:37], v3 offset:1200
    ds_read_b64_tr_b16 v[38:39], v3 offset:1456
    v_mfma_f32_16x16x32_bf16 v[84:87], v[44:47], a[60:63], v[84:87]
    s_waitcnt lgkmcnt(8)
    v_cvt_pk_bf16_f32 v183, v238, v239
    v_cvt_pk_bf16_f32 v184, v240, v241
    v_mfma_f32_16x16x32_bf16 v[88:91], v[48:51], a[48:51], v[88:91]
    ds_read_b64_tr_b16 v[40:41], v3 offset:192
    ds_read_b64_tr_b16 v[42:43], v3 offset:448
    v_mfma_f32_16x16x32_bf16 v[88:91], v[52:55], a[56:59], v[88:91]
    s_waitcnt vmcnt(16)
    s_barrier
    v_cvt_pk_bf16_f32 v185, v242, v243
    v_mfma_f32_16x16x32_bf16 v[92:95], v[48:51], a[52:55], v[92:95]
    ds_read_b64_tr_b16 v[44:45], v3 offset:1232
    ds_read_b64_tr_b16 v[46:47], v3 offset:1488
    v_mfma_f32_16x16x32_bf16 v[92:95], v[52:55], a[60:63], v[92:95]
    s_waitcnt lgkmcnt(8)
    s_add_u32 m0, s29, 83200
    v_cvt_pk_bf16_f32 v186, v248, v249
    v_mfma_f32_16x16x32_bf16 v[96:99], v[24:27], a[48:51], v[96:99]
    ds_read_b64_tr_b16 v[48:49], v3 offset:224
    ds_read_b64_tr_b16 v[50:51], v3 offset:480
    v_mfma_f32_16x16x32_bf16 v[96:99], v[28:31], a[56:59], v[96:99]
    s_add_u32 s36, s83, 768
    buffer_load_dwordx4 v14, s[8:11], s36 offen offset:0 nt lds
    v_mfma_f32_16x16x32_bf16 v[100:103], v[24:27], a[52:55], v[100:103]
    ds_read_b64_tr_b16 v[52:53], v3 offset:1264
    ds_read_b64_tr_b16 v[54:55], v3 offset:1520
    v_mfma_f32_16x16x32_bf16 v[100:103], v[28:31], a[60:63], v[100:103]
    s_waitcnt lgkmcnt(8)
    s_add_u32 s36, s83, 261872
    v_add_u32 v3, 16640, v1
    v_mfma_f32_16x16x32_bf16 v[104:107], v[32:35], a[48:51], v[104:107]
    ds_read_b64_tr_b16 v[24:25], v3 offset:0
    ds_read_b64_tr_b16 v[26:27], v3 offset:256
    v_mfma_f32_16x16x32_bf16 v[104:107], v[36:39], a[56:59], v[104:107]
    buffer_load_dwordx4 v14, s[8:11], s36 offen offset:1040 nt lds
    v_mfma_f32_16x16x32_bf16 v[108:111], v[32:35], a[52:55], v[108:111]
    ds_read_b64_tr_b16 v[28:29], v3 offset:1040
    ds_read_b64_tr_b16 v[30:31], v3 offset:1296
    v_mfma_f32_16x16x32_bf16 v[108:111], v[36:39], a[60:63], v[108:111]
    s_waitcnt lgkmcnt(8)
    s_add_u32 s36, s83, 6880
    v_cvt_pk_bf16_f32 v187, v250, v251
    v_mfma_f32_16x16x32_bf16 v[112:115], v[40:43], a[48:51], v[112:115]
    ds_read_b64_tr_b16 v[32:33], v3 offset:32
    ds_read_b64_tr_b16 v[34:35], v3 offset:288
    v_mfma_f32_16x16x32_bf16 v[112:115], v[44:47], a[56:59], v[112:115]
    buffer_load_dwordx4 v14, s[8:11], s36 offen offset:2080 nt lds
    v_mfma_f32_16x16x32_bf16 v[116:119], v[40:43], a[52:55], v[116:119]
    ds_read_b64_tr_b16 v[36:37], v3 offset:1072
    ds_read_b64_tr_b16 v[38:39], v3 offset:1328
    v_mfma_f32_16x16x32_bf16 v[116:119], v[44:47], a[60:63], v[116:119]
    s_waitcnt lgkmcnt(8)
    s_add_u32 s36, s83, 267984
    v_cvt_pk_bf16_f32 v188, v244, v245
    v_mfma_f32_16x16x32_bf16 v[120:123], v[48:51], a[48:51], v[120:123]
    ds_read_b64_tr_b16 v[40:41], v3 offset:64
    ds_read_b64_tr_b16 v[42:43], v3 offset:320
    v_mfma_f32_16x16x32_bf16 v[120:123], v[52:55], a[56:59], v[120:123]
    buffer_load_dwordx4 v14, s[8:11], s36 offen offset:3120 nt lds
    v_mfma_f32_16x16x32_bf16 v[124:127], v[48:51], a[52:55], v[124:127]
    ds_read_b64_tr_b16 v[44:45], v3 offset:1104
    ds_read_b64_tr_b16 v[46:47], v3 offset:1360
    v_mfma_f32_16x16x32_bf16 v[124:127], v[52:55], a[60:63], v[124:127]
    s_waitcnt lgkmcnt(8)
    s_add_u32 m0, s29, 0
    v_cvt_pk_bf16_f32 v189, v246, v247
    v_mfma_f32_16x16x32_bf16 v[64:67], v[24:27], a[64:67], v[64:67]
    ds_read_b64_tr_b16 v[48:49], v3 offset:96
    ds_read_b64_tr_b16 v[50:51], v3 offset:352
    v_mfma_f32_16x16x32_bf16 v[64:67], v[28:31], a[72:75], v[64:67]
    s_mov_b32 s36, 64
    buffer_load_dwordx4 v4, s[12:15], s36 offen offset:0 nt lds
    v_mfma_f32_16x16x32_bf16 v[68:71], v[24:27], a[68:71], v[68:71]
    ds_read_b64_tr_b16 v[52:53], v3 offset:1136
    ds_read_b64_tr_b16 v[54:55], v3 offset:1392
    v_mfma_f32_16x16x32_bf16 v[68:71], v[28:31], a[76:79], v[68:71]
    s_waitcnt lgkmcnt(8)
    s_mov_b32 s36, 48
    v_cvt_pk_bf16_f32 v190, v252, v253
    v_mfma_f32_16x16x32_bf16 v[72:75], v[32:35], a[64:67], v[72:75]
    ds_read_b64_tr_b16 v[24:25], v3 offset:128
    ds_read_b64_tr_b16 v[26:27], v3 offset:384
    v_mfma_f32_16x16x32_bf16 v[72:75], v[36:39], a[72:75], v[72:75]
    v_mov_b32 v15, 0
    v_cvt_pk_bf16_f32 v191, v254, v255
    v_mfma_f32_16x16x32_bf16 v[76:79], v[32:35], a[68:71], v[76:79]
    ds_read_b64_tr_b16 v[28:29], v3 offset:1168
    ds_read_b64_tr_b16 v[30:31], v3 offset:1424
    v_mfma_f32_16x16x32_bf16 v[76:79], v[36:39], a[76:79], v[76:79]
    s_waitcnt lgkmcnt(8)
    v_lshrrev_b32 v16, 2, v4
    v_permlane32_swap_b32 v160, v162
    v_mfma_f32_16x16x32_bf16 v[80:83], v[40:43], a[64:67], v[80:83]
    ds_read_b64_tr_b16 v[32:33], v3 offset:160
    ds_read_b64_tr_b16 v[34:35], v3 offset:416
    v_mfma_f32_16x16x32_bf16 v[80:83], v[44:47], a[72:75], v[80:83]
    v_and_b32 v16, 0xff, v16
    v_permlane32_swap_b32 v161, v163
    v_mfma_f32_16x16x32_bf16 v[84:87], v[40:43], a[68:71], v[84:87]
    ds_read_b64_tr_b16 v[36:37], v3 offset:1200
    ds_read_b64_tr_b16 v[38:39], v3 offset:1456
    v_mfma_f32_16x16x32_bf16 v[84:87], v[44:47], a[76:79], v[84:87]
    s_waitcnt lgkmcnt(8)
    buffer_load_dwordx4 v4, s[12:15], s36 offen offset:1040 nt lds
    v_mfma_f32_16x16x32_bf16 v[88:91], v[48:51], a[64:67], v[88:91]
    ds_read_b64_tr_b16 v[40:41], v3 offset:192
    ds_read_b64_tr_b16 v[42:43], v3 offset:448
    s_mov_b32 s36, 32
    buffer_load_dwordx4 v4, s[12:15], s36 offen offset:2080 nt lds
    s_mov_b32 s36, 16
    buffer_load_dwordx4 v4, s[12:15], s36 offen offset:3120 nt lds
    v_mfma_f32_16x16x32_bf16 v[88:91], v[52:55], a[72:75], v[88:91]
    v_permlane16_swap_b32 v160, v162
    v_permlane16_swap_b32 v161, v163
    v_mfma_f32_16x16x32_bf16 v[92:95], v[48:51], a[68:71], v[92:95]
    ds_read_b64_tr_b16 v[44:45], v3 offset:1232
    ds_read_b64_tr_b16 v[46:47], v3 offset:1488
    v_mfma_f32_16x16x32_bf16 v[92:95], v[52:55], a[76:79], v[92:95]
    s_waitcnt lgkmcnt(8)
    s_lshl_b32 s46, s2, 2
    v_permlane32_swap_b32 v164, v166
    v_mfma_f32_16x16x32_bf16 v[96:99], v[24:27], a[64:67], v[96:99]
    ds_read_b64_tr_b16 v[48:49], v3 offset:224
    ds_read_b64_tr_b16 v[50:51], v3 offset:480
    v_mfma_f32_16x16x32_bf16 v[96:99], v[28:31], a[72:75], v[96:99]
    v_permlane32_swap_b32 v165, v167
    v_permlane16_swap_b32 v164, v166
    v_mfma_f32_16x16x32_bf16 v[100:103], v[24:27], a[68:71], v[100:103]
    ds_read_b64_tr_b16 v[52:53], v3 offset:1264
    ds_read_b64_tr_b16 v[54:55], v3 offset:1520
    v_mfma_f32_16x16x32_bf16 v[100:103], v[28:31], a[76:79], v[100:103]
    s_waitcnt lgkmcnt(8)
    s_add_u32 s46, s46, s28
    v_add_u32 v3, 116480, v1
    v_mfma_f32_16x16x32_bf16 v[104:107], v[32:35], a[64:67], v[104:107]
    ds_read_b64_tr_b16 v[24:25], v3 offset:0
    ds_read_b64_tr_b16 v[26:27], v3 offset:256
    v_mfma_f32_16x16x32_bf16 v[104:107], v[36:39], a[72:75], v[104:107]
    v_permlane16_swap_b32 v165, v167
    v_permlane32_swap_b32 v168, v170
    v_mfma_f32_16x16x32_bf16 v[108:111], v[32:35], a[68:71], v[108:111]
    ds_read_b64_tr_b16 v[28:29], v3 offset:1040
    ds_read_b64_tr_b16 v[30:31], v3 offset:1296
    v_mfma_f32_16x16x32_bf16 v[108:111], v[36:39], a[76:79], v[108:111]
    s_waitcnt lgkmcnt(8)
    s_lshl_b32 s46, s46, 7
    v_permlane32_swap_b32 v169, v171
    v_mfma_f32_16x16x32_bf16 v[112:115], v[40:43], a[64:67], v[112:115]
    ds_read_b64_tr_b16 v[32:33], v3 offset:32
    ds_read_b64_tr_b16 v[34:35], v3 offset:288
    v_mfma_f32_16x16x32_bf16 v[112:115], v[44:47], a[72:75], v[112:115]
    v_permlane16_swap_b32 v168, v170
    v_permlane16_swap_b32 v169, v171
    v_mfma_f32_16x16x32_bf16 v[116:119], v[40:43], a[68:71], v[116:119]
    ds_read_b64_tr_b16 v[36:37], v3 offset:1072
    ds_read_b64_tr_b16 v[38:39], v3 offset:1328
    v_mfma_f32_16x16x32_bf16 v[116:119], v[44:47], a[76:79], v[116:119]
    s_waitcnt lgkmcnt(8)
    s_add_u32 s46, s46, 33554432
    v_permlane32_swap_b32 v172, v174
    v_mfma_f32_16x16x32_bf16 v[120:123], v[48:51], a[64:67], v[120:123]
    ds_read_b64_tr_b16 v[40:41], v3 offset:64
    ds_read_b64_tr_b16 v[42:43], v3 offset:320
    v_mfma_f32_16x16x32_bf16 v[120:123], v[52:55], a[72:75], v[120:123]
    v_permlane32_swap_b32 v173, v175
    v_permlane16_swap_b32 v172, v174
    v_mfma_f32_16x16x32_bf16 v[124:127], v[48:51], a[68:71], v[124:127]
    ds_read_b64_tr_b16 v[44:45], v3 offset:1104
    ds_read_b64_tr_b16 v[46:47], v3 offset:1360
    v_mfma_f32_16x16x32_bf16 v[124:127], v[52:55], a[76:79], v[124:127]
    s_waitcnt lgkmcnt(8)
    s_add_u32 s4, s84, s46
    s_addc_u32 s5, s85, 0
    v_permlane16_swap_b32 v173, v175
    v_mfma_f32_16x16x32_bf16 v[64:67], v[24:27], a[80:83], v[64:67]
    ds_read_b64_tr_b16 v[48:49], v3 offset:96
    ds_read_b64_tr_b16 v[50:51], v3 offset:352
    v_mfma_f32_16x16x32_bf16 v[64:67], v[28:31], a[88:91], v[64:67]
    v_permlane32_swap_b32 v176, v178
    v_permlane32_swap_b32 v177, v179
    v_mfma_f32_16x16x32_bf16 v[68:71], v[24:27], a[84:87], v[68:71]
    ds_read_b64_tr_b16 v[52:53], v3 offset:1136
    ds_read_b64_tr_b16 v[54:55], v3 offset:1392
    v_mfma_f32_16x16x32_bf16 v[68:71], v[28:31], a[92:95], v[68:71]
    s_waitcnt lgkmcnt(8)
    s_mov_b32 s6, 32
    v_permlane16_swap_b32 v176, v178
    v_mfma_f32_16x16x32_bf16 v[72:75], v[32:35], a[80:83], v[72:75]
    ds_read_b64_tr_b16 v[24:25], v3 offset:128
    ds_read_b64_tr_b16 v[26:27], v3 offset:384
    v_mfma_f32_16x16x32_bf16 v[72:75], v[36:39], a[88:91], v[72:75]
    v_permlane16_swap_b32 v177, v179
    v_permlane32_swap_b32 v180, v182
    v_mfma_f32_16x16x32_bf16 v[76:79], v[32:35], a[84:87], v[76:79]
    ds_read_b64_tr_b16 v[28:29], v3 offset:1168
    ds_read_b64_tr_b16 v[30:31], v3 offset:1424
    v_mfma_f32_16x16x32_bf16 v[76:79], v[36:39], a[92:95], v[76:79]
    s_waitcnt lgkmcnt(8)
    buffer_store_dword v15, v16, s[4:7], 0 offen sc1
    v_permlane32_swap_b32 v181, v183
    v_mfma_f32_16x16x32_bf16 v[80:83], v[40:43], a[80:83], v[80:83]
    ds_read_b64_tr_b16 v[32:33], v3 offset:160
    ds_read_b64_tr_b16 v[34:35], v3 offset:416
    v_mfma_f32_16x16x32_bf16 v[80:83], v[44:47], a[88:91], v[80:83]
    v_permlane16_swap_b32 v180, v182
    v_permlane16_swap_b32 v181, v183
    v_mfma_f32_16x16x32_bf16 v[84:87], v[40:43], a[84:87], v[84:87]
    ds_read_b64_tr_b16 v[36:37], v3 offset:1200
    ds_read_b64_tr_b16 v[38:39], v3 offset:1456
    v_mfma_f32_16x16x32_bf16 v[84:87], v[44:47], a[92:95], v[84:87]
    s_waitcnt lgkmcnt(8)
    v_permlane32_swap_b32 v184, v186
    v_permlane32_swap_b32 v185, v187
    v_mfma_f32_16x16x32_bf16 v[88:91], v[48:51], a[80:83], v[88:91]
    ds_read_b64_tr_b16 v[40:41], v3 offset:192
    ds_read_b64_tr_b16 v[42:43], v3 offset:448
    v_mfma_f32_16x16x32_bf16 v[88:91], v[52:55], a[88:91], v[88:91]
    s_waitcnt vmcnt(17)
    s_barrier
    v_permlane16_swap_b32 v184, v186
    v_mfma_f32_16x16x32_bf16 v[92:95], v[48:51], a[84:87], v[92:95]
    ds_read_b64_tr_b16 v[44:45], v3 offset:1232
    ds_read_b64_tr_b16 v[46:47], v3 offset:1488
    v_mfma_f32_16x16x32_bf16 v[92:95], v[52:55], a[92:95], v[92:95]
    s_waitcnt lgkmcnt(8)
    s_add_u32 m0, s29, 99840
    v_permlane16_swap_b32 v185, v187
    v_mfma_f32_16x16x32_bf16 v[96:99], v[24:27], a[80:83], v[96:99]
    ds_read_b64_tr_b16 v[48:49], v3 offset:224
    ds_read_b64_tr_b16 v[50:51], v3 offset:480
    v_mfma_f32_16x16x32_bf16 v[96:99], v[28:31], a[88:91], v[96:99]
    s_add_u32 s36, s80, 768
    buffer_load_dwordx4 v14, s[8:11], s36 offen offset:0 nt lds
    v_mfma_f32_16x16x32_bf16 v[100:103], v[24:27], a[84:87], v[100:103]
    ds_read_b64_tr_b16 v[52:53], v3 offset:1264
    ds_read_b64_tr_b16 v[54:55], v3 offset:1520
    v_mfma_f32_16x16x32_bf16 v[100:103], v[28:31], a[92:95], v[100:103]
    s_waitcnt lgkmcnt(8)
    s_add_u32 s36, s80, 261872
    v_add_u32 v3, 33280, v1
    v_mfma_f32_16x16x32_bf16 v[104:107], v[32:35], a[80:83], v[104:107]
    ds_read_b64_tr_b16 v[24:25], v3 offset:0
    ds_read_b64_tr_b16 v[26:27], v3 offset:256
    v_mfma_f32_16x16x32_bf16 v[104:107], v[36:39], a[88:91], v[104:107]
    buffer_load_dwordx4 v14, s[8:11], s36 offen offset:1040 nt lds
    v_mfma_f32_16x16x32_bf16 v[108:111], v[32:35], a[84:87], v[108:111]
    ds_read_b64_tr_b16 v[28:29], v3 offset:1040
    ds_read_b64_tr_b16 v[30:31], v3 offset:1296
    v_mfma_f32_16x16x32_bf16 v[108:111], v[36:39], a[92:95], v[108:111]
    s_waitcnt lgkmcnt(8)
    s_add_u32 s36, s80, 6880
    v_permlane32_swap_b32 v188, v190
    v_mfma_f32_16x16x32_bf16 v[112:115], v[40:43], a[80:83], v[112:115]
    ds_read_b64_tr_b16 v[32:33], v3 offset:32
    ds_read_b64_tr_b16 v[34:35], v3 offset:288
    v_mfma_f32_16x16x32_bf16 v[112:115], v[44:47], a[88:91], v[112:115]
    buffer_load_dwordx4 v14, s[8:11], s36 offen offset:2080 nt lds
    v_mfma_f32_16x16x32_bf16 v[116:119], v[40:43], a[84:87], v[116:119]
    ds_read_b64_tr_b16 v[36:37], v3 offset:1072
    ds_read_b64_tr_b16 v[38:39], v3 offset:1328
    v_mfma_f32_16x16x32_bf16 v[116:119], v[44:47], a[92:95], v[116:119]
    s_waitcnt lgkmcnt(8)
    s_add_u32 s36, s80, 267984
    v_permlane32_swap_b32 v189, v191
    v_mfma_f32_16x16x32_bf16 v[120:123], v[48:51], a[80:83], v[120:123]
    ds_read_b64_tr_b16 v[40:41], v3 offset:64
    ds_read_b64_tr_b16 v[42:43], v3 offset:320
    v_mfma_f32_16x16x32_bf16 v[120:123], v[52:55], a[88:91], v[120:123]
    buffer_load_dwordx4 v14, s[8:11], s36 offen offset:3120 nt lds
    v_mfma_f32_16x16x32_bf16 v[124:127], v[48:51], a[84:87], v[124:127]
    ds_read_b64_tr_b16 v[44:45], v3 offset:1104
    ds_read_b64_tr_b16 v[46:47], v3 offset:1360
    v_mfma_f32_16x16x32_bf16 v[124:127], v[52:55], a[92:95], v[124:127]
    s_waitcnt lgkmcnt(8)
    s_add_u32 m0, s29, 16640
    v_permlane16_swap_b32 v188, v190
    v_mfma_f32_16x16x32_bf16 v[64:67], v[24:27], a[96:99], v[64:67]
    ds_read_b64_tr_b16 v[48:49], v3 offset:96
    ds_read_b64_tr_b16 v[50:51], v3 offset:352
    v_mfma_f32_16x16x32_bf16 v[64:67], v[28:31], a[104:107], v[64:67]
    s_mov_b32 s36, 16448
    buffer_load_dwordx4 v4, s[12:15], s36 offen offset:0 nt lds
    v_mfma_f32_16x16x32_bf16 v[68:71], v[24:27], a[100:103], v[68:71]
    ds_read_b64_tr_b16 v[52:53], v3 offset:1136
    ds_read_b64_tr_b16 v[54:55], v3 offset:1392
    v_mfma_f32_16x16x32_bf16 v[68:71], v[28:31], a[108:111], v[68:71]
    s_waitcnt lgkmcnt(8)
    s_mov_b32 s36, 16432
    v_permlane16_swap_b32 v189, v191
    v_mfma_f32_16x16x32_bf16 v[72:75], v[32:35], a[96:99], v[72:75]
    ds_read_b64_tr_b16 v[24:25], v3 offset:128
    ds_read_b64_tr_b16 v[26:27], v3 offset:384
    v_mfma_f32_16x16x32_bf16 v[72:75], v[36:39], a[104:107], v[72:75]
    buffer_load_dwordx4 v4, s[12:15], s36 offen offset:1040 nt lds
    v_mfma_f32_16x16x32_bf16 v[76:79], v[32:35], a[100:103], v[76:79]
    ds_read_b64_tr_b16 v[28:29], v3 offset:1168
    ds_read_b64_tr_b16 v[30:31], v3 offset:1424
    v_mfma_f32_16x16x32_bf16 v[76:79], v[36:39], a[108:111], v[76:79]
    s_waitcnt lgkmcnt(8)
    s_mov_b32 s36, 16416
    v_cvt_pk_bf16_f32 v192, v64, v65
    v_mfma_f32_16x16x32_bf16 v[80:83], v[40:43], a[96:99], v[80:83]
    ds_read_b64_tr_b16 v[32:33], v3 offset:160
    ds_read_b64_tr_b16 v[34:35], v3 offset:416
    v_mfma_f32_16x16x32_bf16 v[80:83], v[44:47], a[104:107], v[80:83]
    buffer_load_dwordx4 v4, s[12:15], s36 offen offset:2080 nt lds
    v_mfma_f32_16x16x32_bf16 v[84:87], v[40:43], a[100:103], v[84:87]
    ds_read_b64_tr_b16 v[36:37], v3 offset:1200
    ds_read_b64_tr_b16 v[38:39], v3 offset:1456
    v_mfma_f32_16x16x32_bf16 v[84:87], v[44:47], a[108:111], v[84:87]
    s_waitcnt lgkmcnt(8)
    s_mov_b32 s36, 16400
    v_cvt_pk_bf16_f32 v193, v66, v67
    v_mfma_f32_16x16x32_bf16 v[88:91], v[48:51], a[96:99], v[88:91]
    ds_read_b64_tr_b16 v[40:41], v3 offset:192
    ds_read_b64_tr_b16 v[42:43], v3 offset:448
    buffer_load_dwordx4 v4, s[12:15], s36 offen offset:3120 nt lds
    v_mfma_f32_16x16x32_bf16 v[88:91], v[52:55], a[104:107], v[88:91]
    v_cvt_pk_bf16_f32 v194, v72, v73
    v_cvt_pk_bf16_f32 v195, v74, v75
    v_mfma_f32_16x16x32_bf16 v[92:95], v[48:51], a[100:103], v[92:95]
    ds_read_b64_tr_b16 v[44:45], v3 offset:1232
    ds_read_b64_tr_b16 v[46:47], v3 offset:1488
    v_mfma_f32_16x16x32_bf16 v[92:95], v[52:55], a[108:111], v[92:95]
    s_waitcnt lgkmcnt(8)
    v_cvt_pk_bf16_f32 v196, v68, v69
    v_cvt_pk_bf16_f32 v197, v70, v71
    v_mfma_f32_16x16x32_bf16 v[96:99], v[24:27], a[96:99], v[96:99]
    ds_read_b64_tr_b16 v[48:49], v3 offset:224
    ds_read_b64_tr_b16 v[50:51], v3 offset:480
    v_mfma_f32_16x16x32_bf16 v[96:99], v[28:31], a[104:107], v[96:99]
    v_cvt_pk_bf16_f32 v198, v76, v77
    v_cvt_pk_bf16_f32 v199, v78, v79
    v_mfma_f32_16x16x32_bf16 v[100:103], v[24:27], a[100:103], v[100:103]
    ds_read_b64_tr_b16 v[52:53], v3 offset:1264
    ds_read_b64_tr_b16 v[54:55], v3 offset:1520
    v_mfma_f32_16x16x32_bf16 v[100:103], v[28:31], a[108:111], v[100:103]
    s_waitcnt lgkmcnt(8)
    v_add_u32 v3, 133120, v1
    v_cvt_pk_bf16_f32 v200, v80, v81
    v_mfma_f32_16x16x32_bf16 v[104:107], v[32:35], a[96:99], v[104:107]
    ds_read_b64_tr_b16 v[24:25], v3 offset:0
    ds_read_b64_tr_b16 v[26:27], v3 offset:256
    v_mfma_f32_16x16x32_bf16 v[104:107], v[36:39], a[104:107], v[104:107]
    v_cvt_pk_bf16_f32 v201, v82, v83
    v_cvt_pk_bf16_f32 v202, v88, v89
    v_mfma_f32_16x16x32_bf16 v[108:111], v[32:35], a[100:103], v[108:111]
    ds_read_b64_tr_b16 v[28:29], v3 offset:1040
    ds_read_b64_tr_b16 v[30:31], v3 offset:1296
    v_mfma_f32_16x16x32_bf16 v[108:111], v[36:39], a[108:111], v[108:111]
    s_waitcnt lgkmcnt(8)
    v_cvt_pk_bf16_f32 v203, v90, v91
    v_cvt_pk_bf16_f32 v204, v84, v85
    v_mfma_f32_16x16x32_bf16 v[112:115], v[40:43], a[96:99], v[112:115]
    ds_read_b64_tr_b16 v[32:33], v3 offset:32
    ds_read_b64_tr_b16 v[34:35], v3 offset:288
    v_mfma_f32_16x16x32_bf16 v[112:115], v[44:47], a[104:107], v[112:115]
    v_cvt_pk_bf16_f32 v205, v86, v87
    v_cvt_pk_bf16_f32 v206, v92, v93
    v_mfma_f32_16x16x32_bf16 v[116:119], v[40:43], a[100:103], v[116:119]
    ds_read_b64_tr_b16 v[36:37], v3 offset:1072
    ds_read_b64_tr_b16 v[38:39], v3 offset:1328
    v_mfma_f32_16x16x32_bf16 v[116:119], v[44:47], a[108:111], v[116:119]
    s_waitcnt lgkmcnt(8)
    v_cvt_pk_bf16_f32 v207, v94, v95
    v_cvt_pk_bf16_f32 v208, v96, v97
    v_mfma_f32_16x16x32_bf16 v[120:123], v[48:51], a[96:99], v[120:123]
    ds_read_b64_tr_b16 v[40:41], v3 offset:64
    ds_read_b64_tr_b16 v[42:43], v3 offset:320
    v_mfma_f32_16x16x32_bf16 v[120:123], v[52:55], a[104:107], v[120:123]
    v_cvt_pk_bf16_f32 v209, v98, v99
    v_cvt_pk_bf16_f32 v210, v104, v105
    v_mfma_f32_16x16x32_bf16 v[124:127], v[48:51], a[100:103], v[124:127]
    ds_read_b64_tr_b16 v[44:45], v3 offset:1104
    ds_read_b64_tr_b16 v[46:47], v3 offset:1360
    v_mfma_f32_16x16x32_bf16 v[124:127], v[52:55], a[108:111], v[124:127]
    s_waitcnt lgkmcnt(8)
    v_cvt_pk_bf16_f32 v211, v106, v107
    v_cvt_pk_bf16_f32 v212, v100, v101
    v_mfma_f32_16x16x32_bf16 v[64:67], v[24:27], a[0:3], 0
    ds_read_b64_tr_b16 v[48:49], v3 offset:96
    ds_read_b64_tr_b16 v[50:51], v3 offset:352
    v_mfma_f32_16x16x32_bf16 v[64:67], v[28:31], a[8:11], v[64:67]
    v_cvt_pk_bf16_f32 v213, v102, v103
    v_cvt_pk_bf16_f32 v214, v108, v109
    v_mfma_f32_16x16x32_bf16 v[68:71], v[24:27], a[4:7], 0
    ds_read_b64_tr_b16 v[52:53], v3 offset:1136
    ds_read_b64_tr_b16 v[54:55], v3 offset:1392
    v_mfma_f32_16x16x32_bf16 v[68:71], v[28:31], a[12:15], v[68:71]
    s_waitcnt lgkmcnt(8)
    v_cvt_pk_bf16_f32 v215, v110, v111
    v_cvt_pk_bf16_f32 v216, v112, v113
    v_mfma_f32_16x16x32_bf16 v[72:75], v[32:35], a[0:3], 0
    ds_read_b64_tr_b16 v[24:25], v3 offset:128
    ds_read_b64_tr_b16 v[26:27], v3 offset:384
    v_mfma_f32_16x16x32_bf16 v[72:75], v[36:39], a[8:11], v[72:75]
    v_cvt_pk_bf16_f32 v217, v114, v115
    v_cvt_pk_bf16_f32 v218, v120, v121
    v_mfma_f32_16x16x32_bf16 v[76:79], v[32:35], a[4:7], 0
    ds_read_b64_tr_b16 v[28:29], v3 offset:1168
    ds_read_b64_tr_b16 v[30:31], v3 offset:1424
    v_mfma_f32_16x16x32_bf16 v[76:79], v[36:39], a[12:15], v[76:79]
    s_waitcnt lgkmcnt(8)
    v_cvt_pk_bf16_f32 v219, v122, v123
    v_cvt_pk_bf16_f32 v220, v116, v117
    v_mfma_f32_16x16x32_bf16 v[80:83], v[40:43], a[0:3], 0
    ds_read_b64_tr_b16 v[32:33], v3 offset:160
    ds_read_b64_tr_b16 v[34:35], v3 offset:416
    v_mfma_f32_16x16x32_bf16 v[80:83], v[44:47], a[8:11], v[80:83]
    v_cvt_pk_bf16_f32 v221, v118, v119
    v_cvt_pk_bf16_f32 v222, v124, v125
    v_mfma_f32_16x16x32_bf16 v[84:87], v[40:43], a[4:7], 0
    ds_read_b64_tr_b16 v[36:37], v3 offset:1200
    ds_read_b64_tr_b16 v[38:39], v3 offset:1456
    v_mfma_f32_16x16x32_bf16 v[84:87], v[44:47], a[12:15], v[84:87]
    s_waitcnt lgkmcnt(8)
    v_cvt_pk_bf16_f32 v223, v126, v127
    v_permlane32_swap_b32 v192, v194
    v_mfma_f32_16x16x32_bf16 v[88:91], v[48:51], a[0:3], 0
    ds_read_b64_tr_b16 v[40:41], v3 offset:192
    ds_read_b64_tr_b16 v[42:43], v3 offset:448
    v_mfma_f32_16x16x32_bf16 v[88:91], v[52:55], a[8:11], v[88:91]
    s_waitcnt vmcnt(17)
    s_barrier
    v_permlane32_swap_b32 v193, v195
    v_mfma_f32_16x16x32_bf16 v[92:95], v[48:51], a[4:7], 0
    ds_read_b64_tr_b16 v[44:45], v3 offset:1232
    ds_read_b64_tr_b16 v[46:47], v3 offset:1488
    v_mfma_f32_16x16x32_bf16 v[92:95], v[52:55], a[12:15], v[92:95]
    s_waitcnt lgkmcnt(8)
    s_add_u32 m0, s29, 116480
    v_permlane16_swap_b32 v192, v194
    v_mfma_f32_16x16x32_bf16 v[96:99], v[24:27], a[0:3], 0
    ds_read_b64_tr_b16 v[48:49], v3 offset:224
    ds_read_b64_tr_b16 v[50:51], v3 offset:480
    v_mfma_f32_16x16x32_bf16 v[96:99], v[28:31], a[8:11], v[96:99]
    s_add_u32 s36, s81, 768
    buffer_load_dwordx4 v14, s[8:11], s36 offen offset:0 nt lds
    v_mfma_f32_16x16x32_bf16 v[100:103], v[24:27], a[4:7], 0
    ds_read_b64_tr_b16 v[52:53], v3 offset:1264
    ds_read_b64_tr_b16 v[54:55], v3 offset:1520
    v_mfma_f32_16x16x32_bf16 v[100:103], v[28:31], a[12:15], v[100:103]
    s_waitcnt lgkmcnt(8)
    s_add_u32 s36, s81, 261872
    v_add_u32 v3, 49920, v1
    v_mfma_f32_16x16x32_bf16 v[104:107], v[32:35], a[0:3], 0
    ds_read_b64_tr_b16 v[24:25], v3 offset:0
    ds_read_b64_tr_b16 v[26:27], v3 offset:256
    v_mfma_f32_16x16x32_bf16 v[104:107], v[36:39], a[8:11], v[104:107]
    buffer_load_dwordx4 v14, s[8:11], s36 offen offset:1040 nt lds
    v_mfma_f32_16x16x32_bf16 v[108:111], v[32:35], a[4:7], 0
    ds_read_b64_tr_b16 v[28:29], v3 offset:1040
    ds_read_b64_tr_b16 v[30:31], v3 offset:1296
    v_mfma_f32_16x16x32_bf16 v[108:111], v[36:39], a[12:15], v[108:111]
    s_waitcnt lgkmcnt(8)
    s_add_u32 s36, s81, 6880
    v_permlane16_swap_b32 v193, v195
    v_mfma_f32_16x16x32_bf16 v[112:115], v[40:43], a[0:3], 0
    ds_read_b64_tr_b16 v[32:33], v3 offset:32
    ds_read_b64_tr_b16 v[34:35], v3 offset:288
    v_mfma_f32_16x16x32_bf16 v[112:115], v[44:47], a[8:11], v[112:115]
    buffer_load_dwordx4 v14, s[8:11], s36 offen offset:2080 nt lds
    v_mfma_f32_16x16x32_bf16 v[116:119], v[40:43], a[4:7], 0
    ds_read_b64_tr_b16 v[36:37], v3 offset:1072
    ds_read_b64_tr_b16 v[38:39], v3 offset:1328
    v_mfma_f32_16x16x32_bf16 v[116:119], v[44:47], a[12:15], v[116:119]
    s_waitcnt lgkmcnt(8)
    s_add_u32 s36, s81, 267984
    v_permlane32_swap_b32 v196, v198
    v_mfma_f32_16x16x32_bf16 v[120:123], v[48:51], a[0:3], 0
    ds_read_b64_tr_b16 v[40:41], v3 offset:64
    ds_read_b64_tr_b16 v[42:43], v3 offset:320
    v_mfma_f32_16x16x32_bf16 v[120:123], v[52:55], a[8:11], v[120:123]
    buffer_load_dwordx4 v14, s[8:11], s36 offen offset:3120 nt lds
    v_mfma_f32_16x16x32_bf16 v[124:127], v[48:51], a[4:7], 0
    ds_read_b64_tr_b16 v[44:45], v3 offset:1104
    ds_read_b64_tr_b16 v[46:47], v3 offset:1360
    v_mfma_f32_16x16x32_bf16 v[124:127], v[52:55], a[12:15], v[124:127]
    s_waitcnt lgkmcnt(8)
    s_add_u32 m0, s29, 33280
    v_permlane32_swap_b32 v197, v199
    v_mfma_f32_16x16x32_bf16 v[64:67], v[24:27], a[16:19], v[64:67]
    ds_read_b64_tr_b16 v[48:49], v3 offset:96
    ds_read_b64_tr_b16 v[50:51], v3 offset:352
    v_mfma_f32_16x16x32_bf16 v[64:67], v[28:31], a[24:27], v[64:67]
    s_mov_b32 s36, 64
    buffer_load_dwordx4 v5, s[16:19], s36 offen offset:0 nt lds
    v_mfma_f32_16x16x32_bf16 v[68:71], v[24:27], a[20:23], v[68:71]
    ds_read_b64_tr_b16 v[52:53], v3 offset:1136
    ds_read_b64_tr_b16 v[54:55], v3 offset:1392
    v_mfma_f32_16x16x32_bf16 v[68:71], v[28:31], a[28:31], v[68:71]
    s_waitcnt lgkmcnt(8)
    s_mov_b32 s36, 48
    v_permlane16_swap_b32 v196, v198
    v_mfma_f32_16x16x32_bf16 v[72:75], v[32:35], a[16:19], v[72:75]
    ds_read_b64_tr_b16 v[24:25], v3 offset:128
    ds_read_b64_tr_b16 v[26:27], v3 offset:384
    v_mfma_f32_16x16x32_bf16 v[72:75], v[36:39], a[24:27], v[72:75]
    buffer_load_dwordx4 v5, s[16:19], s36 offen offset:1040 nt lds
    v_mfma_f32_16x16x32_bf16 v[76:79], v[32:35], a[20:23], v[76:79]
    ds_read_b64_tr_b16 v[28:29], v3 offset:1168
    ds_read_b64_tr_b16 v[30:31], v3 offset:1424
    v_mfma_f32_16x16x32_bf16 v[76:79], v[36:39], a[28:31], v[76:79]
    s_waitcnt lgkmcnt(8)
    s_mov_b32 s36, 32
    v_permlane16_swap_b32 v197, v199
    v_mfma_f32_16x16x32_bf16 v[80:83], v[40:43], a[16:19], v[80:83]
    ds_read_b64_tr_b16 v[32:33], v3 offset:160
    ds_read_b64_tr_b16 v[34:35], v3 offset:416
    v_mfma_f32_16x16x32_bf16 v[80:83], v[44:47], a[24:27], v[80:83]
    buffer_load_dwordx4 v5, s[16:19], s36 offen offset:2080 nt lds
    v_mfma_f32_16x16x32_bf16 v[84:87], v[40:43], a[20:23], v[84:87]
    ds_read_b64_tr_b16 v[36:37], v3 offset:1200
    ds_read_b64_tr_b16 v[38:39], v3 offset:1456
    v_mfma_f32_16x16x32_bf16 v[84:87], v[44:47], a[28:31], v[84:87]
    s_waitcnt lgkmcnt(8)
    s_mov_b32 s36, 16
    v_permlane32_swap_b32 v200, v202
    v_mfma_f32_16x16x32_bf16 v[88:91], v[48:51], a[16:19], v[88:91]
    ds_read_b64_tr_b16 v[40:41], v3 offset:192
    ds_read_b64_tr_b16 v[42:43], v3 offset:448
    buffer_load_dwordx4 v5, s[16:19], s36 offen offset:3120 nt lds
    v_mfma_f32_16x16x32_bf16 v[88:91], v[52:55], a[24:27], v[88:91]
    v_permlane32_swap_b32 v201, v203
    v_permlane16_swap_b32 v200, v202
    v_mfma_f32_16x16x32_bf16 v[92:95], v[48:51], a[20:23], v[92:95]
    ds_read_b64_tr_b16 v[44:45], v3 offset:1232
    ds_read_b64_tr_b16 v[46:47], v3 offset:1488
    v_mfma_f32_16x16x32_bf16 v[92:95], v[52:55], a[28:31], v[92:95]
    s_waitcnt lgkmcnt(8)
    v_permlane16_swap_b32 v201, v203
    v_permlane32_swap_b32 v204, v206
    v_mfma_f32_16x16x32_bf16 v[96:99], v[24:27], a[16:19], v[96:99]
    ds_read_b64_tr_b16 v[48:49], v3 offset:224
    ds_read_b64_tr_b16 v[50:51], v3 offset:480
    v_mfma_f32_16x16x32_bf16 v[96:99], v[28:31], a[24:27], v[96:99]
    v_permlane32_swap_b32 v205, v207
    v_permlane16_swap_b32 v204, v206
    v_mfma_f32_16x16x32_bf16 v[100:103], v[24:27], a[20:23], v[100:103]
    ds_read_b64_tr_b16 v[52:53], v3 offset:1264
    ds_read_b64_tr_b16 v[54:55], v3 offset:1520
    v_mfma_f32_16x16x32_bf16 v[100:103], v[28:31], a[28:31], v[100:103]
    s_waitcnt lgkmcnt(8)
    v_add_u32 v3, 66560, v1
    v_permlane16_swap_b32 v205, v207
    v_mfma_f32_16x16x32_bf16 v[104:107], v[32:35], a[16:19], v[104:107]
    ds_read_b64_tr_b16 v[24:25], v3 offset:0
    ds_read_b64_tr_b16 v[26:27], v3 offset:256
    v_mfma_f32_16x16x32_bf16 v[104:107], v[36:39], a[24:27], v[104:107]
    v_permlane32_swap_b32 v208, v210
    v_permlane32_swap_b32 v209, v211
    v_mfma_f32_16x16x32_bf16 v[108:111], v[32:35], a[20:23], v[108:111]
    ds_read_b64_tr_b16 v[28:29], v3 offset:1040
    ds_read_b64_tr_b16 v[30:31], v3 offset:1296
    v_mfma_f32_16x16x32_bf16 v[108:111], v[36:39], a[28:31], v[108:111]
    s_waitcnt lgkmcnt(8)
    v_permlane16_swap_b32 v208, v210
    v_permlane16_swap_b32 v209, v211
    v_mfma_f32_16x16x32_bf16 v[112:115], v[40:43], a[16:19], v[112:115]
    ds_read_b64_tr_b16 v[32:33], v3 offset:32
    ds_read_b64_tr_b16 v[34:35], v3 offset:288
    v_mfma_f32_16x16x32_bf16 v[112:115], v[44:47], a[24:27], v[112:115]
    v_permlane32_swap_b32 v212, v214
    v_permlane32_swap_b32 v213, v215
    v_mfma_f32_16x16x32_bf16 v[116:119], v[40:43], a[20:23], v[116:119]
    ds_read_b64_tr_b16 v[36:37], v3 offset:1072
    ds_read_b64_tr_b16 v[38:39], v3 offset:1328
    v_mfma_f32_16x16x32_bf16 v[116:119], v[44:47], a[28:31], v[116:119]
    s_waitcnt lgkmcnt(8)
    v_permlane16_swap_b32 v212, v214
    v_permlane16_swap_b32 v213, v215
    v_mfma_f32_16x16x32_bf16 v[120:123], v[48:51], a[16:19], v[120:123]
    ds_read_b64_tr_b16 v[40:41], v3 offset:64
    ds_read_b64_tr_b16 v[42:43], v3 offset:320
    v_mfma_f32_16x16x32_bf16 v[120:123], v[52:55], a[24:27], v[120:123]
    v_permlane32_swap_b32 v216, v218
    v_permlane32_swap_b32 v217, v219
    v_mfma_f32_16x16x32_bf16 v[124:127], v[48:51], a[20:23], v[124:127]
    ds_read_b64_tr_b16 v[44:45], v3 offset:1104
    ds_read_b64_tr_b16 v[46:47], v3 offset:1360
    v_mfma_f32_16x16x32_bf16 v[124:127], v[52:55], a[28:31], v[124:127]
    s_waitcnt lgkmcnt(8)
    v_permlane16_swap_b32 v216, v218
    v_permlane16_swap_b32 v217, v219
    v_mfma_f32_16x16x32_bf16 v[64:67], v[24:27], a[32:35], v[64:67]
    ds_read_b64_tr_b16 v[48:49], v3 offset:96
    ds_read_b64_tr_b16 v[50:51], v3 offset:352
    v_mfma_f32_16x16x32_bf16 v[64:67], v[28:31], a[40:43], v[64:67]
    v_permlane32_swap_b32 v220, v222
    v_permlane32_swap_b32 v221, v223
    v_mfma_f32_16x16x32_bf16 v[68:71], v[24:27], a[36:39], v[68:71]
    ds_read_b64_tr_b16 v[52:53], v3 offset:1136
    ds_read_b64_tr_b16 v[54:55], v3 offset:1392
    v_mfma_f32_16x16x32_bf16 v[68:71], v[28:31], a[44:47], v[68:71]
    s_waitcnt lgkmcnt(8)
    v_permlane16_swap_b32 v220, v222
    v_permlane16_swap_b32 v221, v223
    v_mfma_f32_16x16x32_bf16 v[72:75], v[32:35], a[32:35], v[72:75]
    ds_read_b64_tr_b16 v[24:25], v3 offset:128
    ds_read_b64_tr_b16 v[26:27], v3 offset:384
    v_mfma_f32_16x16x32_bf16 v[72:75], v[36:39], a[40:43], v[72:75]
    v_mfma_f32_16x16x32_bf16 v[76:79], v[32:35], a[36:39], v[76:79]
    ds_read_b64_tr_b16 v[28:29], v3 offset:1168
    ds_read_b64_tr_b16 v[30:31], v3 offset:1424
    v_mfma_f32_16x16x32_bf16 v[76:79], v[36:39], a[44:47], v[76:79]
    s_waitcnt lgkmcnt(8)
    v_mfma_f32_16x16x32_bf16 v[80:83], v[40:43], a[32:35], v[80:83]
    ds_read_b64_tr_b16 v[32:33], v3 offset:160
    ds_read_b64_tr_b16 v[34:35], v3 offset:416
    v_mfma_f32_16x16x32_bf16 v[80:83], v[44:47], a[40:43], v[80:83]
    v_mfma_f32_16x16x32_bf16 v[84:87], v[40:43], a[36:39], v[84:87]
    ds_read_b64_tr_b16 v[36:37], v3 offset:1200
    ds_read_b64_tr_b16 v[38:39], v3 offset:1456
    v_mfma_f32_16x16x32_bf16 v[84:87], v[44:47], a[44:47], v[84:87]
    s_waitcnt lgkmcnt(8)
    v_mfma_f32_16x16x32_bf16 v[88:91], v[48:51], a[32:35], v[88:91]
    ds_read_b64_tr_b16 v[40:41], v3 offset:192
    ds_read_b64_tr_b16 v[42:43], v3 offset:448
    v_mfma_f32_16x16x32_bf16 v[88:91], v[52:55], a[40:43], v[88:91]
    s_waitcnt vmcnt(12)
    s_barrier
    v_mfma_f32_16x16x32_bf16 v[92:95], v[48:51], a[36:39], v[92:95]
    ds_read_b64_tr_b16 v[44:45], v3 offset:1232
    ds_read_b64_tr_b16 v[46:47], v3 offset:1488
    v_mfma_f32_16x16x32_bf16 v[92:95], v[52:55], a[44:47], v[92:95]
    s_waitcnt lgkmcnt(8)
    s_add_u32 m0, s29, 133120
    v_mfma_f32_16x16x32_bf16 v[96:99], v[24:27], a[32:35], v[96:99]
    ds_read_b64_tr_b16 v[48:49], v3 offset:224
    ds_read_b64_tr_b16 v[50:51], v3 offset:480
    v_mfma_f32_16x16x32_bf16 v[96:99], v[28:31], a[40:43], v[96:99]
    s_add_u32 s36, s79, 768
    buffer_load_dwordx4 v14, s[8:11], s36 offen offset:0 nt lds
    v_mfma_f32_16x16x32_bf16 v[100:103], v[24:27], a[36:39], v[100:103]
    ds_read_b64_tr_b16 v[52:53], v3 offset:1264
    ds_read_b64_tr_b16 v[54:55], v3 offset:1520
    v_mfma_f32_16x16x32_bf16 v[100:103], v[28:31], a[44:47], v[100:103]
    s_waitcnt lgkmcnt(8)
    s_add_u32 s36, s79, 261872
    v_add_u32 v3, 83200, v1
    v_mfma_f32_16x16x32_bf16 v[104:107], v[32:35], a[32:35], v[104:107]
    ds_read_b64_tr_b16 v[24:25], v3 offset:0
    ds_read_b64_tr_b16 v[26:27], v3 offset:256
    v_mfma_f32_16x16x32_bf16 v[104:107], v[36:39], a[40:43], v[104:107]
    buffer_load_dwordx4 v14, s[8:11], s36 offen offset:1040 nt lds
    v_mfma_f32_16x16x32_bf16 v[108:111], v[32:35], a[36:39], v[108:111]
    ds_read_b64_tr_b16 v[28:29], v3 offset:1040
    ds_read_b64_tr_b16 v[30:31], v3 offset:1296
    v_mfma_f32_16x16x32_bf16 v[108:111], v[36:39], a[44:47], v[108:111]
    s_waitcnt lgkmcnt(8)
    s_add_u32 s36, s79, 6880
    v_mfma_f32_16x16x32_bf16 v[112:115], v[40:43], a[32:35], v[112:115]
    ds_read_b64_tr_b16 v[32:33], v3 offset:32
    ds_read_b64_tr_b16 v[34:35], v3 offset:288
    v_mfma_f32_16x16x32_bf16 v[112:115], v[44:47], a[40:43], v[112:115]
    buffer_load_dwordx4 v14, s[8:11], s36 offen offset:2080 nt lds
    v_mfma_f32_16x16x32_bf16 v[116:119], v[40:43], a[36:39], v[116:119]
    ds_read_b64_tr_b16 v[36:37], v3 offset:1072
    ds_read_b64_tr_b16 v[38:39], v3 offset:1328
    v_mfma_f32_16x16x32_bf16 v[116:119], v[44:47], a[44:47], v[116:119]
    s_waitcnt lgkmcnt(8)
    s_add_u32 s36, s79, 267984
    v_mfma_f32_16x16x32_bf16 v[120:123], v[48:51], a[32:35], v[120:123]
    ds_read_b64_tr_b16 v[40:41], v3 offset:64
    ds_read_b64_tr_b16 v[42:43], v3 offset:320
    v_mfma_f32_16x16x32_bf16 v[120:123], v[52:55], a[40:43], v[120:123]
    buffer_load_dwordx4 v14, s[8:11], s36 offen offset:3120 nt lds
    v_mfma_f32_16x16x32_bf16 v[124:127], v[48:51], a[36:39], v[124:127]
    ds_read_b64_tr_b16 v[44:45], v3 offset:1104
    ds_read_b64_tr_b16 v[46:47], v3 offset:1360
    v_mfma_f32_16x16x32_bf16 v[124:127], v[52:55], a[44:47], v[124:127]
    s_waitcnt lgkmcnt(8)
    s_add_u32 m0, s29, 49920
    v_mfma_f32_16x16x32_bf16 v[64:67], v[24:27], a[48:51], v[64:67]
    ds_read_b64_tr_b16 v[48:49], v3 offset:96
    ds_read_b64_tr_b16 v[50:51], v3 offset:352
    v_mfma_f32_16x16x32_bf16 v[64:67], v[28:31], a[56:59], v[64:67]
    s_mov_b32 s36, 32832
    buffer_load_dwordx4 v4, s[12:15], s36 offen offset:0 nt lds
    v_mfma_f32_16x16x32_bf16 v[68:71], v[24:27], a[52:55], v[68:71]
    ds_read_b64_tr_b16 v[52:53], v3 offset:1136
    ds_read_b64_tr_b16 v[54:55], v3 offset:1392
    v_mfma_f32_16x16x32_bf16 v[68:71], v[28:31], a[60:63], v[68:71]
    s_waitcnt lgkmcnt(8)
    s_mov_b32 s36, 32816
    v_mfma_f32_16x16x32_bf16 v[72:75], v[32:35], a[48:51], v[72:75]
    ds_read_b64_tr_b16 v[24:25], v3 offset:128
    ds_read_b64_tr_b16 v[26:27], v3 offset:384
    v_mfma_f32_16x16x32_bf16 v[72:75], v[36:39], a[56:59], v[72:75]
    buffer_load_dwordx4 v4, s[12:15], s36 offen offset:1040 nt lds
    v_mfma_f32_16x16x32_bf16 v[76:79], v[32:35], a[52:55], v[76:79]
    ds_read_b64_tr_b16 v[28:29], v3 offset:1168
    ds_read_b64_tr_b16 v[30:31], v3 offset:1424
    v_mfma_f32_16x16x32_bf16 v[76:79], v[36:39], a[60:63], v[76:79]
    s_waitcnt lgkmcnt(8)
    s_mov_b32 s36, 32800
    v_mfma_f32_16x16x32_bf16 v[80:83], v[40:43], a[48:51], v[80:83]
    ds_read_b64_tr_b16 v[32:33], v3 offset:160
    ds_read_b64_tr_b16 v[34:35], v3 offset:416
    v_mfma_f32_16x16x32_bf16 v[80:83], v[44:47], a[56:59], v[80:83]
    buffer_load_dwordx4 v4, s[12:15], s36 offen offset:2080 nt lds
    v_mfma_f32_16x16x32_bf16 v[84:87], v[40:43], a[52:55], v[84:87]
    ds_read_b64_tr_b16 v[36:37], v3 offset:1200
    ds_read_b64_tr_b16 v[38:39], v3 offset:1456
    v_mfma_f32_16x16x32_bf16 v[84:87], v[44:47], a[60:63], v[84:87]
    s_waitcnt lgkmcnt(8)
    s_mov_b32 s36, 32784
    v_mfma_f32_16x16x32_bf16 v[88:91], v[48:51], a[48:51], v[88:91]
    ds_read_b64_tr_b16 v[40:41], v3 offset:192
    ds_read_b64_tr_b16 v[42:43], v3 offset:448
    buffer_load_dwordx4 v4, s[12:15], s36 offen offset:3120 nt lds
    v_mfma_f32_16x16x32_bf16 v[88:91], v[52:55], a[56:59], v[88:91]
    v_mfma_f32_16x16x32_bf16 v[92:95], v[48:51], a[52:55], v[92:95]
    ds_read_b64_tr_b16 v[44:45], v3 offset:1232
    ds_read_b64_tr_b16 v[46:47], v3 offset:1488
    v_mfma_f32_16x16x32_bf16 v[92:95], v[52:55], a[60:63], v[92:95]
    s_waitcnt lgkmcnt(8)
    v_mfma_f32_16x16x32_bf16 v[96:99], v[24:27], a[48:51], v[96:99]
    ds_read_b64_tr_b16 v[48:49], v3 offset:224
    ds_read_b64_tr_b16 v[50:51], v3 offset:480
    v_mfma_f32_16x16x32_bf16 v[96:99], v[28:31], a[56:59], v[96:99]
    v_mfma_f32_16x16x32_bf16 v[100:103], v[24:27], a[52:55], v[100:103]
    ds_read_b64_tr_b16 v[52:53], v3 offset:1264
    ds_read_b64_tr_b16 v[54:55], v3 offset:1520
    v_mfma_f32_16x16x32_bf16 v[100:103], v[28:31], a[60:63], v[100:103]
    s_waitcnt lgkmcnt(8)
    v_add_u32 v3, 99840, v1
    v_mfma_f32_16x16x32_bf16 v[104:107], v[32:35], a[48:51], v[104:107]
    ds_read_b64_tr_b16 v[24:25], v3 offset:0
    ds_read_b64_tr_b16 v[26:27], v3 offset:256
    v_mfma_f32_16x16x32_bf16 v[104:107], v[36:39], a[56:59], v[104:107]
    v_mfma_f32_16x16x32_bf16 v[108:111], v[32:35], a[52:55], v[108:111]
    ds_read_b64_tr_b16 v[28:29], v3 offset:1040
    ds_read_b64_tr_b16 v[30:31], v3 offset:1296
    v_mfma_f32_16x16x32_bf16 v[108:111], v[36:39], a[60:63], v[108:111]
    s_waitcnt lgkmcnt(8)
    v_mfma_f32_16x16x32_bf16 v[112:115], v[40:43], a[48:51], v[112:115]
    ds_read_b64_tr_b16 v[32:33], v3 offset:32
    ds_read_b64_tr_b16 v[34:35], v3 offset:288
    v_mfma_f32_16x16x32_bf16 v[112:115], v[44:47], a[56:59], v[112:115]
    v_mfma_f32_16x16x32_bf16 v[116:119], v[40:43], a[52:55], v[116:119]
    ds_read_b64_tr_b16 v[36:37], v3 offset:1072
    ds_read_b64_tr_b16 v[38:39], v3 offset:1328
    v_mfma_f32_16x16x32_bf16 v[116:119], v[44:47], a[60:63], v[116:119]
    s_waitcnt lgkmcnt(8)
    v_mfma_f32_16x16x32_bf16 v[120:123], v[48:51], a[48:51], v[120:123]
    ds_read_b64_tr_b16 v[40:41], v3 offset:64
    ds_read_b64_tr_b16 v[42:43], v3 offset:320
    v_mfma_f32_16x16x32_bf16 v[120:123], v[52:55], a[56:59], v[120:123]
    v_mfma_f32_16x16x32_bf16 v[124:127], v[48:51], a[52:55], v[124:127]
    ds_read_b64_tr_b16 v[44:45], v3 offset:1104
    ds_read_b64_tr_b16 v[46:47], v3 offset:1360
    v_mfma_f32_16x16x32_bf16 v[124:127], v[52:55], a[60:63], v[124:127]
    s_waitcnt lgkmcnt(8)
    v_mfma_f32_16x16x32_bf16 v[64:67], v[24:27], a[64:67], v[64:67]
    ds_read_b64_tr_b16 v[48:49], v3 offset:96
    ds_read_b64_tr_b16 v[50:51], v3 offset:352
    v_mfma_f32_16x16x32_bf16 v[64:67], v[28:31], a[72:75], v[64:67]
    v_mfma_f32_16x16x32_bf16 v[68:71], v[24:27], a[68:71], v[68:71]
    ds_read_b64_tr_b16 v[52:53], v3 offset:1136
    ds_read_b64_tr_b16 v[54:55], v3 offset:1392
    v_mfma_f32_16x16x32_bf16 v[68:71], v[28:31], a[76:79], v[68:71]
    s_waitcnt lgkmcnt(8)
    v_mfma_f32_16x16x32_bf16 v[72:75], v[32:35], a[64:67], v[72:75]
    ds_read_b64_tr_b16 v[24:25], v3 offset:128
    ds_read_b64_tr_b16 v[26:27], v3 offset:384
    v_mfma_f32_16x16x32_bf16 v[72:75], v[36:39], a[72:75], v[72:75]
    v_mfma_f32_16x16x32_bf16 v[76:79], v[32:35], a[68:71], v[76:79]
    ds_read_b64_tr_b16 v[28:29], v3 offset:1168
    ds_read_b64_tr_b16 v[30:31], v3 offset:1424
    v_mfma_f32_16x16x32_bf16 v[76:79], v[36:39], a[76:79], v[76:79]
    s_waitcnt lgkmcnt(8)
    v_mfma_f32_16x16x32_bf16 v[80:83], v[40:43], a[64:67], v[80:83]
    ds_read_b64_tr_b16 v[32:33], v3 offset:160
    ds_read_b64_tr_b16 v[34:35], v3 offset:416
    v_mfma_f32_16x16x32_bf16 v[80:83], v[44:47], a[72:75], v[80:83]
    v_mfma_f32_16x16x32_bf16 v[84:87], v[40:43], a[68:71], v[84:87]
    ds_read_b64_tr_b16 v[36:37], v3 offset:1200
    ds_read_b64_tr_b16 v[38:39], v3 offset:1456
    v_mfma_f32_16x16x32_bf16 v[84:87], v[44:47], a[76:79], v[84:87]
    s_waitcnt lgkmcnt(8)
    v_mfma_f32_16x16x32_bf16 v[88:91], v[48:51], a[64:67], v[88:91]
    ds_read_b64_tr_b16 v[40:41], v3 offset:192
    ds_read_b64_tr_b16 v[42:43], v3 offset:448
    v_mfma_f32_16x16x32_bf16 v[88:91], v[52:55], a[72:75], v[88:91]
    s_waitcnt vmcnt(4)
    s_barrier
    v_mfma_f32_16x16x32_bf16 v[92:95], v[48:51], a[68:71], v[92:95]
    ds_read_b64_tr_b16 v[44:45], v3 offset:1232
    ds_read_b64_tr_b16 v[46:47], v3 offset:1488
    v_mfma_f32_16x16x32_bf16 v[92:95], v[52:55], a[76:79], v[92:95]
    s_waitcnt lgkmcnt(8)
    s_add_u32 m0, s29, 66560
    v_mfma_f32_16x16x32_bf16 v[96:99], v[24:27], a[64:67], v[96:99]
    ds_read_b64_tr_b16 v[48:49], v3 offset:224
    ds_read_b64_tr_b16 v[50:51], v3 offset:480
    v_mfma_f32_16x16x32_bf16 v[96:99], v[28:31], a[72:75], v[96:99]
    s_mov_b32 s36, 16448
    v_mfma_f32_16x16x32_bf16 v[100:103], v[24:27], a[68:71], v[100:103]
    ds_read_b64_tr_b16 v[52:53], v3 offset:1264
    ds_read_b64_tr_b16 v[54:55], v3 offset:1520
    v_mfma_f32_16x16x32_bf16 v[100:103], v[28:31], a[76:79], v[100:103]
    s_waitcnt lgkmcnt(8)
    v_add_u32 v3, 116480, v1
    v_mfma_f32_16x16x32_bf16 v[104:107], v[32:35], a[64:67], v[104:107]
    ds_read_b64_tr_b16 v[24:25], v3 offset:0
    ds_read_b64_tr_b16 v[26:27], v3 offset:256
    v_mfma_f32_16x16x32_bf16 v[104:107], v[36:39], a[72:75], v[104:107]
    buffer_load_dwordx4 v5, s[16:19], s36 offen offset:0 nt lds
    v_mfma_f32_16x16x32_bf16 v[108:111], v[32:35], a[68:71], v[108:111]
    ds_read_b64_tr_b16 v[28:29], v3 offset:1040
    ds_read_b64_tr_b16 v[30:31], v3 offset:1296
    v_mfma_f32_16x16x32_bf16 v[108:111], v[36:39], a[76:79], v[108:111]
    s_waitcnt lgkmcnt(8)
    s_mov_b32 s36, 16432
    v_mfma_f32_16x16x32_bf16 v[112:115], v[40:43], a[64:67], v[112:115]
    ds_read_b64_tr_b16 v[32:33], v3 offset:32
    ds_read_b64_tr_b16 v[34:35], v3 offset:288
    v_mfma_f32_16x16x32_bf16 v[112:115], v[44:47], a[72:75], v[112:115]
    v_mfma_f32_16x16x32_bf16 v[116:119], v[40:43], a[68:71], v[116:119]
    ds_read_b64_tr_b16 v[36:37], v3 offset:1072
    ds_read_b64_tr_b16 v[38:39], v3 offset:1328
    v_mfma_f32_16x16x32_bf16 v[116:119], v[44:47], a[76:79], v[116:119]
    s_waitcnt lgkmcnt(8)
    buffer_load_dwordx4 v5, s[16:19], s36 offen offset:1040 nt lds
    v_mfma_f32_16x16x32_bf16 v[120:123], v[48:51], a[64:67], v[120:123]
    ds_read_b64_tr_b16 v[40:41], v3 offset:64
    ds_read_b64_tr_b16 v[42:43], v3 offset:320
    v_mfma_f32_16x16x32_bf16 v[120:123], v[52:55], a[72:75], v[120:123]
    v_mfma_f32_16x16x32_bf16 v[124:127], v[48:51], a[68:71], v[124:127]
    ds_read_b64_tr_b16 v[44:45], v3 offset:1104
    ds_read_b64_tr_b16 v[46:47], v3 offset:1360
    v_mfma_f32_16x16x32_bf16 v[124:127], v[52:55], a[76:79], v[124:127]
    s_waitcnt lgkmcnt(8)
    s_mov_b32 s36, 16416
    v_mfma_f32_16x16x32_bf16 v[64:67], v[24:27], a[80:83], v[64:67]
    ds_read_b64_tr_b16 v[48:49], v3 offset:96
    ds_read_b64_tr_b16 v[50:51], v3 offset:352
    v_mfma_f32_16x16x32_bf16 v[64:67], v[28:31], a[88:91], v[64:67]
    buffer_load_dwordx4 v5, s[16:19], s36 offen offset:2080 nt lds
    v_mfma_f32_16x16x32_bf16 v[68:71], v[24:27], a[84:87], v[68:71]
    ds_read_b64_tr_b16 v[52:53], v3 offset:1136
    ds_read_b64_tr_b16 v[54:55], v3 offset:1392
    v_mfma_f32_16x16x32_bf16 v[68:71], v[28:31], a[92:95], v[68:71]
    s_waitcnt lgkmcnt(8)
    v_mfma_f32_16x16x32_bf16 v[72:75], v[32:35], a[80:83], v[72:75]
    ds_read_b64_tr_b16 v[24:25], v3 offset:128
    ds_read_b64_tr_b16 v[26:27], v3 offset:384
    v_mfma_f32_16x16x32_bf16 v[72:75], v[36:39], a[88:91], v[72:75]
    s_mov_b32 s36, 16400
    v_mfma_f32_16x16x32_bf16 v[76:79], v[32:35], a[84:87], v[76:79]
    ds_read_b64_tr_b16 v[28:29], v3 offset:1168
    ds_read_b64_tr_b16 v[30:31], v3 offset:1424
    v_mfma_f32_16x16x32_bf16 v[76:79], v[36:39], a[92:95], v[76:79]
    s_waitcnt lgkmcnt(8)
    buffer_load_dwordx4 v5, s[16:19], s36 offen offset:3120 nt lds
    v_mfma_f32_16x16x32_bf16 v[80:83], v[40:43], a[80:83], v[80:83]
    ds_read_b64_tr_b16 v[32:33], v3 offset:160
    ds_read_b64_tr_b16 v[34:35], v3 offset:416
    v_mfma_f32_16x16x32_bf16 v[80:83], v[44:47], a[88:91], v[80:83]
    v_mfma_f32_16x16x32_bf16 v[84:87], v[40:43], a[84:87], v[84:87]
    ds_read_b64_tr_b16 v[36:37], v3 offset:1200
    ds_read_b64_tr_b16 v[38:39], v3 offset:1456
    v_mfma_f32_16x16x32_bf16 v[84:87], v[44:47], a[92:95], v[84:87]
    s_waitcnt lgkmcnt(8)
    v_mfma_f32_16x16x32_bf16 v[88:91], v[48:51], a[80:83], v[88:91]
    ds_read_b64_tr_b16 v[40:41], v3 offset:192
    ds_read_b64_tr_b16 v[42:43], v3 offset:448
    v_mfma_f32_16x16x32_bf16 v[88:91], v[52:55], a[88:91], v[88:91]
    v_mfma_f32_16x16x32_bf16 v[92:95], v[48:51], a[84:87], v[92:95]
    ds_read_b64_tr_b16 v[44:45], v3 offset:1232
    ds_read_b64_tr_b16 v[46:47], v3 offset:1488
    v_mfma_f32_16x16x32_bf16 v[92:95], v[52:55], a[92:95], v[92:95]
    s_waitcnt lgkmcnt(8)
    v_mfma_f32_16x16x32_bf16 v[96:99], v[24:27], a[80:83], v[96:99]
    ds_read_b64_tr_b16 v[48:49], v3 offset:224
    ds_read_b64_tr_b16 v[50:51], v3 offset:480
    v_mfma_f32_16x16x32_bf16 v[96:99], v[28:31], a[88:91], v[96:99]
    v_mfma_f32_16x16x32_bf16 v[100:103], v[24:27], a[84:87], v[100:103]
    ds_read_b64_tr_b16 v[52:53], v3 offset:1264
    ds_read_b64_tr_b16 v[54:55], v3 offset:1520
    v_mfma_f32_16x16x32_bf16 v[100:103], v[28:31], a[92:95], v[100:103]
    s_waitcnt lgkmcnt(8)
    v_add_u32 v3, 133120, v1
    v_mfma_f32_16x16x32_bf16 v[104:107], v[32:35], a[80:83], v[104:107]
    ds_read_b64_tr_b16 v[24:25], v3 offset:0
    ds_read_b64_tr_b16 v[26:27], v3 offset:256
    v_mfma_f32_16x16x32_bf16 v[104:107], v[36:39], a[88:91], v[104:107]
    v_mfma_f32_16x16x32_bf16 v[108:111], v[32:35], a[84:87], v[108:111]
    ds_read_b64_tr_b16 v[28:29], v3 offset:1040
    ds_read_b64_tr_b16 v[30:31], v3 offset:1296
    v_mfma_f32_16x16x32_bf16 v[108:111], v[36:39], a[92:95], v[108:111]
    s_waitcnt lgkmcnt(8)
    v_mfma_f32_16x16x32_bf16 v[112:115], v[40:43], a[80:83], v[112:115]
    ds_read_b64_tr_b16 v[32:33], v3 offset:32
    ds_read_b64_tr_b16 v[34:35], v3 offset:288
    v_mfma_f32_16x16x32_bf16 v[112:115], v[44:47], a[88:91], v[112:115]
    v_mfma_f32_16x16x32_bf16 v[116:119], v[40:43], a[84:87], v[116:119]
    ds_read_b64_tr_b16 v[36:37], v3 offset:1072
    ds_read_b64_tr_b16 v[38:39], v3 offset:1328
    v_mfma_f32_16x16x32_bf16 v[116:119], v[44:47], a[92:95], v[116:119]
    s_waitcnt lgkmcnt(8)
    v_mfma_f32_16x16x32_bf16 v[120:123], v[48:51], a[80:83], v[120:123]
    ds_read_b64_tr_b16 v[40:41], v3 offset:64
    ds_read_b64_tr_b16 v[42:43], v3 offset:320
    v_mfma_f32_16x16x32_bf16 v[120:123], v[52:55], a[88:91], v[120:123]
    v_mfma_f32_16x16x32_bf16 v[124:127], v[48:51], a[84:87], v[124:127]
    ds_read_b64_tr_b16 v[44:45], v3 offset:1104
    ds_read_b64_tr_b16 v[46:47], v3 offset:1360
    v_mfma_f32_16x16x32_bf16 v[124:127], v[52:55], a[92:95], v[124:127]
    s_waitcnt lgkmcnt(8)
    v_mfma_f32_16x16x32_bf16 v[64:67], v[24:27], a[96:99], v[64:67]
    ds_read_b64_tr_b16 v[48:49], v3 offset:96
    ds_read_b64_tr_b16 v[50:51], v3 offset:352
    v_mfma_f32_16x16x32_bf16 v[64:67], v[28:31], a[104:107], v[64:67]
    v_mfma_f32_16x16x32_bf16 v[68:71], v[24:27], a[100:103], v[68:71]
    ds_read_b64_tr_b16 v[52:53], v3 offset:1136
    ds_read_b64_tr_b16 v[54:55], v3 offset:1392
    v_mfma_f32_16x16x32_bf16 v[68:71], v[28:31], a[108:111], v[68:71]
    s_waitcnt lgkmcnt(8)
    v_mfma_f32_16x16x32_bf16 v[72:75], v[32:35], a[96:99], v[72:75]
    ds_read_b64_tr_b16 v[24:25], v3 offset:128
    ds_read_b64_tr_b16 v[26:27], v3 offset:384
    v_mfma_f32_16x16x32_bf16 v[72:75], v[36:39], a[104:107], v[72:75]
    v_cvt_pk_bf16_f32 v224, v64, v65
    v_cvt_pk_bf16_f32 v225, v66, v67
    v_mfma_f32_16x16x32_bf16 v[76:79], v[32:35], a[100:103], v[76:79]
    ds_read_b64_tr_b16 v[28:29], v3 offset:1168
    ds_read_b64_tr_b16 v[30:31], v3 offset:1424
    v_mfma_f32_16x16x32_bf16 v[76:79], v[36:39], a[108:111], v[76:79]
    s_waitcnt lgkmcnt(8)
    v_cvt_pk_bf16_f32 v228, v68, v69
    v_cvt_pk_bf16_f32 v226, v72, v73
    v_mfma_f32_16x16x32_bf16 v[80:83], v[40:43], a[96:99], v[80:83]
    ds_read_b64_tr_b16 v[32:33], v3 offset:160
    ds_read_b64_tr_b16 v[34:35], v3 offset:416
    v_mfma_f32_16x16x32_bf16 v[80:83], v[44:47], a[104:107], v[80:83]
    v_cvt_pk_bf16_f32 v227, v74, v75
    v_cvt_pk_bf16_f32 v229, v70, v71
    v_mfma_f32_16x16x32_bf16 v[84:87], v[40:43], a[100:103], v[84:87]
    ds_read_b64_tr_b16 v[36:37], v3 offset:1200
    ds_read_b64_tr_b16 v[38:39], v3 offset:1456
    v_mfma_f32_16x16x32_bf16 v[84:87], v[44:47], a[108:111], v[84:87]
    s_waitcnt lgkmcnt(8)
    v_cvt_pk_bf16_f32 v230, v76, v77
    v_cvt_pk_bf16_f32 v231, v78, v79
    v_mfma_f32_16x16x32_bf16 v[88:91], v[48:51], a[96:99], v[88:91]
    ds_read_b64_tr_b16 v[40:41], v3 offset:192
    ds_read_b64_tr_b16 v[42:43], v3 offset:448
    v_mfma_f32_16x16x32_bf16 v[88:91], v[52:55], a[104:107], v[88:91]
    s_waitcnt vmcnt(29)
    s_barrier
    v_cvt_pk_bf16_f32 v232, v80, v81
    v_mfma_f32_16x16x32_bf16 v[92:95], v[48:51], a[100:103], v[92:95]
    ds_read_b64_tr_b16 v[44:45], v3 offset:1232
    ds_read_b64_tr_b16 v[46:47], v3 offset:1488
    v_mfma_f32_16x16x32_bf16 v[92:95], v[52:55], a[108:111], v[92:95]
    s_waitcnt lgkmcnt(8)
    s_add_u32 m0, s29, 83200
    v_cvt_pk_bf16_f32 v233, v82, v83
    v_mfma_f32_16x16x32_bf16 v[96:99], v[24:27], a[96:99], v[96:99]
    ds_read_b64_tr_b16 v[48:49], v3 offset:224
    ds_read_b64_tr_b16 v[50:51], v3 offset:480
    v_mfma_f32_16x16x32_bf16 v[96:99], v[28:31], a[104:107], v[96:99]
    s_mov_b32 s36, 49216
    v_cvt_pk_bf16_f32 v234, v88, v89
    v_cvt_pk_bf16_f32 v235, v90, v91
    v_mfma_f32_16x16x32_bf16 v[100:103], v[24:27], a[100:103], v[100:103]
    ds_read_b64_tr_b16 v[52:53], v3 offset:1264
    ds_read_b64_tr_b16 v[54:55], v3 offset:1520
    v_mfma_f32_16x16x32_bf16 v[100:103], v[28:31], a[108:111], v[100:103]
    s_waitcnt lgkmcnt(8)
    v_cvt_pk_bf16_f32 v236, v84, v85
    v_cvt_pk_bf16_f32 v237, v86, v87
    v_mfma_f32_16x16x32_bf16 v[104:107], v[32:35], a[96:99], v[104:107]
    v_add_u32 v2, 0, v0
    v_cvt_pk_bf16_f32 v238, v92, v93
    v_mfma_f32_16x16x32_bf16 v[104:107], v[36:39], a[104:107], v[104:107]
    buffer_load_dwordx4 v4, s[12:15], s36 offen offset:0 nt lds
    v_mfma_f32_16x16x32_bf16 v[108:111], v[32:35], a[100:103], v[108:111]
    v_cvt_pk_bf16_f32 v239, v94, v95
    v_cvt_pk_bf16_f32 v240, v96, v97
    v_mfma_f32_16x16x32_bf16 v[108:111], v[36:39], a[108:111], v[108:111]
    s_waitcnt lgkmcnt(4)
    s_mov_b32 s36, 49200
    v_cvt_pk_bf16_f32 v241, v98, v99
    v_mfma_f32_16x16x32_bf16 v[112:115], v[40:43], a[96:99], v[112:115]
    ds_read_b128 v[24:27], v2 offset:0
    v_cvt_pk_bf16_f32 v242, v104, v105
    v_mfma_f32_16x16x32_bf16 v[112:115], v[44:47], a[104:107], v[112:115]
    v_cvt_pk_bf16_f32 v243, v106, v107
    v_cvt_pk_bf16_f32 v244, v100, v101
    v_mfma_f32_16x16x32_bf16 v[116:119], v[40:43], a[100:103], v[116:119]
    ds_read_b128 v[28:31], v2 offset:64
    v_cvt_pk_bf16_f32 v245, v102, v103
    v_mfma_f32_16x16x32_bf16 v[116:119], v[44:47], a[108:111], v[116:119]
    s_waitcnt lgkmcnt(2)
    buffer_load_dwordx4 v4, s[12:15], s36 offen offset:1040 nt lds
    v_mfma_f32_16x16x32_bf16 v[120:123], v[48:51], a[96:99], v[120:123]
    ds_read_b128 v[32:35], v2 offset:128
    v_cvt_pk_bf16_f32 v246, v108, v109
    v_mfma_f32_16x16x32_bf16 v[120:123], v[52:55], a[104:107], v[120:123]
    v_cvt_pk_bf16_f32 v247, v110, v111
    v_cvt_pk_bf16_f32 v248, v112, v113
    v_mfma_f32_16x16x32_bf16 v[124:127], v[48:51], a[100:103], v[124:127]
    ds_read_b128 v[36:39], v2 offset:192
    v_cvt_pk_bf16_f32 v249, v114, v115
    v_mfma_f32_16x16x32_bf16 v[124:127], v[52:55], a[108:111], v[124:127]
    s_mov_b32 s36, 49184
    v_cvt_pk_bf16_f32 v252, v116, v117
    v_cvt_pk_bf16_f32 v250, v120, v121
    buffer_load_dwordx4 v4, s[12:15], s36 offen offset:2080 nt lds
    s_mov_b32 s36, 49168
    buffer_load_dwordx4 v4, s[12:15], s36 offen offset:3120 nt lds
    s_waitcnt lgkmcnt(0)
    v_mfma_f32_16x16x32_bf16 v[80:83], v[24:27], v[128:131], 0
    ds_read_b128 v[40:43], v2 offset:256
    v_cvt_pk_bf16_f32 v251, v122, v123
    v_mfma_f32_16x16x32_bf16 v[80:83], v[28:31], v[136:139], v[80:83]
    v_cvt_pk_bf16_f32 v253, v118, v119
    v_cvt_pk_bf16_f32 v254, v124, v125
    v_mfma_f32_16x16x32_bf16 v[80:83], v[32:35], v[144:147], v[80:83]
    ds_read_b128 v[44:47], v2 offset:320
    v_cvt_pk_bf16_f32 v255, v126, v127
    v_mfma_f32_16x16x32_bf16 v[80:83], v[36:39], v[152:155], v[80:83]
    v_permlane32_swap_b32 v224, v226
    v_permlane32_swap_b32 v225, v227
    v_mfma_f32_16x16x32_bf16 v[88:91], v[24:27], v[132:135], 0
    ds_read_b128 v[48:51], v2 offset:384
    v_permlane16_swap_b32 v224, v226
    v_mfma_f32_16x16x32_bf16 v[88:91], v[28:31], v[140:143], v[88:91]
    v_permlane16_swap_b32 v225, v227
    v_permlane32_swap_b32 v228, v230
    v_mfma_f32_16x16x32_bf16 v[88:91], v[32:35], v[148:151], v[88:91]
    ds_read_b128 v[52:55], v2 offset:448
    v_permlane32_swap_b32 v229, v231
    v_mfma_f32_16x16x32_bf16 v[88:91], v[36:39], v[156:159], v[88:91]
    v_permlane16_swap_b32 v228, v230
    v_permlane16_swap_b32 v229, v231
    v_mfma_f32_16x16x32_bf16 v[96:99], v[24:27], v[192:195], 0
    v_permlane32_swap_b32 v232, v234
    v_permlane32_swap_b32 v233, v235
    v_mfma_f32_16x16x32_bf16 v[96:99], v[28:31], v[200:203], v[96:99]
    s_waitcnt vmcnt(16)
    s_barrier
    v_permlane16_swap_b32 v232, v234
    v_mfma_f32_16x16x32_bf16 v[96:99], v[32:35], v[208:211], v[96:99]
    v_permlane16_swap_b32 v233, v235
    v_permlane32_swap_b32 v236, v238
    v_mfma_f32_16x16x32_bf16 v[96:99], v[36:39], v[216:219], v[96:99]
    v_permlane32_swap_b32 v237, v239
    v_permlane16_swap_b32 v236, v238
    v_mfma_f32_16x16x32_bf16 v[104:107], v[24:27], v[196:199], 0
    v_permlane16_swap_b32 v237, v239
    v_permlane32_swap_b32 v240, v242
    v_mfma_f32_16x16x32_bf16 v[104:107], v[28:31], v[204:207], v[104:107]
    v_permlane32_swap_b32 v241, v243
    v_permlane16_swap_b32 v240, v242
    v_mfma_f32_16x16x32_bf16 v[104:107], v[32:35], v[212:215], v[104:107]
    v_permlane16_swap_b32 v241, v243
    v_permlane32_swap_b32 v244, v246
    v_mfma_f32_16x16x32_bf16 v[104:107], v[36:39], v[220:223], v[104:107]
    s_waitcnt lgkmcnt(0)
    v_permlane32_swap_b32 v245, v247
    v_permlane16_swap_b32 v244, v246
    v_mfma_f32_16x16x32_bf16 v[80:83], v[40:43], v[160:163], v[80:83]
    ds_read_b128 v[24:27], v2 offset:1040
    v_permlane16_swap_b32 v245, v247
    v_mfma_f32_16x16x32_bf16 v[80:83], v[44:47], v[168:171], v[80:83]
    v_permlane32_swap_b32 v248, v250
    v_permlane32_swap_b32 v249, v251
    v_mfma_f32_16x16x32_bf16 v[80:83], v[48:51], v[176:179], v[80:83]
    ds_read_b128 v[28:31], v2 offset:1104
    v_permlane16_swap_b32 v248, v250
    v_mfma_f32_16x16x32_bf16 v[80:83], v[52:55], v[184:187], v[80:83]
    v_permlane16_swap_b32 v249, v251
    v_permlane32_swap_b32 v252, v254
    v_mfma_f32_16x16x32_bf16 v[88:91], v[40:43], v[164:167], v[88:91]
    ds_read_b128 v[32:35], v2 offset:1168
    v_permlane32_swap_b32 v253, v255
    v_mfma_f32_16x16x32_bf16 v[88:91], v[44:47], v[172:175], v[88:91]
    v_permlane16_swap_b32 v252, v254
    v_permlane16_swap_b32 v253, v255
    v_mfma_f32_16x16x32_bf16 v[88:91], v[48:51], v[180:183], v[88:91]
    ds_read_b128 v[36:39], v2 offset:1232
    v_mfma_f32_16x16x32_bf16 v[88:91], v[52:55], v[188:191], v[88:91]
    v_mfma_f32_16x16x32_bf16 v[96:99], v[40:43], v[224:227], v[96:99]
    s_add_u32 m0, s29, 99840
    v_mfma_f32_16x16x32_bf16 v[96:99], v[44:47], v[232:235], v[96:99]
    v_mfma_f32_16x16x32_bf16 v[96:99], v[48:51], v[240:243], v[96:99]
    v_mfma_f32_16x16x32_bf16 v[96:99], v[52:55], v[248:251], v[96:99]
    v_mfma_f32_16x16x32_bf16 v[104:107], v[40:43], v[228:231], v[104:107]
    s_mov_b32 s36, 32832
    v_mfma_f32_16x16x32_bf16 v[104:107], v[44:47], v[236:239], v[104:107]
    v_mfma_f32_16x16x32_bf16 v[104:107], v[48:51], v[244:247], v[104:107]
    v_mfma_f32_16x16x32_bf16 v[104:107], v[52:55], v[252:255], v[104:107]
    s_waitcnt lgkmcnt(0)
    v_mfma_f32_16x16x32_bf16 v[84:87], v[24:27], v[128:131], 0
    ds_read_b128 v[40:43], v2 offset:1296
    v_mfma_f32_16x16x32_bf16 v[84:87], v[28:31], v[136:139], v[84:87]
    buffer_load_dwordx4 v5, s[16:19], s36 offen offset:0 nt lds
    v_mfma_f32_16x16x32_bf16 v[84:87], v[32:35], v[144:147], v[84:87]
    ds_read_b128 v[44:47], v2 offset:1360
    v_mfma_f32_16x16x32_bf16 v[84:87], v[36:39], v[152:155], v[84:87]
    v_mfma_f32_16x16x32_bf16 v[92:95], v[24:27], v[132:135], 0
    ds_read_b128 v[48:51], v2 offset:1424
    v_mfma_f32_16x16x32_bf16 v[92:95], v[28:31], v[140:143], v[92:95]
    s_mov_b32 s36, 32816
    v_mfma_f32_16x16x32_bf16 v[92:95], v[32:35], v[148:151], v[92:95]
    ds_read_b128 v[52:55], v2 offset:1488
    v_mfma_f32_16x16x32_bf16 v[92:95], v[36:39], v[156:159], v[92:95]
    v_mfma_f32_16x16x32_bf16 v[100:103], v[24:27], v[192:195], 0
    buffer_load_dwordx4 v5, s[16:19], s36 offen offset:1040 nt lds
    v_mfma_f32_16x16x32_bf16 v[100:103], v[28:31], v[200:203], v[100:103]
    v_mfma_f32_16x16x32_bf16 v[100:103], v[32:35], v[208:211], v[100:103]
    v_mfma_f32_16x16x32_bf16 v[100:103], v[36:39], v[216:219], v[100:103]
    v_mfma_f32_16x16x32_bf16 v[108:111], v[24:27], v[196:199], 0
    s_mov_b32 s36, 32800
    v_mfma_f32_16x16x32_bf16 v[108:111], v[28:31], v[204:207], v[108:111]
    v_add_u32 v2, 16640, v0
    v_mfma_f32_16x16x32_bf16 v[108:111], v[32:35], v[212:215], v[108:111]
    v_mfma_f32_16x16x32_bf16 v[108:111], v[36:39], v[220:223], v[108:111]
    s_waitcnt lgkmcnt(0)
    v_mfma_f32_16x16x32_bf16 v[84:87], v[40:43], v[160:163], v[84:87]
    ds_read_b128 v[24:27], v2 offset:0
    v_mfma_f32_16x16x32_bf16 v[84:87], v[44:47], v[168:171], v[84:87]
    buffer_load_dwordx4 v5, s[16:19], s36 offen offset:2080 nt lds
    v_mfma_f32_16x16x32_bf16 v[84:87], v[48:51], v[176:179], v[84:87]
    ds_read_b128 v[28:31], v2 offset:64
    v_mfma_f32_16x16x32_bf16 v[84:87], v[52:55], v[184:187], v[84:87]
    v_mfma_f32_16x16x32_bf16 v[92:95], v[40:43], v[164:167], v[92:95]
    ds_read_b128 v[32:35], v2 offset:128
    v_mfma_f32_16x16x32_bf16 v[92:95], v[44:47], v[172:175], v[92:95]
    s_mov_b32 s36, 32784
    v_mfma_f32_16x16x32_bf16 v[92:95], v[48:51], v[180:183], v[92:95]
    ds_read_b128 v[36:39], v2 offset:192
    v_mfma_f32_16x16x32_bf16 v[92:95], v[52:55], v[188:191], v[92:95]
    v_mfma_f32_16x16x32_bf16 v[100:103], v[40:43], v[224:227], v[100:103]
    buffer_load_dwordx4 v5, s[16:19], s36 offen offset:3120 nt lds
    v_mfma_f32_16x16x32_bf16 v[100:103], v[44:47], v[232:235], v[100:103]
    v_mfma_f32_16x16x32_bf16 v[100:103], v[48:51], v[240:243], v[100:103]
    v_mfma_f32_16x16x32_bf16 v[100:103], v[52:55], v[248:251], v[100:103]
    v_mfma_f32_16x16x32_bf16 v[108:111], v[40:43], v[228:231], v[108:111]
    v_mfma_f32_16x16x32_bf16 v[108:111], v[44:47], v[236:239], v[108:111]
    v_mfma_f32_16x16x32_bf16 v[108:111], v[48:51], v[244:247], v[108:111]
    v_mfma_f32_16x16x32_bf16 v[108:111], v[52:55], v[252:255], v[108:111]
    s_waitcnt lgkmcnt(0)
    v_max3_f32 v14, v80, v81, v82
    v_max3_f32 v14, v14, v83, v84
    v_max3_f32 v14, v14, v85, v86
    v_max_f32 v14, v14, v87
    v_max3_f32 v15, v88, v89, v90
    v_max3_f32 v15, v15, v91, v92
    v_max3_f32 v15, v15, v93, v94
    v_max_f32 v15, v15, v95
    v_mov_b32 v16, v14
    v_mov_b32 v17, v15
    s_nop 0
    v_permlane32_swap_b32 v14, v16
    v_permlane32_swap_b32 v15, v17
    v_max_f32 v14, v14, v16
    v_max_f32 v15, v15, v17
    v_mov_b32 v16, v14
    v_mov_b32 v17, v15
    s_nop 0
    v_permlane16_swap_b32 v14, v16
    v_permlane16_swap_b32 v15, v17
    v_max_f32 v14, v14, v16
    v_max_f32 v15, v15, v17
    v_mul_f32 v6, s42, v14
    v_mul_f32 v7, s42, v15
    v_fma_f32 v80, v80, s42, -v6
    v_fma_f32 v81, v81, s42, -v6
    v_exp_f32 v14, v80
    v_exp_f32 v15, v81
    s_nop 0
    v_add_f32 v10, v14, v15
    v_cvt_pk_bf16_f32 v56, v14, v15
    v_fma_f32 v88, v88, s42, -v7
    v_fma_f32 v89, v89, s42, -v7
    v_exp_f32 v16, v88
    v_exp_f32 v17, v89
    s_nop 0
    v_add_f32 v11, v16, v17
    v_cvt_pk_bf16_f32 v60, v16, v17
    v_fma_f32 v82, v82, s42, -v6
    v_fma_f32 v83, v83, s42, -v6
    v_exp_f32 v18, v82
    v_exp_f32 v19, v83
    v_add_f32 v10, v10, v18
    v_add_f32 v10, v10, v19
    v_cvt_pk_bf16_f32 v57, v18, v19
    v_fma_f32 v90, v90, s42, -v7
    v_fma_f32 v91, v91, s42, -v7
    v_exp_f32 v20, v90
    v_exp_f32 v21, v91
    v_add_f32 v11, v11, v20
    v_add_f32 v11, v11, v21
    v_cvt_pk_bf16_f32 v61, v20, v21
    v_fma_f32 v84, v84, s42, -v6
    v_fma_f32 v85, v85, s42, -v6
    v_exp_f32 v14, v84
    v_exp_f32 v15, v85
    v_add_f32 v10, v10, v14
    v_add_f32 v10, v10, v15
    v_cvt_pk_bf16_f32 v58, v14, v15
    v_fma_f32 v92, v92, s42, -v7
    v_fma_f32 v93, v93, s42, -v7
    v_exp_f32 v16, v92
    v_exp_f32 v17, v93
    v_add_f32 v11, v11, v16
    v_add_f32 v11, v11, v17
    v_cvt_pk_bf16_f32 v62, v16, v17
    v_fma_f32 v86, v86, s42, -v6
    v_fma_f32 v87, v87, s42, -v6
    v_exp_f32 v18, v86
    v_exp_f32 v19, v87
    v_add_f32 v10, v10, v18
    v_add_f32 v10, v10, v19
    v_cvt_pk_bf16_f32 v59, v18, v19
    v_fma_f32 v94, v94, s42, -v7
    v_fma_f32 v95, v95, s42, -v7
    v_exp_f32 v20, v94
    v_exp_f32 v21, v95
    v_add_f32 v11, v11, v20
    v_add_f32 v11, v11, v21
    v_cvt_pk_bf16_f32 v63, v20, v21
    v_mfma_f32_16x16x32_bf16 v[80:83], v[24:27], v[128:131], 0
    ds_read_b128 v[40:43], v2 offset:256
    v_max3_f32 v14, v96, v97, v98
    v_mfma_f32_16x16x32_bf16 v[80:83], v[28:31], v[136:139], v[80:83]
    v_max3_f32 v14, v14, v99, v100
    v_max3_f32 v14, v14, v101, v102
    v_mfma_f32_16x16x32_bf16 v[80:83], v[32:35], v[144:147], v[80:83]
    ds_read_b128 v[44:47], v2 offset:320
    v_max_f32 v14, v14, v103
    v_mfma_f32_16x16x32_bf16 v[80:83], v[36:39], v[152:155], v[80:83]
    v_max3_f32 v15, v104, v105, v106
    v_max3_f32 v15, v15, v107, v108
    v_mfma_f32_16x16x32_bf16 v[88:91], v[24:27], v[132:135], 0
    ds_read_b128 v[48:51], v2 offset:384
    v_max3_f32 v15, v15, v109, v110
    v_mfma_f32_16x16x32_bf16 v[88:91], v[28:31], v[140:143], v[88:91]
    v_max_f32 v15, v15, v111
    v_mov_b32 v16, v14
    v_mfma_f32_16x16x32_bf16 v[88:91], v[32:35], v[148:151], v[88:91]
    ds_read_b128 v[52:55], v2 offset:448
    v_mov_b32 v17, v15
    v_mfma_f32_16x16x32_bf16 v[88:91], v[36:39], v[156:159], v[88:91]
    v_permlane32_swap_b32 v14, v16
    v_permlane32_swap_b32 v15, v17
    v_mfma_f32_16x16x32_bf16 v[112:115], v[24:27], v[192:195], 0
    v_max_f32 v14, v14, v16
    v_max_f32 v15, v15, v17
    v_mfma_f32_16x16x32_bf16 v[112:115], v[28:31], v[200:203], v[112:115]
    s_add_u32 m0, s29, 116480
    v_mov_b32 v16, v14
    v_mov_b32 v17, v15
    v_mfma_f32_16x16x32_bf16 v[112:115], v[32:35], v[208:211], v[112:115]
    v_permlane16_swap_b32 v14, v16
    v_permlane16_swap_b32 v15, v17
    v_mfma_f32_16x16x32_bf16 v[112:115], v[36:39], v[216:219], v[112:115]
    s_mov_b32 s36, 65600
    v_max_f32 v14, v14, v16
    v_max_f32 v15, v15, v17
    v_mfma_f32_16x16x32_bf16 v[120:123], v[24:27], v[196:199], 0
    v_mul_f32 v8, s42, v14
    v_mul_f32 v9, s42, v15
    v_mfma_f32_16x16x32_bf16 v[120:123], v[28:31], v[204:207], v[120:123]
    buffer_load_dwordx4 v4, s[12:15], s36 offen offset:0 nt lds
    v_mfma_f32_16x16x32_bf16 v[120:123], v[32:35], v[212:215], v[120:123]
    v_fma_f32 v96, v96, s42, -v8
    v_fma_f32 v97, v97, s42, -v8
    v_mfma_f32_16x16x32_bf16 v[120:123], v[36:39], v[220:223], v[120:123]
    s_waitcnt lgkmcnt(0)
    v_exp_f32 v14, v96
    v_mfma_f32_16x16x32_bf16 v[80:83], v[40:43], v[160:163], v[80:83]
    ds_read_b128 v[24:27], v2 offset:1040
    v_fma_f32 v104, v104, s42, -v9
    v_mfma_f32_16x16x32_bf16 v[80:83], v[44:47], v[168:171], v[80:83]
    s_mov_b32 s36, 65584
    v_exp_f32 v15, v97
    v_mfma_f32_16x16x32_bf16 v[80:83], v[48:51], v[176:179], v[80:83]
    ds_read_b128 v[28:31], v2 offset:1104
    v_add_f32 v12, v14, v15
    v_mfma_f32_16x16x32_bf16 v[80:83], v[52:55], v[184:187], v[80:83]
    buffer_load_dwordx4 v4, s[12:15], s36 offen offset:1040 nt lds
    v_mfma_f32_16x16x32_bf16 v[88:91], v[40:43], v[164:167], v[88:91]
    ds_read_b128 v[32:35], v2 offset:1168
    v_cvt_pk_bf16_f32 v72, v14, v15
    v_mfma_f32_16x16x32_bf16 v[88:91], v[44:47], v[172:175], v[88:91]
    s_mov_b32 s36, 65568
    v_exp_f32 v16, v104
    v_mfma_f32_16x16x32_bf16 v[88:91], v[48:51], v[180:183], v[88:91]
    ds_read_b128 v[36:39], v2 offset:1232
    v_fma_f32 v105, v105, s42, -v9
    v_mfma_f32_16x16x32_bf16 v[88:91], v[52:55], v[188:191], v[88:91]
    buffer_load_dwordx4 v4, s[12:15], s36 offen offset:2080 nt lds
    v_mfma_f32_16x16x32_bf16 v[112:115], v[40:43], v[224:227], v[112:115]
    v_exp_f32 v17, v105
    v_mfma_f32_16x16x32_bf16 v[112:115], v[44:47], v[232:235], v[112:115]
    v_add_f32 v13, v16, v17
    v_cvt_pk_bf16_f32 v76, v16, v17
    v_mfma_f32_16x16x32_bf16 v[112:115], v[48:51], v[240:243], v[112:115]
    s_mov_b32 s36, 65552
    v_fma_f32 v98, v98, s42, -v8
    v_fma_f32 v99, v99, s42, -v8
    v_mfma_f32_16x16x32_bf16 v[112:115], v[52:55], v[248:251], v[112:115]
    v_exp_f32 v18, v98
    v_mfma_f32_16x16x32_bf16 v[120:123], v[40:43], v[228:231], v[120:123]
    buffer_load_dwordx4 v4, s[12:15], s36 offen offset:3120 nt lds
    v_mfma_f32_16x16x32_bf16 v[120:123], v[44:47], v[236:239], v[120:123]
    v_exp_f32 v19, v99
    v_mfma_f32_16x16x32_bf16 v[120:123], v[48:51], v[244:247], v[120:123]
    v_add_f32 v12, v12, v18
    v_add_f32 v12, v12, v19
    v_mfma_f32_16x16x32_bf16 v[120:123], v[52:55], v[252:255], v[120:123]
    s_waitcnt lgkmcnt(0)
    v_cvt_pk_bf16_f32 v73, v18, v19
    v_fma_f32 v106, v106, s42, -v9
    v_mfma_f32_16x16x32_bf16 v[84:87], v[24:27], v[128:131], 0
    ds_read_b128 v[40:43], v2 offset:1296
    v_fma_f32 v107, v107, s42, -v9
    v_mfma_f32_16x16x32_bf16 v[84:87], v[28:31], v[136:139], v[84:87]
    s_add_u32 s44, s3, 1
    v_exp_f32 v20, v106
    v_mfma_f32_16x16x32_bf16 v[84:87], v[32:35], v[144:147], v[84:87]
    ds_read_b128 v[44:47], v2 offset:1360
    v_add_f32 v13, v13, v20
    v_mfma_f32_16x16x32_bf16 v[84:87], v[36:39], v[152:155], v[84:87]
    s_cmp_ge_u32 s44, 7
    v_exp_f32 v21, v107
    v_mfma_f32_16x16x32_bf16 v[92:95], v[24:27], v[132:135], 0
    ds_read_b128 v[48:51], v2 offset:1424
    v_add_f32 v13, v13, v21
    v_mfma_f32_16x16x32_bf16 v[92:95], v[28:31], v[140:143], v[92:95]
    s_cselect_b32 s62, 7, 0
    v_cvt_pk_bf16_f32 v77, v20, v21
    v_fma_f32 v100, v100, s42, -v8
    v_mfma_f32_16x16x32_bf16 v[92:95], v[32:35], v[148:151], v[92:95]
    ds_read_b128 v[52:55], v2 offset:1488
    v_fma_f32 v101, v101, s42, -v8
    v_mfma_f32_16x16x32_bf16 v[92:95], v[36:39], v[156:159], v[92:95]
    s_sub_u32 s44, s44, s62
    v_exp_f32 v14, v100
    v_mfma_f32_16x16x32_bf16 v[116:119], v[24:27], v[192:195], 0
    s_lshl_b32 s62, s44, 19
    v_exp_f32 v15, v101
    v_mfma_f32_16x16x32_bf16 v[116:119], v[28:31], v[200:203], v[116:119]
    s_add_u32 s63, s62, 524288
    v_add_f32 v12, v12, v14
    v_add_f32 v12, v12, v15
    v_mfma_f32_16x16x32_bf16 v[116:119], v[32:35], v[208:211], v[116:119]
    s_cmp_eq_u32 s63, 3670016
    v_cvt_pk_bf16_f32 v74, v14, v15
    v_fma_f32 v108, v108, s42, -v9
    v_mfma_f32_16x16x32_bf16 v[116:119], v[36:39], v[216:219], v[116:119]
    s_cselect_b32 s63, 0, s63
    v_exp_f32 v16, v108
    v_mfma_f32_16x16x32_bf16 v[124:127], v[24:27], v[196:199], 0
    s_add_u32 s82, s63, 524288
    v_fma_f32 v109, v109, s42, -v9
    v_add_f32 v13, v13, v16
    v_mfma_f32_16x16x32_bf16 v[124:127], v[28:31], v[204:207], v[124:127]
    s_cmp_eq_u32 s82, 3670016
    v_add_u32 v3, 33280, v1
    v_fma_f32 v102, v102, s42, -v8
    v_mfma_f32_16x16x32_bf16 v[124:127], v[32:35], v[212:215], v[124:127]
    s_cselect_b32 s82, 0, s82
    v_exp_f32 v17, v109
    v_mfma_f32_16x16x32_bf16 v[124:127], v[36:39], v[220:223], v[124:127]
    s_waitcnt lgkmcnt(0)
    v_exp_f32 v18, v102
    v_mfma_f32_16x16x32_bf16 v[84:87], v[40:43], v[160:163], v[84:87]
    ds_read_b64_tr_b16 v[24:25], v3 offset:0
    v_add_f32 v13, v13, v17
    v_mfma_f32_16x16x32_bf16 v[84:87], v[44:47], v[168:171], v[84:87]
    ds_read_b64_tr_b16 v[26:27], v3 offset:1040
    v_cvt_pk_bf16_f32 v78, v16, v17
    v_mfma_f32_16x16x32_bf16 v[84:87], v[48:51], v[176:179], v[84:87]
    ds_read_b64_tr_b16 v[28:29], v3 offset:32
    v_fma_f32 v103, v103, s42, -v8
    v_mfma_f32_16x16x32_bf16 v[84:87], v[52:55], v[184:187], v[84:87]
    ds_read_b64_tr_b16 v[30:31], v3 offset:1072
    v_add_f32 v12, v12, v18
    v_mfma_f32_16x16x32_bf16 v[92:95], v[40:43], v[164:167], v[92:95]
    ds_read_b64_tr_b16 v[32:33], v3 offset:64
    v_fma_f32 v110, v110, s42, -v9
    v_mfma_f32_16x16x32_bf16 v[92:95], v[44:47], v[172:175], v[92:95]
    ds_read_b64_tr_b16 v[34:35], v3 offset:1104
    v_fma_f32 v111, v111, s42, -v9
    v_mfma_f32_16x16x32_bf16 v[92:95], v[48:51], v[180:183], v[92:95]
    ds_read_b64_tr_b16 v[36:37], v3 offset:96
    v_mfma_f32_16x16x32_bf16 v[92:95], v[52:55], v[188:191], v[92:95]
    ds_read_b64_tr_b16 v[38:39], v3 offset:1136
    v_mfma_f32_16x16x32_bf16 v[116:119], v[40:43], v[224:227], v[116:119]
    s_add_u32 s83, s82, 524288
    v_exp_f32 v19, v103
    v_mfma_f32_16x16x32_bf16 v[116:119], v[44:47], v[232:235], v[116:119]
    s_cmp_eq_u32 s83, 3670016
    v_exp_f32 v20, v110
    v_mfma_f32_16x16x32_bf16 v[116:119], v[48:51], v[240:243], v[116:119]
    s_cselect_b32 s83, 0, s83
    v_exp_f32 v21, v111
    v_mfma_f32_16x16x32_bf16 v[116:119], v[52:55], v[248:251], v[116:119]
    s_add_u32 s80, s83, 524288
    v_add_f32 v12, v12, v19
    v_cvt_pk_bf16_f32 v75, v18, v19
    v_mfma_f32_16x16x32_bf16 v[124:127], v[40:43], v[228:231], v[124:127]
    s_cmp_eq_u32 s80, 3670016
    v_add_f32 v13, v13, v20
    v_add_f32 v13, v13, v21
    v_mfma_f32_16x16x32_bf16 v[124:127], v[44:47], v[236:239], v[124:127]
    s_cselect_b32 s80, 0, s80
    v_cvt_pk_bf16_f32 v79, v20, v21
    v_mfma_f32_16x16x32_bf16 v[124:127], v[48:51], v[244:247], v[124:127]
    v_mfma_f32_16x16x32_bf16 v[124:127], v[52:55], v[252:255], v[124:127]
    s_waitcnt lgkmcnt(0)
    v_mfma_f32_16x16x32_bf16 a[0:3], v[24:27], v[56:59], 0
    ds_read_b64_tr_b16 v[40:41], v3 offset:128
    v_fma_f32 v80, v80, s42, -v6
    v_mfma_f32_16x16x32_bf16 a[64:67], v[24:27], v[60:63], 0
    ds_read_b64_tr_b16 v[42:43], v3 offset:1168
    v_fma_f32 v81, v81, s42, -v6
    v_mfma_f32_16x16x32_bf16 a[128:131], v[24:27], v[72:75], 0
    ds_read_b64_tr_b16 v[44:45], v3 offset:160
    v_fma_f32 v88, v88, s42, -v7
    v_mfma_f32_16x16x32_bf16 a[192:195], v[24:27], v[76:79], 0
    ds_read_b64_tr_b16 v[46:47], v3 offset:1200
    v_fma_f32 v89, v89, s42, -v7
    v_mfma_f32_16x16x32_bf16 a[4:7], v[28:31], v[56:59], 0
    ds_read_b64_tr_b16 v[48:49], v3 offset:192
    v_fma_f32 v82, v82, s42, -v6
    v_mfma_f32_16x16x32_bf16 a[68:71], v[28:31], v[60:63], 0
    ds_read_b64_tr_b16 v[50:51], v3 offset:1232
    v_fma_f32 v83, v83, s42, -v6
    v_mfma_f32_16x16x32_bf16 a[132:135], v[28:31], v[72:75], 0
    ds_read_b64_tr_b16 v[52:53], v3 offset:224
    v_mfma_f32_16x16x32_bf16 a[196:199], v[28:31], v[76:79], 0
    ds_read_b64_tr_b16 v[54:55], v3 offset:1264
    v_mfma_f32_16x16x32_bf16 a[8:11], v[32:35], v[56:59], 0
    v_exp_f32 v14, v80
    v_mfma_f32_16x16x32_bf16 a[72:75], v[32:35], v[60:63], 0
    v_exp_f32 v15, v81
    v_mfma_f32_16x16x32_bf16 a[136:139], v[32:35], v[72:75], 0
    v_exp_f32 v16, v88
    v_mfma_f32_16x16x32_bf16 a[200:203], v[32:35], v[76:79], 0
    s_add_u32 m0, s29, 133120
    v_exp_f32 v17, v89
    v_mfma_f32_16x16x32_bf16 a[12:15], v[36:39], v[56:59], 0
    v_exp_f32 v18, v82
    v_mfma_f32_16x16x32_bf16 a[76:79], v[36:39], v[60:63], 0
    v_exp_f32 v19, v83
    v_mfma_f32_16x16x32_bf16 a[140:143], v[36:39], v[72:75], 0
    v_add_f32 v10, v10, v14
    v_add_f32 v10, v10, v15
    v_mfma_f32_16x16x32_bf16 a[204:207], v[36:39], v[76:79], 0
    s_waitcnt lgkmcnt(0)
    v_cvt_pk_bf16_f32 v64, v14, v15
    v_add_f32 v11, v11, v16
    v_mfma_f32_16x16x32_bf16 a[16:19], v[40:43], v[56:59], 0
    ds_read_b64_tr_b16 v[24:25], v3 offset:256
    v_add_f32 v11, v11, v17
    v_mfma_f32_16x16x32_bf16 a[80:83], v[40:43], v[60:63], 0
    ds_read_b64_tr_b16 v[26:27], v3 offset:1296
    v_cvt_pk_bf16_f32 v68, v16, v17
    v_mfma_f32_16x16x32_bf16 a[144:147], v[40:43], v[72:75], 0
    ds_read_b64_tr_b16 v[28:29], v3 offset:288
    v_add_f32 v10, v10, v18
    v_mfma_f32_16x16x32_bf16 a[208:211], v[40:43], v[76:79], 0
    ds_read_b64_tr_b16 v[30:31], v3 offset:1328
    v_add_f32 v10, v10, v19
    v_mfma_f32_16x16x32_bf16 a[20:23], v[44:47], v[56:59], 0
    ds_read_b64_tr_b16 v[32:33], v3 offset:320
    v_cvt_pk_bf16_f32 v65, v18, v19
    v_mfma_f32_16x16x32_bf16 a[84:87], v[44:47], v[60:63], 0
    ds_read_b64_tr_b16 v[34:35], v3 offset:1360
    v_fma_f32 v90, v90, s42, -v7
    v_mfma_f32_16x16x32_bf16 a[148:151], v[44:47], v[72:75], 0
    ds_read_b64_tr_b16 v[36:37], v3 offset:352
    v_fma_f32 v91, v91, s42, -v7
    v_mfma_f32_16x16x32_bf16 a[212:215], v[44:47], v[76:79], 0
    ds_read_b64_tr_b16 v[38:39], v3 offset:1392
    v_fma_f32 v84, v84, s42, -v6
    v_mfma_f32_16x16x32_bf16 a[24:27], v[48:51], v[56:59], 0
    s_mov_b32 s36, 49216
    v_exp_f32 v20, v90
    v_mfma_f32_16x16x32_bf16 a[88:91], v[48:51], v[60:63], 0
    buffer_load_dwordx4 v5, s[16:19], s36 offen offset:0 nt lds
    v_mfma_f32_16x16x32_bf16 a[152:155], v[48:51], v[72:75], 0
    s_mov_b32 s36, 49200
    v_exp_f32 v21, v91
    v_mfma_f32_16x16x32_bf16 a[216:219], v[48:51], v[76:79], 0
    v_exp_f32 v14, v84
    v_mfma_f32_16x16x32_bf16 a[28:31], v[52:55], v[56:59], 0
    s_waitcnt vmcnt(13)
    s_barrier
    v_add_f32 v11, v11, v20
    v_mfma_f32_16x16x32_bf16 a[92:95], v[52:55], v[60:63], 0
    v_add_f32 v11, v11, v21
    v_cvt_pk_bf16_f32 v69, v20, v21
    v_mfma_f32_16x16x32_bf16 a[156:159], v[52:55], v[72:75], 0
    v_fma_f32 v85, v85, s42, -v6
    v_add_f32 v10, v10, v14
    v_mfma_f32_16x16x32_bf16 a[220:223], v[52:55], v[76:79], 0
    s_waitcnt lgkmcnt(0)
    v_exp_f32 v15, v85
    v_mfma_f32_16x16x32_bf16 a[32:35], v[24:27], v[56:59], 0
    ds_read_b64_tr_b16 v[40:41], v3 offset:384
    v_add_f32 v10, v10, v15
    v_mfma_f32_16x16x32_bf16 a[96:99], v[24:27], v[60:63], 0
    ds_read_b64_tr_b16 v[42:43], v3 offset:1424
    v_cvt_pk_bf16_f32 v66, v14, v15
    v_mfma_f32_16x16x32_bf16 a[160:163], v[24:27], v[72:75], 0
    ds_read_b64_tr_b16 v[44:45], v3 offset:416
    v_fma_f32 v92, v92, s42, -v7
    v_mfma_f32_16x16x32_bf16 a[224:227], v[24:27], v[76:79], 0
    ds_read_b64_tr_b16 v[46:47], v3 offset:1456
    v_fma_f32 v93, v93, s42, -v7
    v_mfma_f32_16x16x32_bf16 a[36:39], v[28:31], v[56:59], 0
    ds_read_b64_tr_b16 v[48:49], v3 offset:448
    v_fma_f32 v86, v86, s42, -v6
    v_mfma_f32_16x16x32_bf16 a[100:103], v[28:31], v[60:63], 0
    ds_read_b64_tr_b16 v[50:51], v3 offset:1488
    v_fma_f32 v87, v87, s42, -v6
    v_mfma_f32_16x16x32_bf16 a[164:167], v[28:31], v[72:75], 0
    ds_read_b64_tr_b16 v[52:53], v3 offset:480
    v_fma_f32 v94, v94, s42, -v7
    v_mfma_f32_16x16x32_bf16 a[228:231], v[28:31], v[76:79], 0
    ds_read_b64_tr_b16 v[54:55], v3 offset:1520
    v_fma_f32 v95, v95, s42, -v7
    v_mfma_f32_16x16x32_bf16 a[40:43], v[32:35], v[56:59], 0
    buffer_load_dwordx4 v5, s[16:19], s36 offen offset:1040 nt lds
    v_mfma_f32_16x16x32_bf16 a[104:107], v[32:35], v[60:63], 0
    s_mov_b32 s36, 49184
    v_exp_f32 v16, v92
    v_mfma_f32_16x16x32_bf16 a[168:171], v[32:35], v[72:75], 0
    buffer_load_dwordx4 v5, s[16:19], s36 offen offset:2080 nt lds
    v_mfma_f32_16x16x32_bf16 a[232:235], v[32:35], v[76:79], 0
    v_exp_f32 v17, v93
    v_mfma_f32_16x16x32_bf16 a[44:47], v[36:39], v[56:59], 0
    v_exp_f32 v18, v86
    v_mfma_f32_16x16x32_bf16 a[108:111], v[36:39], v[60:63], 0
    v_add_u32 v2, 49920, v0
    v_add_f32 v11, v11, v16
    v_mfma_f32_16x16x32_bf16 a[172:175], v[36:39], v[72:75], 0
    s_mov_b32 s36, 49168
    v_exp_f32 v19, v87
    v_mfma_f32_16x16x32_bf16 a[236:239], v[36:39], v[76:79], 0
    s_waitcnt lgkmcnt(0)
    v_exp_f32 v20, v94
    v_mfma_f32_16x16x32_bf16 a[48:51], v[40:43], v[56:59], 0
    ds_read_b128 v[24:27], v2 offset:0
    v_add_f32 v11, v11, v17
    v_mfma_f32_16x16x32_bf16 a[112:115], v[40:43], v[60:63], 0
    v_exp_f32 v21, v95
    v_mfma_f32_16x16x32_bf16 a[176:179], v[40:43], v[72:75], 0
    ds_read_b128 v[28:31], v2 offset:64
    v_cvt_pk_bf16_f32 v70, v16, v17
    v_mfma_f32_16x16x32_bf16 a[240:243], v[40:43], v[76:79], 0
    buffer_load_dwordx4 v5, s[16:19], s36 offen offset:3120 nt lds
    v_mfma_f32_16x16x32_bf16 a[52:55], v[44:47], v[56:59], 0
    ds_read_b128 v[32:35], v2 offset:128
    v_add_f32 v10, v10, v18
    v_mfma_f32_16x16x32_bf16 a[116:119], v[44:47], v[60:63], 0
    v_add_f32 v10, v10, v19
    v_cvt_pk_bf16_f32 v67, v18, v19
    v_mfma_f32_16x16x32_bf16 a[180:183], v[44:47], v[72:75], 0
    ds_read_b128 v[36:39], v2 offset:192
    v_add_f32 v11, v11, v20
    v_mfma_f32_16x16x32_bf16 a[244:247], v[44:47], v[76:79], 0
    v_add_f32 v11, v11, v21
    v_cvt_pk_bf16_f32 v71, v20, v21
    v_mfma_f32_16x16x32_bf16 a[56:59], v[48:51], v[56:59], 0
    v_max_f32 v22, v10, v11
    v_cmp_nge_f32 vcc, s43, v22
    v_mfma_f32_16x16x32_bf16 a[120:123], v[48:51], v[60:63], 0
    v_mfma_f32_16x16x32_bf16 a[184:187], v[48:51], v[72:75], 0
    v_mfma_f32_16x16x32_bf16 a[248:251], v[48:51], v[76:79], 0
    v_mfma_f32_16x16x32_bf16 a[60:63], v[52:55], v[56:59], 0
    v_mfma_f32_16x16x32_bf16 a[124:127], v[52:55], v[60:63], 0
    v_mfma_f32_16x16x32_bf16 a[188:191], v[52:55], v[72:75], 0
    v_mfma_f32_16x16x32_bf16 a[252:255], v[52:55], v[76:79], 0
    s_waitcnt lgkmcnt(0)
    s_cbranch_vccnz L_rarep0
L_backp0:
L_loop:
    v_mfma_f32_16x16x32_bf16 v[80:83], v[24:27], v[128:131], 0
    ds_read_b128 v[40:43], v2 offset:256
    v_fma_f32 v112, v112, s42, -v8
    v_mfma_f32_16x16x32_bf16 v[80:83], v[28:31], v[136:139], v[80:83]
    s_cmp_eq_u32 s41, 14
    s_cbranch_scc1 L_fix1
L_fixret1:
    v_fma_f32 v113, v113, s42, -v8
    v_mfma_f32_16x16x32_bf16 v[80:83], v[32:35], v[144:147], v[80:83]
    ds_read_b128 v[44:47], v2 offset:320
    v_fma_f32 v120, v120, s42, -v9
    v_mfma_f32_16x16x32_bf16 v[80:83], v[36:39], v[152:155], v[80:83]
    s_add_u32 m0, s40, s29
    v_exp_f32 v14, v112
    v_mfma_f32_16x16x32_bf16 v[88:91], v[24:27], v[132:135], 0
    ds_read_b128 v[48:51], v2 offset:384
    v_add_f32 v12, v12, v14
    v_mfma_f32_16x16x32_bf16 v[88:91], v[28:31], v[140:143], v[88:91]
    s_add_u32 s40, s39, 16640
    v_exp_f32 v15, v113
    v_mfma_f32_16x16x32_bf16 v[88:91], v[32:35], v[148:151], v[88:91]
    ds_read_b128 v[52:55], v2 offset:448
    v_add_f32 v12, v12, v15
    v_mfma_f32_16x16x32_bf16 v[88:91], v[36:39], v[156:159], v[88:91]
    s_cmp_eq_u32 s40, 149760
    v_exp_f32 v16, v120
    v_mfma_f32_16x16x32_bf16 v[96:99], v[24:27], v[192:195], 0
    s_cselect_b32 s40, 0, s40
    v_cvt_pk_bf16_f32 v72, v14, v15
    v_fma_f32 v121, v121, s42, -v9
    v_mfma_f32_16x16x32_bf16 v[96:99], v[28:31], v[200:203], v[96:99]
    s_add_u32 s36, s30, s32
    v_exp_f32 v17, v121
    v_mfma_f32_16x16x32_bf16 v[96:99], v[32:35], v[208:211], v[96:99]
    v_add_f32 v13, v13, v16
    v_add_f32 v13, v13, v17
    v_mfma_f32_16x16x32_bf16 v[96:99], v[36:39], v[216:219], v[96:99]
    v_cvt_pk_bf16_f32 v76, v16, v17
    v_fma_f32 v114, v114, s42, -v8
    v_mfma_f32_16x16x32_bf16 v[104:107], v[24:27], v[196:199], 0
    v_exp_f32 v18, v114
    v_mfma_f32_16x16x32_bf16 v[104:107], v[28:31], v[204:207], v[104:107]
    v_fma_f32 v115, v115, s42, -v8
    v_add_f32 v12, v12, v18
    v_mfma_f32_16x16x32_bf16 v[104:107], v[32:35], v[212:215], v[104:107]
    v_exp_f32 v19, v115
    v_mfma_f32_16x16x32_bf16 v[104:107], v[36:39], v[220:223], v[104:107]
    s_waitcnt lgkmcnt(0)
    v_add_f32 v12, v12, v19
    v_cvt_pk_bf16_f32 v73, v18, v19
    v_mfma_f32_16x16x32_bf16 v[80:83], v[40:43], v[160:163], v[80:83]
    ds_read_b128 v[24:27], v2 offset:1040
    v_fma_f32 v122, v122, s42, -v9
    v_mfma_f32_16x16x32_bf16 v[80:83], v[44:47], v[168:171], v[80:83]
    buffer_load_dwordx4 v4, s[12:15], s30 offen offset:0 nt lds
    v_mfma_f32_16x16x32_bf16 v[80:83], v[48:51], v[176:179], v[80:83]
    ds_read_b128 v[28:31], v2 offset:1104
    v_fma_f32 v123, v123, s42, -v9
    v_mfma_f32_16x16x32_bf16 v[80:83], v[52:55], v[184:187], v[80:83]
    v_exp_f32 v20, v122
    v_mfma_f32_16x16x32_bf16 v[88:91], v[40:43], v[164:167], v[88:91]
    ds_read_b128 v[32:35], v2 offset:1168
    v_add_f32 v13, v13, v20
    v_mfma_f32_16x16x32_bf16 v[88:91], v[44:47], v[172:175], v[88:91]
    v_exp_f32 v21, v123
    v_mfma_f32_16x16x32_bf16 v[88:91], v[48:51], v[180:183], v[88:91]
    ds_read_b128 v[36:39], v2 offset:1232
    v_add_f32 v13, v13, v21
    v_mfma_f32_16x16x32_bf16 v[88:91], v[52:55], v[188:191], v[88:91]
    buffer_load_dwordx4 v4, s[12:15], s36 offen offset:1040 nt lds
    v_mfma_f32_16x16x32_bf16 v[96:99], v[40:43], v[224:227], v[96:99]
    v_cvt_pk_bf16_f32 v77, v20, v21
    v_fma_f32 v116, v116, s42, -v8
    v_mfma_f32_16x16x32_bf16 v[96:99], v[44:47], v[232:235], v[96:99]
    v_exp_f32 v14, v116
    v_mfma_f32_16x16x32_bf16 v[96:99], v[48:51], v[240:243], v[96:99]
    v_fma_f32 v117, v117, s42, -v8
    v_add_f32 v12, v12, v14
    v_mfma_f32_16x16x32_bf16 v[96:99], v[52:55], v[248:251], v[96:99]
    v_exp_f32 v15, v117
    v_mfma_f32_16x16x32_bf16 v[104:107], v[40:43], v[228:231], v[104:107]
    s_add_u32 s36, s30, s33
    v_add_f32 v12, v12, v15
    v_cvt_pk_bf16_f32 v74, v14, v15
    v_mfma_f32_16x16x32_bf16 v[104:107], v[44:47], v[236:239], v[104:107]
    v_fma_f32 v124, v124, s42, -v9
    v_fma_f32 v125, v125, s42, -v9
    v_mfma_f32_16x16x32_bf16 v[104:107], v[48:51], v[244:247], v[104:107]
    v_exp_f32 v16, v124
    v_mfma_f32_16x16x32_bf16 v[104:107], v[52:55], v[252:255], v[104:107]
    s_waitcnt lgkmcnt(0)
    v_exp_f32 v17, v125
    v_mfma_f32_16x16x32_bf16 v[84:87], v[24:27], v[128:131], 0
    ds_read_b128 v[40:43], v2 offset:1296
    v_add_f32 v13, v13, v16
    v_mfma_f32_16x16x32_bf16 v[84:87], v[28:31], v[136:139], v[84:87]
    v_add_f32 v13, v13, v17
    v_cvt_pk_bf16_f32 v78, v16, v17
    v_mfma_f32_16x16x32_bf16 v[84:87], v[32:35], v[144:147], v[84:87]
    ds_read_b128 v[44:47], v2 offset:1360
    v_fma_f32 v118, v118, s42, -v8
    v_mfma_f32_16x16x32_bf16 v[84:87], v[36:39], v[152:155], v[84:87]
    buffer_load_dwordx4 v4, s[12:15], s36 offen offset:2080 nt lds
    v_mfma_f32_16x16x32_bf16 v[92:95], v[24:27], v[132:135], 0
    ds_read_b128 v[48:51], v2 offset:1424
    v_fma_f32 v119, v119, s42, -v8
    v_mfma_f32_16x16x32_bf16 v[92:95], v[28:31], v[140:143], v[92:95]
    v_exp_f32 v18, v118
    v_mfma_f32_16x16x32_bf16 v[92:95], v[32:35], v[148:151], v[92:95]
    ds_read_b128 v[52:55], v2 offset:1488
    v_add_f32 v12, v12, v18
    v_mfma_f32_16x16x32_bf16 v[92:95], v[36:39], v[156:159], v[92:95]
    v_exp_f32 v19, v119
    v_mfma_f32_16x16x32_bf16 v[100:103], v[24:27], v[192:195], 0
    v_add_f32 v12, v12, v19
    v_cvt_pk_bf16_f32 v75, v18, v19
    v_mfma_f32_16x16x32_bf16 v[100:103], v[28:31], v[200:203], v[100:103]
    s_add_u32 s36, s30, s54
    v_fma_f32 v126, v126, s42, -v9
    v_fma_f32 v127, v127, s42, -v9
    v_mfma_f32_16x16x32_bf16 v[100:103], v[32:35], v[208:211], v[100:103]
    v_exp_f32 v20, v126
    v_mfma_f32_16x16x32_bf16 v[100:103], v[36:39], v[216:219], v[100:103]
    v_exp_f32 v21, v127
    v_mfma_f32_16x16x32_bf16 v[108:111], v[24:27], v[196:199], 0
    v_add_f32 v13, v13, v20
    v_add_f32 v13, v13, v21
    v_mfma_f32_16x16x32_bf16 v[108:111], v[28:31], v[204:207], v[108:111]
    v_add_u32 v3, s40, v1
    v_cvt_pk_bf16_f32 v79, v20, v21
    v_mfma_f32_16x16x32_bf16 v[108:111], v[32:35], v[212:215], v[108:111]
    v_max_f32 v22, v12, v13
    v_cmp_nge_f32 vcc, s43, v22
    v_mfma_f32_16x16x32_bf16 v[108:111], v[36:39], v[220:223], v[108:111]
    s_waitcnt lgkmcnt(0)
    v_mfma_f32_16x16x32_bf16 v[84:87], v[40:43], v[160:163], v[84:87]
    ds_read_b64_tr_b16 v[24:25], v3 offset:0
    v_mfma_f32_16x16x32_bf16 v[84:87], v[44:47], v[168:171], v[84:87]
    ds_read_b64_tr_b16 v[26:27], v3 offset:1040
    v_mfma_f32_16x16x32_bf16 v[84:87], v[48:51], v[176:179], v[84:87]
    ds_read_b64_tr_b16 v[28:29], v3 offset:32
    v_mfma_f32_16x16x32_bf16 v[84:87], v[52:55], v[184:187], v[84:87]
    ds_read_b64_tr_b16 v[30:31], v3 offset:1072
    v_mfma_f32_16x16x32_bf16 v[92:95], v[40:43], v[164:167], v[92:95]
    ds_read_b64_tr_b16 v[32:33], v3 offset:64
    v_mfma_f32_16x16x32_bf16 v[92:95], v[44:47], v[172:175], v[92:95]
    ds_read_b64_tr_b16 v[34:35], v3 offset:1104
    v_mfma_f32_16x16x32_bf16 v[92:95], v[48:51], v[180:183], v[92:95]
    ds_read_b64_tr_b16 v[36:37], v3 offset:96
    v_mfma_f32_16x16x32_bf16 v[92:95], v[52:55], v[188:191], v[92:95]
    ds_read_b64_tr_b16 v[38:39], v3 offset:1136
    v_mfma_f32_16x16x32_bf16 v[100:103], v[40:43], v[224:227], v[100:103]
    buffer_load_dwordx4 v4, s[12:15], s36 offen offset:3120 nt lds
    v_mfma_f32_16x16x32_bf16 v[100:103], v[44:47], v[232:235], v[100:103]
    s_add_u32 s30, s30, s34
    v_mfma_f32_16x16x32_bf16 v[100:103], v[48:51], v[240:243], v[100:103]
    v_mfma_f32_16x16x32_bf16 v[100:103], v[52:55], v[248:251], v[100:103]
    v_mfma_f32_16x16x32_bf16 v[108:111], v[40:43], v[228:231], v[108:111]
    v_mfma_f32_16x16x32_bf16 v[108:111], v[44:47], v[236:239], v[108:111]
    v_mfma_f32_16x16x32_bf16 v[108:111], v[48:51], v[244:247], v[108:111]
    v_mfma_f32_16x16x32_bf16 v[108:111], v[52:55], v[252:255], v[108:111]
    s_waitcnt lgkmcnt(0)
    s_cbranch_vccnz L_rarea1
L_backa1:
    v_mfma_f32_16x16x32_bf16 a[0:3], v[24:27], v[64:67], a[0:3]
    ds_read_b64_tr_b16 v[40:41], v3 offset:128
    v_fma_f32 v80, v80, s42, -v6
    v_mfma_f32_16x16x32_bf16 a[64:67], v[24:27], v[68:71], a[64:67]
    ds_read_b64_tr_b16 v[42:43], v3 offset:1168
    v_fma_f32 v81, v81, s42, -v6
    v_mfma_f32_16x16x32_bf16 a[128:131], v[24:27], v[72:75], a[128:131]
    ds_read_b64_tr_b16 v[44:45], v3 offset:160
    v_fma_f32 v88, v88, s42, -v7
    v_mfma_f32_16x16x32_bf16 a[192:195], v[24:27], v[76:79], a[192:195]
    ds_read_b64_tr_b16 v[46:47], v3 offset:1200
    v_fma_f32 v89, v89, s42, -v7
    v_mfma_f32_16x16x32_bf16 a[4:7], v[28:31], v[64:67], a[4:7]
    ds_read_b64_tr_b16 v[48:49], v3 offset:192
    v_fma_f32 v82, v82, s42, -v6
    v_mfma_f32_16x16x32_bf16 a[68:71], v[28:31], v[68:71], a[68:71]
    ds_read_b64_tr_b16 v[50:51], v3 offset:1232
    v_fma_f32 v83, v83, s42, -v6
    v_mfma_f32_16x16x32_bf16 a[132:135], v[28:31], v[72:75], a[132:135]
    ds_read_b64_tr_b16 v[52:53], v3 offset:224
    v_mfma_f32_16x16x32_bf16 a[196:199], v[28:31], v[76:79], a[196:199]
    ds_read_b64_tr_b16 v[54:55], v3 offset:1264
    v_mfma_f32_16x16x32_bf16 a[8:11], v[32:35], v[64:67], a[8:11]
    s_add_u32 m0, s37, s29
    v_exp_f32 v14, v80
    v_mfma_f32_16x16x32_bf16 a[72:75], v[32:35], v[68:71], a[72:75]
    s_add_u32 s37, s40, 16640
    v_exp_f32 v15, v81
    v_mfma_f32_16x16x32_bf16 a[136:139], v[32:35], v[72:75], a[136:139]
    s_cmp_eq_u32 s37, 149760
    v_exp_f32 v16, v88
    v_mfma_f32_16x16x32_bf16 a[200:203], v[32:35], v[76:79], a[200:203]
    s_cselect_b32 s37, 0, s37
    v_exp_f32 v17, v89
    v_mfma_f32_16x16x32_bf16 a[12:15], v[36:39], v[64:67], a[12:15]
    s_add_u32 s36, s31, s55
    v_exp_f32 v18, v82
    v_mfma_f32_16x16x32_bf16 a[76:79], v[36:39], v[68:71], a[76:79]
    v_exp_f32 v19, v83
    v_mfma_f32_16x16x32_bf16 a[140:143], v[36:39], v[72:75], a[140:143]
    v_add_f32 v10, v10, v14
    v_add_f32 v10, v10, v15
    v_mfma_f32_16x16x32_bf16 a[204:207], v[36:39], v[76:79], a[204:207]
    s_waitcnt lgkmcnt(0)
    v_cvt_pk_bf16_f32 v56, v14, v15
    v_add_f32 v11, v11, v16
    v_mfma_f32_16x16x32_bf16 a[16:19], v[40:43], v[64:67], a[16:19]
    ds_read_b64_tr_b16 v[24:25], v3 offset:256
    v_add_f32 v11, v11, v17
    v_mfma_f32_16x16x32_bf16 a[80:83], v[40:43], v[68:71], a[80:83]
    ds_read_b64_tr_b16 v[26:27], v3 offset:1296
    v_cvt_pk_bf16_f32 v60, v16, v17
    v_mfma_f32_16x16x32_bf16 a[144:147], v[40:43], v[72:75], a[144:147]
    ds_read_b64_tr_b16 v[28:29], v3 offset:288
    v_add_f32 v10, v10, v18
    v_mfma_f32_16x16x32_bf16 a[208:211], v[40:43], v[76:79], a[208:211]
    ds_read_b64_tr_b16 v[30:31], v3 offset:1328
    v_add_f32 v10, v10, v19
    v_mfma_f32_16x16x32_bf16 a[20:23], v[44:47], v[64:67], a[20:23]
    ds_read_b64_tr_b16 v[32:33], v3 offset:320
    v_cvt_pk_bf16_f32 v57, v18, v19
    v_mfma_f32_16x16x32_bf16 a[84:87], v[44:47], v[68:71], a[84:87]
    ds_read_b64_tr_b16 v[34:35], v3 offset:1360
    v_fma_f32 v90, v90, s42, -v7
    v_mfma_f32_16x16x32_bf16 a[148:151], v[44:47], v[72:75], a[148:151]
    ds_read_b64_tr_b16 v[36:37], v3 offset:352
    v_fma_f32 v91, v91, s42, -v7
    v_mfma_f32_16x16x32_bf16 a[212:215], v[44:47], v[76:79], a[212:215]
    ds_read_b64_tr_b16 v[38:39], v3 offset:1392
    v_fma_f32 v84, v84, s42, -v6
    v_mfma_f32_16x16x32_bf16 a[24:27], v[48:51], v[64:67], a[24:27]
    buffer_load_dwordx4 v5, s[16:19], s31 offen offset:0 nt lds
    v_mfma_f32_16x16x32_bf16 a[88:91], v[48:51], v[68:71], a[88:91]
    buffer_load_dwordx4 v5, s[16:19], s36 offen offset:1040 nt lds
    v_mfma_f32_16x16x32_bf16 a[152:155], v[48:51], v[72:75], a[152:155]
    v_exp_f32 v20, v90
    v_mfma_f32_16x16x32_bf16 a[216:219], v[48:51], v[76:79], a[216:219]
    v_exp_f32 v21, v91
    v_mfma_f32_16x16x32_bf16 a[28:31], v[52:55], v[64:67], a[28:31]
    s_waitcnt vmcnt(14)
    s_barrier
    v_add_f32 v11, v11, v20
    v_mfma_f32_16x16x32_bf16 a[92:95], v[52:55], v[68:71], a[92:95]
    s_add_u32 s36, s31, s60
    v_exp_f32 v14, v84
    v_mfma_f32_16x16x32_bf16 a[156:159], v[52:55], v[72:75], a[156:159]
    v_add_f32 v11, v11, v21
    v_cvt_pk_bf16_f32 v61, v20, v21
    v_mfma_f32_16x16x32_bf16 a[220:223], v[52:55], v[76:79], a[220:223]
    s_waitcnt lgkmcnt(0)
    v_fma_f32 v85, v85, s42, -v6
    v_add_f32 v10, v10, v14
    v_mfma_f32_16x16x32_bf16 a[32:35], v[24:27], v[64:67], a[32:35]
    ds_read_b64_tr_b16 v[40:41], v3 offset:384
    v_fma_f32 v92, v92, s42, -v7
    v_mfma_f32_16x16x32_bf16 a[96:99], v[24:27], v[68:71], a[96:99]
    ds_read_b64_tr_b16 v[42:43], v3 offset:1424
    v_fma_f32 v93, v93, s42, -v7
    v_mfma_f32_16x16x32_bf16 a[160:163], v[24:27], v[72:75], a[160:163]
    ds_read_b64_tr_b16 v[44:45], v3 offset:416
    v_fma_f32 v86, v86, s42, -v6
    v_mfma_f32_16x16x32_bf16 a[224:227], v[24:27], v[76:79], a[224:227]
    ds_read_b64_tr_b16 v[46:47], v3 offset:1456
    v_fma_f32 v87, v87, s42, -v6
    v_mfma_f32_16x16x32_bf16 a[36:39], v[28:31], v[64:67], a[36:39]
    ds_read_b64_tr_b16 v[48:49], v3 offset:448
    v_fma_f32 v94, v94, s42, -v7
    v_mfma_f32_16x16x32_bf16 a[100:103], v[28:31], v[68:71], a[100:103]
    ds_read_b64_tr_b16 v[50:51], v3 offset:1488
    v_fma_f32 v95, v95, s42, -v7
    v_mfma_f32_16x16x32_bf16 a[164:167], v[28:31], v[72:75], a[164:167]
    ds_read_b64_tr_b16 v[52:53], v3 offset:480
    v_mfma_f32_16x16x32_bf16 a[228:231], v[28:31], v[76:79], a[228:231]
    ds_read_b64_tr_b16 v[54:55], v3 offset:1520
    v_mfma_f32_16x16x32_bf16 a[40:43], v[32:35], v[64:67], a[40:43]
    buffer_load_dwordx4 v5, s[16:19], s36 offen offset:2080 nt lds
    v_mfma_f32_16x16x32_bf16 a[104:107], v[32:35], v[68:71], a[104:107]
    s_add_u32 s36, s31, s61
    v_exp_f32 v15, v85
    v_mfma_f32_16x16x32_bf16 a[168:171], v[32:35], v[72:75], a[168:171]
    v_exp_f32 v16, v92
    v_mfma_f32_16x16x32_bf16 a[232:235], v[32:35], v[76:79], a[232:235]
    v_exp_f32 v17, v93
    v_mfma_f32_16x16x32_bf16 a[44:47], v[36:39], v[64:67], a[44:47]
    v_exp_f32 v18, v86
    v_mfma_f32_16x16x32_bf16 a[108:111], v[36:39], v[68:71], a[108:111]
    v_add_u32 v2, s37, v0
    v_add_f32 v10, v10, v15
    v_mfma_f32_16x16x32_bf16 a[172:175], v[36:39], v[72:75], a[172:175]
    buffer_load_dwordx4 v5, s[16:19], s36 offen offset:3120 nt lds
    v_mfma_f32_16x16x32_bf16 a[236:239], v[36:39], v[76:79], a[236:239]
    s_waitcnt lgkmcnt(0)
    v_exp_f32 v19, v87
    v_mfma_f32_16x16x32_bf16 a[48:51], v[40:43], v[64:67], a[48:51]
    ds_read_b128 v[24:27], v2 offset:0
    v_cvt_pk_bf16_f32 v58, v14, v15
    v_mfma_f32_16x16x32_bf16 a[112:115], v[40:43], v[68:71], a[112:115]
    v_exp_f32 v20, v94
    v_mfma_f32_16x16x32_bf16 a[176:179], v[40:43], v[72:75], a[176:179]
    ds_read_b128 v[28:31], v2 offset:64
    v_add_f32 v11, v11, v16
    v_mfma_f32_16x16x32_bf16 a[240:243], v[40:43], v[76:79], a[240:243]
    s_add_u32 s31, s31, s35
    v_exp_f32 v21, v95
    v_mfma_f32_16x16x32_bf16 a[52:55], v[44:47], v[64:67], a[52:55]
    ds_read_b128 v[32:35], v2 offset:128
    v_add_f32 v11, v11, v17
    v_mfma_f32_16x16x32_bf16 a[116:119], v[44:47], v[68:71], a[116:119]
    v_cvt_pk_bf16_f32 v62, v16, v17
    v_add_f32 v10, v10, v18
    v_mfma_f32_16x16x32_bf16 a[180:183], v[44:47], v[72:75], a[180:183]
    ds_read_b128 v[36:39], v2 offset:192
    v_add_f32 v10, v10, v19
    v_mfma_f32_16x16x32_bf16 a[244:247], v[44:47], v[76:79], a[244:247]
    v_cvt_pk_bf16_f32 v59, v18, v19
    v_add_f32 v11, v11, v20
    v_mfma_f32_16x16x32_bf16 a[56:59], v[48:51], v[64:67], a[56:59]
    v_add_f32 v11, v11, v21
    v_cvt_pk_bf16_f32 v63, v20, v21
    v_mfma_f32_16x16x32_bf16 a[120:123], v[48:51], v[68:71], a[120:123]
    v_max_f32 v22, v10, v11
    v_cmp_nge_f32 vcc, s43, v22
    v_mfma_f32_16x16x32_bf16 a[184:187], v[48:51], v[72:75], a[184:187]
    v_mfma_f32_16x16x32_bf16 a[248:251], v[48:51], v[76:79], a[248:251]
    v_mfma_f32_16x16x32_bf16 a[60:63], v[52:55], v[64:67], a[60:63]
    v_mfma_f32_16x16x32_bf16 a[124:127], v[52:55], v[68:71], a[124:127]
    v_mfma_f32_16x16x32_bf16 a[188:191], v[52:55], v[72:75], a[188:191]
    v_mfma_f32_16x16x32_bf16 a[252:255], v[52:55], v[76:79], a[252:255]
    s_waitcnt lgkmcnt(0)
    s_cbranch_vccnz L_rareb1
L_backb1:
    v_mfma_f32_16x16x32_bf16 v[80:83], v[24:27], v[128:131], 0
    ds_read_b128 v[40:43], v2 offset:256
    v_fma_f32 v96, v96, s42, -v8
    v_mfma_f32_16x16x32_bf16 v[80:83], v[28:31], v[136:139], v[80:83]
    s_cmp_eq_u32 s41, 13
    s_cbranch_scc1 L_fix0
L_fixret0:
    v_fma_f32 v97, v97, s42, -v8
    v_mfma_f32_16x16x32_bf16 v[80:83], v[32:35], v[144:147], v[80:83]
    ds_read_b128 v[44:47], v2 offset:320
    v_fma_f32 v104, v104, s42, -v9
    v_mfma_f32_16x16x32_bf16 v[80:83], v[36:39], v[152:155], v[80:83]
    s_add_u32 m0, s38, s29
    v_exp_f32 v14, v96
    v_mfma_f32_16x16x32_bf16 v[88:91], v[24:27], v[132:135], 0
    ds_read_b128 v[48:51], v2 offset:384
    v_add_f32 v12, v12, v14
    v_mfma_f32_16x16x32_bf16 v[88:91], v[28:31], v[140:143], v[88:91]
    s_add_u32 s38, s37, 16640
    v_exp_f32 v15, v97
    v_mfma_f32_16x16x32_bf16 v[88:91], v[32:35], v[148:151], v[88:91]
    ds_read_b128 v[52:55], v2 offset:448
    v_add_f32 v12, v12, v15
    v_mfma_f32_16x16x32_bf16 v[88:91], v[36:39], v[156:159], v[88:91]
    s_cmp_eq_u32 s38, 149760
    v_exp_f32 v16, v104
    v_mfma_f32_16x16x32_bf16 v[112:115], v[24:27], v[192:195], 0
    s_cselect_b32 s38, 0, s38
    v_cvt_pk_bf16_f32 v72, v14, v15
    v_fma_f32 v105, v105, s42, -v9
    v_mfma_f32_16x16x32_bf16 v[112:115], v[28:31], v[200:203], v[112:115]
    s_add_u32 s36, s30, s32
    v_exp_f32 v17, v105
    v_mfma_f32_16x16x32_bf16 v[112:115], v[32:35], v[208:211], v[112:115]
    v_add_f32 v13, v13, v16
    v_add_f32 v13, v13, v17
    v_mfma_f32_16x16x32_bf16 v[112:115], v[36:39], v[216:219], v[112:115]
    v_cvt_pk_bf16_f32 v76, v16, v17
    v_fma_f32 v98, v98, s42, -v8
    v_mfma_f32_16x16x32_bf16 v[120:123], v[24:27], v[196:199], 0
    v_exp_f32 v18, v98
    v_mfma_f32_16x16x32_bf16 v[120:123], v[28:31], v[204:207], v[120:123]
    v_fma_f32 v99, v99, s42, -v8
    v_add_f32 v12, v12, v18
    v_mfma_f32_16x16x32_bf16 v[120:123], v[32:35], v[212:215], v[120:123]
    v_exp_f32 v19, v99
    v_mfma_f32_16x16x32_bf16 v[120:123], v[36:39], v[220:223], v[120:123]
    s_waitcnt lgkmcnt(0)
    v_add_f32 v12, v12, v19
    v_cvt_pk_bf16_f32 v73, v18, v19
    v_mfma_f32_16x16x32_bf16 v[80:83], v[40:43], v[160:163], v[80:83]
    ds_read_b128 v[24:27], v2 offset:1040
    v_fma_f32 v106, v106, s42, -v9
    v_mfma_f32_16x16x32_bf16 v[80:83], v[44:47], v[168:171], v[80:83]
    buffer_load_dwordx4 v4, s[12:15], s30 offen offset:0 nt lds
    v_mfma_f32_16x16x32_bf16 v[80:83], v[48:51], v[176:179], v[80:83]
    ds_read_b128 v[28:31], v2 offset:1104
    v_fma_f32 v107, v107, s42, -v9
    v_mfma_f32_16x16x32_bf16 v[80:83], v[52:55], v[184:187], v[80:83]
    v_exp_f32 v20, v106
    v_mfma_f32_16x16x32_bf16 v[88:91], v[40:43], v[164:167], v[88:91]
    ds_read_b128 v[32:35], v2 offset:1168
    v_add_f32 v13, v13, v20
    v_mfma_f32_16x16x32_bf16 v[88:91], v[44:47], v[172:175], v[88:91]
    v_exp_f32 v21, v107
    v_mfma_f32_16x16x32_bf16 v[88:91], v[48:51], v[180:183], v[88:91]
    ds_read_b128 v[36:39], v2 offset:1232
    v_add_f32 v13, v13, v21
    v_mfma_f32_16x16x32_bf16 v[88:91], v[52:55], v[188:191], v[88:91]
    buffer_load_dwordx4 v4, s[12:15], s36 offen offset:1040 nt lds
    v_mfma_f32_16x16x32_bf16 v[112:115], v[40:43], v[224:227], v[112:115]
    v_cvt_pk_bf16_f32 v77, v20, v21
    v_fma_f32 v100, v100, s42, -v8
    v_mfma_f32_16x16x32_bf16 v[112:115], v[44:47], v[232:235], v[112:115]
    v_exp_f32 v14, v100
    v_mfma_f32_16x16x32_bf16 v[112:115], v[48:51], v[240:243], v[112:115]
    v_fma_f32 v101, v101, s42, -v8
    v_add_f32 v12, v12, v14
    v_mfma_f32_16x16x32_bf16 v[112:115], v[52:55], v[248:251], v[112:115]
    v_exp_f32 v15, v101
    v_mfma_f32_16x16x32_bf16 v[120:123], v[40:43], v[228:231], v[120:123]
    s_add_u32 s36, s30, s33
    v_add_f32 v12, v12, v15
    v_cvt_pk_bf16_f32 v74, v14, v15
    v_mfma_f32_16x16x32_bf16 v[120:123], v[44:47], v[236:239], v[120:123]
    v_fma_f32 v108, v108, s42, -v9
    v_fma_f32 v109, v109, s42, -v9
    v_mfma_f32_16x16x32_bf16 v[120:123], v[48:51], v[244:247], v[120:123]
    v_exp_f32 v16, v108
    v_mfma_f32_16x16x32_bf16 v[120:123], v[52:55], v[252:255], v[120:123]
    s_waitcnt lgkmcnt(0)
    v_exp_f32 v17, v109
    v_mfma_f32_16x16x32_bf16 v[84:87], v[24:27], v[128:131], 0
    ds_read_b128 v[40:43], v2 offset:1296
    v_add_f32 v13, v13, v16
    v_mfma_f32_16x16x32_bf16 v[84:87], v[28:31], v[136:139], v[84:87]
    v_add_f32 v13, v13, v17
    v_cvt_pk_bf16_f32 v78, v16, v17
    v_mfma_f32_16x16x32_bf16 v[84:87], v[32:35], v[144:147], v[84:87]
    ds_read_b128 v[44:47], v2 offset:1360
    v_fma_f32 v102, v102, s42, -v8
    v_mfma_f32_16x16x32_bf16 v[84:87], v[36:39], v[152:155], v[84:87]
    buffer_load_dwordx4 v4, s[12:15], s36 offen offset:2080 nt lds
    v_mfma_f32_16x16x32_bf16 v[92:95], v[24:27], v[132:135], 0
    ds_read_b128 v[48:51], v2 offset:1424
    v_fma_f32 v103, v103, s42, -v8
    v_mfma_f32_16x16x32_bf16 v[92:95], v[28:31], v[140:143], v[92:95]
    v_exp_f32 v18, v102
    v_mfma_f32_16x16x32_bf16 v[92:95], v[32:35], v[148:151], v[92:95]
    ds_read_b128 v[52:55], v2 offset:1488
    v_add_f32 v12, v12, v18
    v_mfma_f32_16x16x32_bf16 v[92:95], v[36:39], v[156:159], v[92:95]
    v_exp_f32 v19, v103
    v_mfma_f32_16x16x32_bf16 v[116:119], v[24:27], v[192:195], 0
    v_add_f32 v12, v12, v19
    v_cvt_pk_bf16_f32 v75, v18, v19
    v_mfma_f32_16x16x32_bf16 v[116:119], v[28:31], v[200:203], v[116:119]
    s_add_u32 s36, s30, s54
    v_fma_f32 v110, v110, s42, -v9
    v_fma_f32 v111, v111, s42, -v9
    v_mfma_f32_16x16x32_bf16 v[116:119], v[32:35], v[208:211], v[116:119]
    v_exp_f32 v20, v110
    v_mfma_f32_16x16x32_bf16 v[116:119], v[36:39], v[216:219], v[116:119]
    v_exp_f32 v21, v111
    v_mfma_f32_16x16x32_bf16 v[124:127], v[24:27], v[196:199], 0
    v_add_f32 v13, v13, v20
    v_add_f32 v13, v13, v21
    v_mfma_f32_16x16x32_bf16 v[124:127], v[28:31], v[204:207], v[124:127]
    v_add_u32 v3, s38, v1
    v_cvt_pk_bf16_f32 v79, v20, v21
    v_mfma_f32_16x16x32_bf16 v[124:127], v[32:35], v[212:215], v[124:127]
    v_max_f32 v22, v12, v13
    v_cmp_nge_f32 vcc, s43, v22
    v_mfma_f32_16x16x32_bf16 v[124:127], v[36:39], v[220:223], v[124:127]
    s_waitcnt lgkmcnt(0)
    v_mfma_f32_16x16x32_bf16 v[84:87], v[40:43], v[160:163], v[84:87]
    ds_read_b64_tr_b16 v[24:25], v3 offset:0
    v_mfma_f32_16x16x32_bf16 v[84:87], v[44:47], v[168:171], v[84:87]
    ds_read_b64_tr_b16 v[26:27], v3 offset:1040
    v_mfma_f32_16x16x32_bf16 v[84:87], v[48:51], v[176:179], v[84:87]
    ds_read_b64_tr_b16 v[28:29], v3 offset:32
    v_mfma_f32_16x16x32_bf16 v[84:87], v[52:55], v[184:187], v[84:87]
    ds_read_b64_tr_b16 v[30:31], v3 offset:1072
    v_mfma_f32_16x16x32_bf16 v[92:95], v[40:43], v[164:167], v[92:95]
    ds_read_b64_tr_b16 v[32:33], v3 offset:64
    v_mfma_f32_16x16x32_bf16 v[92:95], v[44:47], v[172:175], v[92:95]
    ds_read_b64_tr_b16 v[34:35], v3 offset:1104
    v_mfma_f32_16x16x32_bf16 v[92:95], v[48:51], v[180:183], v[92:95]
    ds_read_b64_tr_b16 v[36:37], v3 offset:96
    v_mfma_f32_16x16x32_bf16 v[92:95], v[52:55], v[188:191], v[92:95]
    ds_read_b64_tr_b16 v[38:39], v3 offset:1136
    v_mfma_f32_16x16x32_bf16 v[116:119], v[40:43], v[224:227], v[116:119]
    buffer_load_dwordx4 v4, s[12:15], s36 offen offset:3120 nt lds
    v_mfma_f32_16x16x32_bf16 v[116:119], v[44:47], v[232:235], v[116:119]
    s_add_u32 s30, s30, s34
    v_mfma_f32_16x16x32_bf16 v[116:119], v[48:51], v[240:243], v[116:119]
    v_mfma_f32_16x16x32_bf16 v[116:119], v[52:55], v[248:251], v[116:119]
    v_mfma_f32_16x16x32_bf16 v[124:127], v[40:43], v[228:231], v[124:127]
    v_mfma_f32_16x16x32_bf16 v[124:127], v[44:47], v[236:239], v[124:127]
    v_mfma_f32_16x16x32_bf16 v[124:127], v[48:51], v[244:247], v[124:127]
    v_mfma_f32_16x16x32_bf16 v[124:127], v[52:55], v[252:255], v[124:127]
    s_waitcnt lgkmcnt(0)
    s_cbranch_vccnz L_rarea0
L_backa0:
    v_mfma_f32_16x16x32_bf16 a[0:3], v[24:27], v[56:59], a[0:3]
    ds_read_b64_tr_b16 v[40:41], v3 offset:128
    v_fma_f32 v80, v80, s42, -v6
    v_mfma_f32_16x16x32_bf16 a[64:67], v[24:27], v[60:63], a[64:67]
    ds_read_b64_tr_b16 v[42:43], v3 offset:1168
    v_fma_f32 v81, v81, s42, -v6
    v_mfma_f32_16x16x32_bf16 a[128:131], v[24:27], v[72:75], a[128:131]
    ds_read_b64_tr_b16 v[44:45], v3 offset:160
    v_fma_f32 v88, v88, s42, -v7
    v_mfma_f32_16x16x32_bf16 a[192:195], v[24:27], v[76:79], a[192:195]
    ds_read_b64_tr_b16 v[46:47], v3 offset:1200
    v_fma_f32 v89, v89, s42, -v7
    v_mfma_f32_16x16x32_bf16 a[4:7], v[28:31], v[56:59], a[4:7]
    ds_read_b64_tr_b16 v[48:49], v3 offset:192
    v_fma_f32 v82, v82, s42, -v6
    v_mfma_f32_16x16x32_bf16 a[68:71], v[28:31], v[60:63], a[68:71]
    ds_read_b64_tr_b16 v[50:51], v3 offset:1232
    v_fma_f32 v83, v83, s42, -v6
    v_mfma_f32_16x16x32_bf16 a[132:135], v[28:31], v[72:75], a[132:135]
    ds_read_b64_tr_b16 v[52:53], v3 offset:224
    v_mfma_f32_16x16x32_bf16 a[196:199], v[28:31], v[76:79], a[196:199]
    ds_read_b64_tr_b16 v[54:55], v3 offset:1264
    v_mfma_f32_16x16x32_bf16 a[8:11], v[32:35], v[56:59], a[8:11]
    s_add_u32 m0, s39, s29
    v_exp_f32 v14, v80
    v_mfma_f32_16x16x32_bf16 a[72:75], v[32:35], v[60:63], a[72:75]
    s_add_u32 s39, s38, 16640
    v_exp_f32 v15, v81
    v_mfma_f32_16x16x32_bf16 a[136:139], v[32:35], v[72:75], a[136:139]
    s_cmp_eq_u32 s39, 149760
    v_exp_f32 v16, v88
    v_mfma_f32_16x16x32_bf16 a[200:203], v[32:35], v[76:79], a[200:203]
    s_cselect_b32 s39, 0, s39
    v_exp_f32 v17, v89
    v_mfma_f32_16x16x32_bf16 a[12:15], v[36:39], v[56:59], a[12:15]
    s_add_u32 s36, s31, s55
    v_exp_f32 v18, v82
    v_mfma_f32_16x16x32_bf16 a[76:79], v[36:39], v[60:63], a[76:79]
    v_exp_f32 v19, v83
    v_mfma_f32_16x16x32_bf16 a[140:143], v[36:39], v[72:75], a[140:143]
    v_add_f32 v10, v10, v14
    v_add_f32 v10, v10, v15
    v_mfma_f32_16x16x32_bf16 a[204:207], v[36:39], v[76:79], a[204:207]
    s_waitcnt lgkmcnt(0)
    v_cvt_pk_bf16_f32 v64, v14, v15
    v_add_f32 v11, v11, v16
    v_mfma_f32_16x16x32_bf16 a[16:19], v[40:43], v[56:59], a[16:19]
    ds_read_b64_tr_b16 v[24:25], v3 offset:256
    v_add_f32 v11, v11, v17
    v_mfma_f32_16x16x32_bf16 a[80:83], v[40:43], v[60:63], a[80:83]
    ds_read_b64_tr_b16 v[26:27], v3 offset:1296
    v_cvt_pk_bf16_f32 v68, v16, v17
    v_mfma_f32_16x16x32_bf16 a[144:147], v[40:43], v[72:75], a[144:147]
    ds_read_b64_tr_b16 v[28:29], v3 offset:288
    v_add_f32 v10, v10, v18
    v_mfma_f32_16x16x32_bf16 a[208:211], v[40:43], v[76:79], a[208:211]
    ds_read_b64_tr_b16 v[30:31], v3 offset:1328
    v_add_f32 v10, v10, v19
    v_mfma_f32_16x16x32_bf16 a[20:23], v[44:47], v[56:59], a[20:23]
    ds_read_b64_tr_b16 v[32:33], v3 offset:320
    v_cvt_pk_bf16_f32 v65, v18, v19
    v_mfma_f32_16x16x32_bf16 a[84:87], v[44:47], v[60:63], a[84:87]
    ds_read_b64_tr_b16 v[34:35], v3 offset:1360
    v_fma_f32 v90, v90, s42, -v7
    v_mfma_f32_16x16x32_bf16 a[148:151], v[44:47], v[72:75], a[148:151]
    ds_read_b64_tr_b16 v[36:37], v3 offset:352
    v_fma_f32 v91, v91, s42, -v7
    v_mfma_f32_16x16x32_bf16 a[212:215], v[44:47], v[76:79], a[212:215]
    ds_read_b64_tr_b16 v[38:39], v3 offset:1392
    v_fma_f32 v84, v84, s42, -v6
    v_mfma_f32_16x16x32_bf16 a[24:27], v[48:51], v[56:59], a[24:27]
    buffer_load_dwordx4 v5, s[16:19], s31 offen offset:0 nt lds
    v_mfma_f32_16x16x32_bf16 a[88:91], v[48:51], v[60:63], a[88:91]
    buffer_load_dwordx4 v5, s[16:19], s36 offen offset:1040 nt lds
    v_mfma_f32_16x16x32_bf16 a[152:155], v[48:51], v[72:75], a[152:155]
    v_exp_f32 v20, v90
    v_mfma_f32_16x16x32_bf16 a[216:219], v[48:51], v[76:79], a[216:219]
    v_exp_f32 v21, v91
    v_mfma_f32_16x16x32_bf16 a[28:31], v[52:55], v[56:59], a[28:31]
    s_waitcnt vmcnt(14)
    s_barrier
    v_add_f32 v11, v11, v20
    v_mfma_f32_16x16x32_bf16 a[92:95], v[52:55], v[60:63], a[92:95]
    s_add_u32 s36, s31, s60
    v_exp_f32 v14, v84
    v_mfma_f32_16x16x32_bf16 a[156:159], v[52:55], v[72:75], a[156:159]
    v_add_f32 v11, v11, v21
    v_cvt_pk_bf16_f32 v69, v20, v21
    v_mfma_f32_16x16x32_bf16 a[220:223], v[52:55], v[76:79], a[220:223]
    s_waitcnt lgkmcnt(0)
    v_fma_f32 v85, v85, s42, -v6
    v_add_f32 v10, v10, v14
    v_mfma_f32_16x16x32_bf16 a[32:35], v[24:27], v[56:59], a[32:35]
    ds_read_b64_tr_b16 v[40:41], v3 offset:384
    v_fma_f32 v92, v92, s42, -v7
    v_mfma_f32_16x16x32_bf16 a[96:99], v[24:27], v[60:63], a[96:99]
    ds_read_b64_tr_b16 v[42:43], v3 offset:1424
    v_fma_f32 v93, v93, s42, -v7
    v_mfma_f32_16x16x32_bf16 a[160:163], v[24:27], v[72:75], a[160:163]
    ds_read_b64_tr_b16 v[44:45], v3 offset:416
    v_fma_f32 v86, v86, s42, -v6
    v_mfma_f32_16x16x32_bf16 a[224:227], v[24:27], v[76:79], a[224:227]
    ds_read_b64_tr_b16 v[46:47], v3 offset:1456
    v_fma_f32 v87, v87, s42, -v6
    v_mfma_f32_16x16x32_bf16 a[36:39], v[28:31], v[56:59], a[36:39]
    ds_read_b64_tr_b16 v[48:49], v3 offset:448
    v_fma_f32 v94, v94, s42, -v7
    v_mfma_f32_16x16x32_bf16 a[100:103], v[28:31], v[60:63], a[100:103]
    ds_read_b64_tr_b16 v[50:51], v3 offset:1488
    v_fma_f32 v95, v95, s42, -v7
    v_mfma_f32_16x16x32_bf16 a[164:167], v[28:31], v[72:75], a[164:167]
    ds_read_b64_tr_b16 v[52:53], v3 offset:480
    v_mfma_f32_16x16x32_bf16 a[228:231], v[28:31], v[76:79], a[228:231]
    ds_read_b64_tr_b16 v[54:55], v3 offset:1520
    v_mfma_f32_16x16x32_bf16 a[40:43], v[32:35], v[56:59], a[40:43]
    buffer_load_dwordx4 v5, s[16:19], s36 offen offset:2080 nt lds
    v_mfma_f32_16x16x32_bf16 a[104:107], v[32:35], v[60:63], a[104:107]
    s_add_u32 s36, s31, s61
    v_exp_f32 v15, v85
    v_mfma_f32_16x16x32_bf16 a[168:171], v[32:35], v[72:75], a[168:171]
    v_exp_f32 v16, v92
    v_mfma_f32_16x16x32_bf16 a[232:235], v[32:35], v[76:79], a[232:235]
    v_exp_f32 v17, v93
    v_mfma_f32_16x16x32_bf16 a[44:47], v[36:39], v[56:59], a[44:47]
    v_exp_f32 v18, v86
    v_mfma_f32_16x16x32_bf16 a[108:111], v[36:39], v[60:63], a[108:111]
    v_add_u32 v2, s39, v0
    v_add_f32 v10, v10, v15
    v_mfma_f32_16x16x32_bf16 a[172:175], v[36:39], v[72:75], a[172:175]
    buffer_load_dwordx4 v5, s[16:19], s36 offen offset:3120 nt lds
    v_mfma_f32_16x16x32_bf16 a[236:239], v[36:39], v[76:79], a[236:239]
    s_waitcnt lgkmcnt(0)
    v_exp_f32 v19, v87
    v_mfma_f32_16x16x32_bf16 a[48:51], v[40:43], v[56:59], a[48:51]
    ds_read_b128 v[24:27], v2 offset:0
    v_cvt_pk_bf16_f32 v66, v14, v15
    v_mfma_f32_16x16x32_bf16 a[112:115], v[40:43], v[60:63], a[112:115]
    v_exp_f32 v20, v94
    v_mfma_f32_16x16x32_bf16 a[176:179], v[40:43], v[72:75], a[176:179]
    ds_read_b128 v[28:31], v2 offset:64
    v_add_f32 v11, v11, v16
    v_mfma_f32_16x16x32_bf16 a[240:243], v[40:43], v[76:79], a[240:243]
    s_add_u32 s31, s31, s35
    v_exp_f32 v21, v95
    v_mfma_f32_16x16x32_bf16 a[52:55], v[44:47], v[56:59], a[52:55]
    ds_read_b128 v[32:35], v2 offset:128
    v_add_f32 v11, v11, v17
    v_mfma_f32_16x16x32_bf16 a[116:119], v[44:47], v[60:63], a[116:119]
    v_cvt_pk_bf16_f32 v70, v16, v17
    v_add_f32 v10, v10, v18
    v_mfma_f32_16x16x32_bf16 a[180:183], v[44:47], v[72:75], a[180:183]
    ds_read_b128 v[36:39], v2 offset:192
    v_add_f32 v10, v10, v19
    v_mfma_f32_16x16x32_bf16 a[244:247], v[44:47], v[76:79], a[244:247]
    v_cvt_pk_bf16_f32 v67, v18, v19
    v_add_f32 v11, v11, v20
    v_mfma_f32_16x16x32_bf16 a[56:59], v[48:51], v[56:59], a[56:59]
    s_add_u32 s41, s41, 1
    v_add_f32 v11, v11, v21
    v_cvt_pk_bf16_f32 v71, v20, v21
    v_mfma_f32_16x16x32_bf16 a[120:123], v[48:51], v[60:63], a[120:123]
    v_max_f32 v22, v10, v11
    v_cmp_nge_f32 vcc, s43, v22
    v_mfma_f32_16x16x32_bf16 a[184:187], v[48:51], v[72:75], a[184:187]
    s_cmp_lt_u32 s41, 15
    v_mfma_f32_16x16x32_bf16 a[248:251], v[48:51], v[76:79], a[248:251]
    v_mfma_f32_16x16x32_bf16 a[60:63], v[52:55], v[56:59], a[60:63]
    v_mfma_f32_16x16x32_bf16 a[124:127], v[52:55], v[60:63], a[124:127]
    v_mfma_f32_16x16x32_bf16 a[188:191], v[52:55], v[72:75], a[188:191]
    v_mfma_f32_16x16x32_bf16 a[252:255], v[52:55], v[76:79], a[252:255]
    s_waitcnt lgkmcnt(0)
    s_cbranch_vccnz L_rareb0
L_backb0:
    s_cbranch_scc1 L_loop
    v_add_u32 v3, 0, v1
    ds_read_b64_tr_b16 v[24:25], v3 offset:0
    ds_read_b64_tr_b16 v[26:27], v3 offset:1040
    ds_read_b64_tr_b16 v[28:29], v3 offset:32
    ds_read_b64_tr_b16 v[30:31], v3 offset:1072
    ds_read_b64_tr_b16 v[32:33], v3 offset:64
    ds_read_b64_tr_b16 v[34:35], v3 offset:1104
    ds_read_b64_tr_b16 v[36:37], v3 offset:96
    ds_read_b64_tr_b16 v[38:39], v3 offset:1136
    v_fma_f32 v112, v112, s42, -v8
    v_fma_f32 v113, v113, s42, -v8
    v_exp_f32 v14, v112
    v_exp_f32 v15, v113
    v_add_f32 v12, v12, v14
    v_add_f32 v12, v12, v15
    v_cvt_pk_bf16_f32 v72, v14, v15
    v_fma_f32 v120, v120, s42, -v9
    v_fma_f32 v121, v121, s42, -v9
    v_exp_f32 v16, v120
    v_exp_f32 v17, v121
    v_add_f32 v13, v13, v16
    v_add_f32 v13, v13, v17
    v_cvt_pk_bf16_f32 v76, v16, v17
    v_fma_f32 v114, v114, s42, -v8
    v_fma_f32 v115, v115, s42, -v8
    v_exp_f32 v18, v114
    v_exp_f32 v19, v115
    v_add_f32 v12, v12, v18
    v_add_f32 v12, v12, v19
    v_cvt_pk_bf16_f32 v73, v18, v19
    v_fma_f32 v122, v122, s42, -v9
    v_fma_f32 v123, v123, s42, -v9
    v_exp_f32 v20, v122
    v_exp_f32 v21, v123
    v_add_f32 v13, v13, v20
    v_add_f32 v13, v13, v21
    v_cvt_pk_bf16_f32 v77, v20, v21
    v_fma_f32 v116, v116, s42, -v8
    v_fma_f32 v117, v117, s42, -v8
    v_exp_f32 v14, v116
    v_exp_f32 v15, v117
    v_add_f32 v12, v12, v14
    v_add_f32 v12, v12, v15
    v_cvt_pk_bf16_f32 v74, v14, v15
    v_fma_f32 v124, v124, s42, -v9
    v_fma_f32 v125, v125, s42, -v9
    v_exp_f32 v16, v124
    v_exp_f32 v17, v125
    v_add_f32 v13, v13, v16
    v_add_f32 v13, v13, v17
    v_cvt_pk_bf16_f32 v78, v16, v17
    v_fma_f32 v118, v118, s42, -v8
    v_fma_f32 v119, v119, s42, -v8
    v_exp_f32 v18, v118
    v_exp_f32 v19, v119
    v_add_f32 v12, v12, v18
    v_add_f32 v12, v12, v19
    v_cvt_pk_bf16_f32 v75, v18, v19
    v_fma_f32 v126, v126, s42, -v9
    v_fma_f32 v127, v127, s42, -v9
    v_exp_f32 v20, v126
    v_exp_f32 v21, v127
    v_add_f32 v13, v13, v20
    v_add_f32 v13, v13, v21
    v_cvt_pk_bf16_f32 v79, v20, v21
    v_max_f32 v22, v12, v13
    v_cmp_nge_f32 vcc, s43, v22
    s_nop 0
    s_cbranch_vccnz L_raret
L_backt:
    s_waitcnt lgkmcnt(0)
    v_mfma_f32_16x16x32_bf16 a[0:3], v[24:27], v[64:67], a[0:3]
    ds_read_b64_tr_b16 v[40:41], v3 offset:128
    v_mov_b32 v14, v10
    v_mfma_f32_16x16x32_bf16 a[64:67], v[24:27], v[68:71], a[64:67]
    ds_read_b64_tr_b16 v[42:43], v3 offset:1168
    v_mov_b32 v15, v11
    v_mfma_f32_16x16x32_bf16 a[128:131], v[24:27], v[72:75], a[128:131]
    ds_read_b64_tr_b16 v[44:45], v3 offset:160
    v_mov_b32 v16, v12
    v_mfma_f32_16x16x32_bf16 a[192:195], v[24:27], v[76:79], a[192:195]
    ds_read_b64_tr_b16 v[46:47], v3 offset:1200
    v_mov_b32 v17, v13
    v_mfma_f32_16x16x32_bf16 a[4:7], v[28:31], v[64:67], a[4:7]
    ds_read_b64_tr_b16 v[48:49], v3 offset:192
    v_permlane32_swap_b32 v10, v14
    v_mfma_f32_16x16x32_bf16 a[68:71], v[28:31], v[68:71], a[68:71]
    ds_read_b64_tr_b16 v[50:51], v3 offset:1232
    v_permlane32_swap_b32 v11, v15
    v_mfma_f32_16x16x32_bf16 a[132:135], v[28:31], v[72:75], a[132:135]
    ds_read_b64_tr_b16 v[52:53], v3 offset:224
    v_permlane32_swap_b32 v12, v16
    v_mfma_f32_16x16x32_bf16 a[196:199], v[28:31], v[76:79], a[196:199]
    ds_read_b64_tr_b16 v[54:55], v3 offset:1264
    v_permlane32_swap_b32 v13, v17
    v_mfma_f32_16x16x32_bf16 a[8:11], v[32:35], v[64:67], a[8:11]
    s_add_u32 m0, s29, 99840
    v_add_f32 v10, v10, v14
    v_add_f32 v11, v11, v15
    v_mfma_f32_16x16x32_bf16 a[72:75], v[32:35], v[68:71], a[72:75]
    v_add_f32 v12, v12, v16
    v_add_f32 v13, v13, v17
    v_mfma_f32_16x16x32_bf16 a[136:139], v[32:35], v[72:75], a[136:139]
    s_lshr_b32 s44, s63, 12
    v_mov_b32 v14, v10
    v_mov_b32 v15, v11
    v_mfma_f32_16x16x32_bf16 a[200:203], v[32:35], v[76:79], a[200:203]
    v_mov_b32 v16, v12
    v_mov_b32 v17, v13
    v_mfma_f32_16x16x32_bf16 a[12:15], v[36:39], v[64:67], a[12:15]
    v_permlane16_swap_b32 v10, v14
    v_permlane16_swap_b32 v11, v15
    v_mfma_f32_16x16x32_bf16 a[76:79], v[36:39], v[68:71], a[76:79]
    s_add_u32 s36, s44, 231424
    v_permlane16_swap_b32 v12, v16
    v_permlane16_swap_b32 v13, v17
    v_mfma_f32_16x16x32_bf16 a[140:143], v[36:39], v[72:75], a[140:143]
    v_add_f32 v10, v10, v14
    v_add_f32 v11, v11, v15
    v_mfma_f32_16x16x32_bf16 a[204:207], v[36:39], v[76:79], a[204:207]
    s_waitcnt lgkmcnt(0)
    v_rcp_f32 v6, v10
    v_mfma_f32_16x16x32_bf16 a[16:19], v[40:43], v[64:67], a[16:19]
    ds_read_b64_tr_b16 v[24:25], v3 offset:256
    v_add_f32 v12, v12, v16
    v_mfma_f32_16x16x32_bf16 a[80:83], v[40:43], v[68:71], a[80:83]
    ds_read_b64_tr_b16 v[26:27], v3 offset:1296
    v_add_f32 v13, v13, v17
    v_mfma_f32_16x16x32_bf16 a[144:147], v[40:43], v[72:75], a[144:147]
    ds_read_b64_tr_b16 v[28:29], v3 offset:288
    v_mbcnt_lo_u32_b32 v0, -1, 0
    v_mfma_f32_16x16x32_bf16 a[208:211], v[40:43], v[76:79], a[208:211]
    ds_read_b64_tr_b16 v[30:31], v3 offset:1328
    v_mbcnt_hi_u32_b32 v0, -1, v0
    v_mfma_f32_16x16x32_bf16 a[20:23], v[44:47], v[64:67], a[20:23]
    ds_read_b64_tr_b16 v[32:33], v3 offset:320
    v_lshlrev_b32 v0, 4, v0
    v_mfma_f32_16x16x32_bf16 a[84:87], v[44:47], v[68:71], a[84:87]
    ds_read_b64_tr_b16 v[34:35], v3 offset:1360
    v_add_u32 v2, 16640, v1
    v_mfma_f32_16x16x32_bf16 a[148:151], v[44:47], v[72:75], a[148:151]
    ds_read_b64_tr_b16 v[36:37], v3 offset:352
    v_accvgpr_read_b32 v14, a0
    v_mfma_f32_16x16x32_bf16 a[212:215], v[44:47], v[76:79], a[212:215]
    ds_read_b64_tr_b16 v[38:39], v3 offset:1392
    v_accvgpr_read_b32 v15, a1
    v_mfma_f32_16x16x32_bf16 a[24:27], v[48:51], v[64:67], a[24:27]
    buffer_load_dwordx4 v4, s[20:23], s36 offen offset:0 nt lds
    v_mfma_f32_16x16x32_bf16 a[88:91], v[48:51], v[68:71], a[88:91]
    s_add_u32 s36, s44, 259056
    v_rcp_f32 v7, v11
    v_mfma_f32_16x16x32_bf16 a[152:155], v[48:51], v[72:75], a[152:155]
    buffer_load_dwordx4 v4, s[20:23], s36 offen offset:1040 nt lds
    v_mfma_f32_16x16x32_bf16 a[216:219], v[48:51], v[76:79], a[216:219]
    s_add_u32 s36, s44, 230240
    v_rcp_f32 v8, v12
    v_mfma_f32_16x16x32_bf16 a[28:31], v[52:55], v[64:67], a[28:31]
    buffer_load_dwordx4 v4, s[20:23], s36 offen offset:2080 nt lds
    v_mfma_f32_16x16x32_bf16 a[92:95], v[52:55], v[68:71], a[92:95]
    s_add_u32 s36, s44, 257872
    v_rcp_f32 v9, v13
    v_mfma_f32_16x16x32_bf16 a[156:159], v[52:55], v[72:75], a[156:159]
    v_accvgpr_read_b32 v16, a2
    v_accvgpr_read_b32 v17, a3
    v_mfma_f32_16x16x32_bf16 a[220:223], v[52:55], v[76:79], a[220:223]
    s_waitcnt lgkmcnt(0)
    v_accvgpr_read_b32 v18, a4
    v_accvgpr_read_b32 v19, a5
    v_mfma_f32_16x16x32_bf16 a[32:35], v[24:27], v[64:67], a[32:35]
    ds_read_b64_tr_b16 v[40:41], v3 offset:384
    v_accvgpr_read_b32 v20, a6
    v_mfma_f32_16x16x32_bf16 a[96:99], v[24:27], v[68:71], a[96:99]
    ds_read_b64_tr_b16 v[42:43], v3 offset:1424
    v_accvgpr_read_b32 v21, a7
    v_mfma_f32_16x16x32_bf16 a[160:163], v[24:27], v[72:75], a[160:163]
    ds_read_b64_tr_b16 v[44:45], v3 offset:416
    v_mul_f32 v14, v14, v6
    v_mfma_f32_16x16x32_bf16 a[224:227], v[24:27], v[76:79], a[224:227]
    ds_read_b64_tr_b16 v[46:47], v3 offset:1456
    v_mul_f32 v15, v15, v6
    v_mfma_f32_16x16x32_bf16 a[36:39], v[28:31], v[64:67], a[36:39]
    ds_read_b64_tr_b16 v[48:49], v3 offset:448
    v_mul_f32 v16, v16, v6
    v_mfma_f32_16x16x32_bf16 a[100:103], v[28:31], v[68:71], a[100:103]
    ds_read_b64_tr_b16 v[50:51], v3 offset:1488
    v_mul_f32 v17, v17, v6
    v_mfma_f32_16x16x32_bf16 a[164:167], v[28:31], v[72:75], a[164:167]
    ds_read_b64_tr_b16 v[52:53], v3 offset:480
    v_mul_f32 v18, v18, v6
    v_mfma_f32_16x16x32_bf16 a[228:231], v[28:31], v[76:79], a[228:231]
    ds_read_b64_tr_b16 v[54:55], v3 offset:1520
    v_mul_f32 v19, v19, v6
    v_mfma_f32_16x16x32_bf16 a[40:43], v[32:35], v[64:67], a[40:43]
    buffer_load_dwordx4 v4, s[20:23], s36 offen offset:3120 nt lds
    v_mfma_f32_16x16x32_bf16 a[104:107], v[32:35], v[68:71], a[104:107]
    s_add_u32 m0, s29, 116480
    v_mul_f32 v20, v20, v6
    v_mul_f32 v21, v21, v6
    v_mfma_f32_16x16x32_bf16 a[168:171], v[32:35], v[72:75], a[168:171]
    s_lshr_b32 s44, s62, 12
    v_cvt_pk_bf16_f32 v128, v14, v15
    v_cvt_pk_bf16_f32 v129, v16, v17
    v_mfma_f32_16x16x32_bf16 a[232:235], v[32:35], v[76:79], a[232:235]
    s_add_u32 s36, s44, 346112
    v_cvt_pk_bf16_f32 v130, v18, v19
    v_cvt_pk_bf16_f32 v131, v20, v21
    v_mfma_f32_16x16x32_bf16 a[44:47], v[36:39], v[64:67], a[44:47]
    buffer_load_dwordx4 v4, s[20:23], s36 offen offset:0 nt lds
    v_mfma_f32_16x16x32_bf16 a[108:111], v[36:39], v[68:71], a[108:111]
    s_add_u32 s36, s44, 373744
    v_accvgpr_read_b32 v56, a8
    v_accvgpr_read_b32 v57, a9
    v_mfma_f32_16x16x32_bf16 a[172:175], v[36:39], v[72:75], a[172:175]
    v_accvgpr_read_b32 v58, a10
    v_accvgpr_read_b32 v59, a11
    v_mfma_f32_16x16x32_bf16 a[236:239], v[36:39], v[76:79], a[236:239]
    s_waitcnt lgkmcnt(0)
    v_accvgpr_read_b32 v60, a12
    v_accvgpr_read_b32 v61, a13
    v_mfma_f32_16x16x32_bf16 a[48:51], v[40:43], v[64:67], a[48:51]
    ds_read_b64_tr_b16 v[24:25], v2 offset:0
    v_accvgpr_read_b32 v62, a14
    v_mfma_f32_16x16x32_bf16 a[112:115], v[40:43], v[68:71], a[112:115]
    ds_read_b64_tr_b16 v[26:27], v2 offset:128
    v_accvgpr_read_b32 v63, a15
    v_mfma_f32_16x16x32_bf16 a[176:179], v[40:43], v[72:75], a[176:179]
    ds_read_b64_tr_b16 v[28:29], v2 offset:1040
    v_mul_f32 v56, v56, v6
    v_mfma_f32_16x16x32_bf16 a[240:243], v[40:43], v[76:79], a[240:243]
    ds_read_b64_tr_b16 v[30:31], v2 offset:1168
    v_mul_f32 v57, v57, v6
    v_mfma_f32_16x16x32_bf16 a[52:55], v[44:47], v[64:67], a[52:55]
    ds_read_b64_tr_b16 v[32:33], v2 offset:256
    v_mul_f32 v58, v58, v6
    v_mfma_f32_16x16x32_bf16 a[116:119], v[44:47], v[68:71], a[116:119]
    ds_read_b64_tr_b16 v[34:35], v2 offset:384
    v_mul_f32 v59, v59, v6
    v_mfma_f32_16x16x32_bf16 a[180:183], v[44:47], v[72:75], a[180:183]
    ds_read_b64_tr_b16 v[36:37], v2 offset:1296
    v_mul_f32 v60, v60, v6
    v_mfma_f32_16x16x32_bf16 a[244:247], v[44:47], v[76:79], a[244:247]
    ds_read_b64_tr_b16 v[38:39], v2 offset:1424
    v_mul_f32 v61, v61, v6
    v_mfma_f32_16x16x32_bf16 a[56:59], v[48:51], v[64:67], a[56:59]
    buffer_load_dwordx4 v4, s[20:23], s36 offen offset:1040 nt lds
    v_mfma_f32_16x16x32_bf16 a[120:123], v[48:51], v[68:71], a[120:123]
    s_add_u32 s36, s44, 344928
    v_mul_f32 v62, v62, v6
    v_mul_f32 v63, v63, v6
    v_mfma_f32_16x16x32_bf16 a[184:187], v[48:51], v[72:75], a[184:187]
    buffer_load_dwordx4 v4, s[20:23], s36 offen offset:2080 nt lds
    v_mfma_f32_16x16x32_bf16 a[248:251], v[48:51], v[76:79], a[248:251]
    s_add_u32 s36, s44, 372560
    v_cvt_pk_bf16_f32 v136, v56, v57
    v_cvt_pk_bf16_f32 v137, v58, v59
    v_mfma_f32_16x16x32_bf16 a[60:63], v[52:55], v[64:67], a[60:63]
    buffer_load_dwordx4 v4, s[20:23], s36 offen offset:3120 nt lds
    v_mfma_f32_16x16x32_bf16 a[124:127], v[52:55], v[68:71], a[124:127]
    v_cvt_pk_bf16_f32 v138, v60, v61
    v_cvt_pk_bf16_f32 v139, v62, v63
    v_mfma_f32_16x16x32_bf16 a[188:191], v[52:55], v[72:75], a[188:191]
    v_accvgpr_read_b32 v14, a16
    v_accvgpr_read_b32 v15, a17
    v_mfma_f32_16x16x32_bf16 a[252:255], v[52:55], v[76:79], a[252:255]
    v_accvgpr_read_b32 v16, a18
    v_accvgpr_read_b32 v17, a19
    ds_read_b64_tr_b16 v[40:41], v2 offset:32
    ds_read_b64_tr_b16 v[42:43], v2 offset:160
    ds_read_b64_tr_b16 v[44:45], v2 offset:1072
    ds_read_b64_tr_b16 v[46:47], v2 offset:1200
    s_waitcnt lgkmcnt(8)
    v_mfma_f32_16x16x32_bf16 v[96:99], v[24:27], v[128:131], 0
    ds_read_b64_tr_b16 v[48:49], v2 offset:288
    ds_read_b64_tr_b16 v[50:51], v2 offset:416
    v_accvgpr_read_b32 v18, a20
    v_accvgpr_read_b32 v19, a21
    v_accvgpr_read_b32 v20, a22
    v_accvgpr_read_b32 v21, a23
    v_mul_f32 v14, v14, v6
    v_mul_f32 v15, v15, v6
    v_mul_f32 v16, v16, v6
    v_mul_f32 v17, v17, v6
    v_mul_f32 v18, v18, v6
    v_mul_f32 v19, v19, v6
    v_mul_f32 v20, v20, v6
    v_mul_f32 v21, v21, v6
    v_cvt_pk_bf16_f32 v144, v14, v15
    v_cvt_pk_bf16_f32 v145, v16, v17
    v_cvt_pk_bf16_f32 v146, v18, v19
    v_cvt_pk_bf16_f32 v147, v20, v21
    v_mfma_f32_16x16x32_bf16 v[96:99], v[28:31], v[136:139], v[96:99]
    s_waitcnt lgkmcnt(6)
    v_accvgpr_read_b32 v56, a24
    v_accvgpr_read_b32 v57, a25
    v_accvgpr_read_b32 v58, a26
    v_accvgpr_read_b32 v59, a27
    v_accvgpr_read_b32 v60, a28
    v_accvgpr_read_b32 v61, a29
    v_accvgpr_read_b32 v62, a30
    v_accvgpr_read_b32 v63, a31
    v_mul_f32 v56, v56, v6
    v_mul_f32 v57, v57, v6
    v_mul_f32 v58, v58, v6
    v_mul_f32 v59, v59, v6
    v_mul_f32 v60, v60, v6
    v_mul_f32 v61, v61, v6
    v_mul_f32 v62, v62, v6
    v_mul_f32 v63, v63, v6
    v_cvt_pk_bf16_f32 v152, v56, v57
    v_cvt_pk_bf16_f32 v153, v58, v59
    v_cvt_pk_bf16_f32 v154, v60, v61
    v_cvt_pk_bf16_f32 v155, v62, v63
    v_mfma_f32_16x16x32_bf16 v[96:99], v[32:35], v[144:147], v[96:99]
    ds_read_b64_tr_b16 v[52:53], v2 offset:1328
    ds_read_b64_tr_b16 v[54:55], v2 offset:1456
    v_accvgpr_read_b32 v14, a64
    v_accvgpr_read_b32 v15, a65
    v_accvgpr_read_b32 v16, a66
    v_accvgpr_read_b32 v17, a67
    v_accvgpr_read_b32 v18, a68
    v_accvgpr_read_b32 v19, a69
    v_accvgpr_read_b32 v20, a70
    v_accvgpr_read_b32 v21, a71
    v_mul_f32 v14, v14, v7
    v_mul_f32 v15, v15, v7
    v_mul_f32 v16, v16, v7
    v_mul_f32 v17, v17, v7
    v_mul_f32 v18, v18, v7
    v_mul_f32 v19, v19, v7
    v_mul_f32 v20, v20, v7
    v_mul_f32 v21, v21, v7
    v_cvt_pk_bf16_f32 v132, v14, v15
    v_cvt_pk_bf16_f32 v133, v16, v17
    v_cvt_pk_bf16_f32 v134, v18, v19
    v_cvt_pk_bf16_f32 v135, v20, v21
    v_mfma_f32_16x16x32_bf16 v[96:99], v[36:39], v[152:155], v[96:99]
    s_waitcnt vmcnt(16)
    s_barrier
    v_accvgpr_read_b32 v56, a72
    v_accvgpr_read_b32 v57, a73
    v_accvgpr_read_b32 v58, a74
    v_accvgpr_read_b32 v59, a75
    v_accvgpr_read_b32 v60, a76
    v_accvgpr_read_b32 v61, a77
    v_accvgpr_read_b32 v62, a78
    v_accvgpr_read_b32 v63, a79
    v_mul_f32 v56, v56, v7
    v_mul_f32 v57, v57, v7
    v_mul_f32 v58, v58, v7
    v_mul_f32 v59, v59, v7
    v_mul_f32 v60, v60, v7
    v_mul_f32 v61, v61, v7
    v_mul_f32 v62, v62, v7
    v_mul_f32 v63, v63, v7
    v_cvt_pk_bf16_f32 v140, v56, v57
    v_cvt_pk_bf16_f32 v141, v58, v59
    v_cvt_pk_bf16_f32 v142, v60, v61
    v_cvt_pk_bf16_f32 v143, v62, v63
    v_mfma_f32_16x16x32_bf16 v[100:103], v[24:27], v[132:135], 0
    ds_read_b64_tr_b16 v[24:25], v2 offset:64
    ds_read_b64_tr_b16 v[26:27], v2 offset:192
    v_accvgpr_read_b32 v14, a80
    v_accvgpr_read_b32 v15, a81
    v_accvgpr_read_b32 v16, a82
    v_accvgpr_read_b32 v17, a83
    v_accvgpr_read_b32 v18, a84
    v_accvgpr_read_b32 v19, a85
    v_accvgpr_read_b32 v20, a86
    v_accvgpr_read_b32 v21, a87
    v_mul_f32 v14, v14, v7
    v_mul_f32 v15, v15, v7
    v_mul_f32 v16, v16, v7
    v_mul_f32 v17, v17, v7
    v_mul_f32 v18, v18, v7
    v_mul_f32 v19, v19, v7
    v_mul_f32 v20, v20, v7
    v_mul_f32 v21, v21, v7
    v_cvt_pk_bf16_f32 v148, v14, v15
    v_cvt_pk_bf16_f32 v149, v16, v17
    v_cvt_pk_bf16_f32 v150, v18, v19
    v_cvt_pk_bf16_f32 v151, v20, v21
    v_mfma_f32_16x16x32_bf16 v[100:103], v[28:31], v[140:143], v[100:103]
    v_accvgpr_read_b32 v56, a88
    v_accvgpr_read_b32 v57, a89
    v_accvgpr_read_b32 v58, a90
    v_accvgpr_read_b32 v59, a91
    v_accvgpr_read_b32 v60, a92
    v_accvgpr_read_b32 v61, a93
    v_accvgpr_read_b32 v62, a94
    v_accvgpr_read_b32 v63, a95
    v_mul_f32 v56, v56, v7
    v_mul_f32 v57, v57, v7
    v_mul_f32 v58, v58, v7
    v_mul_f32 v59, v59, v7
    v_mul_f32 v60, v60, v7
    v_mul_f32 v61, v61, v7
    v_mul_f32 v62, v62, v7
    v_mul_f32 v63, v63, v7
    v_cvt_pk_bf16_f32 v156, v56, v57
    v_cvt_pk_bf16_f32 v157, v58, v59
    v_cvt_pk_bf16_f32 v158, v60, v61
    v_cvt_pk_bf16_f32 v159, v62, v63
    v_mfma_f32_16x16x32_bf16 v[100:103], v[32:35], v[148:151], v[100:103]
    ds_read_b64_tr_b16 v[28:29], v2 offset:1104
    ds_read_b64_tr_b16 v[30:31], v2 offset:1232
    v_mfma_f32_16x16x32_bf16 v[100:103], v[36:39], v[156:159], v[100:103]
    s_waitcnt lgkmcnt(8)
    v_accvgpr_read_b32 v14, a32
    v_accvgpr_read_b32 v15, a33
    v_mfma_f32_16x16x32_bf16 v[104:107], v[40:43], v[128:131], 0
    ds_read_b64_tr_b16 v[32:33], v2 offset:320
    ds_read_b64_tr_b16 v[34:35], v2 offset:448
    v_mfma_f32_16x16x32_bf16 v[104:107], v[44:47], v[136:139], v[104:107]
    s_waitcnt lgkmcnt(6)
    v_accvgpr_read_b32 v16, a34
    v_accvgpr_read_b32 v17, a35
    v_mfma_f32_16x16x32_bf16 v[104:107], v[48:51], v[144:147], v[104:107]
    ds_read_b64_tr_b16 v[36:37], v2 offset:1360
    ds_read_b64_tr_b16 v[38:39], v2 offset:1488
    v_mfma_f32_16x16x32_bf16 v[104:107], v[52:55], v[152:155], v[104:107]
    s_add_u32 m0, s29, 133120
    s_lshr_b32 s44, s63, 12
    v_accvgpr_read_b32 v18, a36
    v_mfma_f32_16x16x32_bf16 v[108:111], v[40:43], v[132:135], 0
    ds_read_b64_tr_b16 v[40:41], v2 offset:96
    ds_read_b64_tr_b16 v[42:43], v2 offset:224
    v_mfma_f32_16x16x32_bf16 v[108:111], v[44:47], v[140:143], v[108:111]
    s_add_u32 s36, s44, 346112
    v_accvgpr_read_b32 v19, a37
    v_accvgpr_read_b32 v20, a38
    v_mfma_f32_16x16x32_bf16 v[108:111], v[48:51], v[148:151], v[108:111]
    ds_read_b64_tr_b16 v[44:45], v2 offset:1136
    ds_read_b64_tr_b16 v[46:47], v2 offset:1264
    v_mfma_f32_16x16x32_bf16 v[108:111], v[52:55], v[156:159], v[108:111]
    s_waitcnt lgkmcnt(8)
    buffer_load_dwordx4 v4, s[20:23], s36 offen offset:0 nt lds
    v_mfma_f32_16x16x32_bf16 v[112:115], v[24:27], v[128:131], 0
    ds_read_b64_tr_b16 v[48:49], v2 offset:352
    ds_read_b64_tr_b16 v[50:51], v2 offset:480
    v_mfma_f32_16x16x32_bf16 v[112:115], v[28:31], v[136:139], v[112:115]
    s_waitcnt lgkmcnt(6)
    s_add_u32 s36, s44, 373744
    v_accvgpr_read_b32 v21, a39
    v_mfma_f32_16x16x32_bf16 v[112:115], v[32:35], v[144:147], v[112:115]
    ds_read_b64_tr_b16 v[52:53], v2 offset:1392
    ds_read_b64_tr_b16 v[54:55], v2 offset:1520
    v_mfma_f32_16x16x32_bf16 v[112:115], v[36:39], v[152:155], v[112:115]
    v_add_u32 v2, 33280, v1
    v_mul_f32 v14, v14, v6
    v_mfma_f32_16x16x32_bf16 v[116:119], v[24:27], v[132:135], 0
    ds_read_b64_tr_b16 v[24:25], v2 offset:0
    ds_read_b64_tr_b16 v[26:27], v2 offset:128
    v_mfma_f32_16x16x32_bf16 v[116:119], v[28:31], v[140:143], v[116:119]
    buffer_load_dwordx4 v4, s[20:23], s36 offen offset:1040 nt lds
    v_mfma_f32_16x16x32_bf16 v[116:119], v[32:35], v[148:151], v[116:119]
    ds_read_b64_tr_b16 v[28:29], v2 offset:1040
    ds_read_b64_tr_b16 v[30:31], v2 offset:1168
    v_mfma_f32_16x16x32_bf16 v[116:119], v[36:39], v[156:159], v[116:119]
    s_waitcnt lgkmcnt(8)
    s_add_u32 s36, s44, 344928
    v_mul_f32 v15, v15, v6
    v_mfma_f32_16x16x32_bf16 v[120:123], v[40:43], v[128:131], 0
    ds_read_b64_tr_b16 v[32:33], v2 offset:256
    ds_read_b64_tr_b16 v[34:35], v2 offset:384
    v_mfma_f32_16x16x32_bf16 v[120:123], v[44:47], v[136:139], v[120:123]
    s_waitcnt lgkmcnt(6)
    buffer_load_dwordx4 v4, s[20:23], s36 offen offset:2080 nt lds
    v_mfma_f32_16x16x32_bf16 v[120:123], v[48:51], v[144:147], v[120:123]
    ds_read_b64_tr_b16 v[36:37], v2 offset:1296
    ds_read_b64_tr_b16 v[38:39], v2 offset:1424
    v_mfma_f32_16x16x32_bf16 v[120:123], v[52:55], v[152:155], v[120:123]
    s_add_u32 s36, s44, 372560
    buffer_load_dwordx4 v4, s[20:23], s36 offen offset:3120 nt lds
    v_mfma_f32_16x16x32_bf16 v[124:127], v[40:43], v[132:135], 0
    ds_read_b64_tr_b16 v[40:41], v2 offset:32
    ds_read_b64_tr_b16 v[42:43], v2 offset:160
    v_mfma_f32_16x16x32_bf16 v[124:127], v[44:47], v[140:143], v[124:127]
    v_mul_f32 v16, v16, v6
    v_mul_f32 v17, v17, v6
    v_mfma_f32_16x16x32_bf16 v[124:127], v[48:51], v[148:151], v[124:127]
    ds_read_b64_tr_b16 v[44:45], v2 offset:1072
    ds_read_b64_tr_b16 v[46:47], v2 offset:1200
    v_mfma_f32_16x16x32_bf16 v[124:127], v[52:55], v[156:159], v[124:127]
    s_waitcnt lgkmcnt(8)
    v_mul_f32 v18, v18, v6
    v_mul_f32 v19, v19, v6
    v_mfma_f32_16x16x32_bf16 v[64:67], v[24:27], v[128:131], 0
    ds_read_b64_tr_b16 v[48:49], v2 offset:288
    ds_read_b64_tr_b16 v[50:51], v2 offset:416
    v_mfma_f32_16x16x32_bf16 v[64:67], v[28:31], v[136:139], v[64:67]
    s_waitcnt lgkmcnt(6)
    v_mul_f32 v20, v20, v6
    v_mul_f32 v21, v21, v6
    v_mfma_f32_16x16x32_bf16 v[64:67], v[32:35], v[144:147], v[64:67]
    ds_read_b64_tr_b16 v[52:53], v2 offset:1328
    ds_read_b64_tr_b16 v[54:55], v2 offset:1456
    v_mfma_f32_16x16x32_bf16 v[64:67], v[36:39], v[152:155], v[64:67]
    v_cvt_pk_bf16_f32 v160, v14, v15
    v_cvt_pk_bf16_f32 v161, v16, v17
    v_mfma_f32_16x16x32_bf16 v[68:71], v[24:27], v[132:135], 0
    ds_read_b64_tr_b16 v[24:25], v2 offset:64
    ds_read_b64_tr_b16 v[26:27], v2 offset:192
    v_mfma_f32_16x16x32_bf16 v[68:71], v[28:31], v[140:143], v[68:71]
    v_cvt_pk_bf16_f32 v162, v18, v19
    v_cvt_pk_bf16_f32 v163, v20, v21
    v_mfma_f32_16x16x32_bf16 v[68:71], v[32:35], v[148:151], v[68:71]
    ds_read_b64_tr_b16 v[28:29], v2 offset:1104
    ds_read_b64_tr_b16 v[30:31], v2 offset:1232
    v_mfma_f32_16x16x32_bf16 v[68:71], v[36:39], v[156:159], v[68:71]
    s_waitcnt lgkmcnt(8)
    v_accvgpr_read_b32 v56, a40
    v_accvgpr_read_b32 v57, a41
    v_mfma_f32_16x16x32_bf16 v[72:75], v[40:43], v[128:131], 0
    ds_read_b64_tr_b16 v[32:33], v2 offset:320
    ds_read_b64_tr_b16 v[34:35], v2 offset:448
    v_mfma_f32_16x16x32_bf16 v[72:75], v[44:47], v[136:139], v[72:75]
    s_waitcnt lgkmcnt(6)
    v_accvgpr_read_b32 v58, a42
    v_accvgpr_read_b32 v59, a43
    v_mfma_f32_16x16x32_bf16 v[72:75], v[48:51], v[144:147], v[72:75]
    ds_read_b64_tr_b16 v[36:37], v2 offset:1360
    ds_read_b64_tr_b16 v[38:39], v2 offset:1488
    v_mfma_f32_16x16x32_bf16 v[72:75], v[52:55], v[152:155], v[72:75]
    s_add_u32 m0, s29, 0
    s_lshr_b32 s44, s82, 12
    v_accvgpr_read_b32 v60, a44
    v_mfma_f32_16x16x32_bf16 v[76:79], v[40:43], v[132:135], 0
    ds_read_b64_tr_b16 v[40:41], v2 offset:96
    ds_read_b64_tr_b16 v[42:43], v2 offset:224
    v_mfma_f32_16x16x32_bf16 v[76:79], v[44:47], v[140:143], v[76:79]
    s_add_u32 s36, s44, 2048
    buffer_load_dwordx4 v4, s[20:23], s36 offen offset:0 nt lds
    v_mfma_f32_16x16x32_bf16 v[76:79], v[48:51], v[148:151], v[76:79]
    ds_read_b64_tr_b16 v[44:45], v2 offset:1136
    ds_read_b64_tr_b16 v[46:47], v2 offset:1264
    v_mfma_f32_16x16x32_bf16 v[76:79], v[52:55], v[156:159], v[76:79]
    s_waitcnt lgkmcnt(8)
    s_add_u32 s36, s44, 29680
    v_accvgpr_read_b32 v61, a45
    v_mfma_f32_16x16x32_bf16 v[80:83], v[24:27], v[128:131], 0
    ds_read_b64_tr_b16 v[48:49], v2 offset:352
    ds_read_b64_tr_b16 v[50:51], v2 offset:480
    v_mfma_f32_16x16x32_bf16 v[80:83], v[28:31], v[136:139], v[80:83]
    s_waitcnt lgkmcnt(6)
    buffer_load_dwordx4 v4, s[20:23], s36 offen offset:1040 nt lds
    v_mfma_f32_16x16x32_bf16 v[80:83], v[32:35], v[144:147], v[80:83]
    ds_read_b64_tr_b16 v[52:53], v2 offset:1392
    ds_read_b64_tr_b16 v[54:55], v2 offset:1520
    v_mfma_f32_16x16x32_bf16 v[80:83], v[36:39], v[152:155], v[80:83]
    s_add_u32 s36, s44, 864
    v_add_u32 v2, 49920, v1
    v_accvgpr_read_b32 v62, a46
    v_mfma_f32_16x16x32_bf16 v[84:87], v[24:27], v[132:135], 0
    ds_read_b64_tr_b16 v[24:25], v2 offset:0
    ds_read_b64_tr_b16 v[26:27], v2 offset:128
    v_mfma_f32_16x16x32_bf16 v[84:87], v[28:31], v[140:143], v[84:87]
    buffer_load_dwordx4 v4, s[20:23], s36 offen offset:2080 nt lds
    v_mfma_f32_16x16x32_bf16 v[84:87], v[32:35], v[148:151], v[84:87]
    ds_read_b64_tr_b16 v[28:29], v2 offset:1040
    ds_read_b64_tr_b16 v[30:31], v2 offset:1168
    v_mfma_f32_16x16x32_bf16 v[84:87], v[36:39], v[156:159], v[84:87]
    s_waitcnt lgkmcnt(8)
    s_add_u32 s36, s44, 28496
    v_accvgpr_read_b32 v63, a47
    v_mfma_f32_16x16x32_bf16 v[88:91], v[40:43], v[128:131], 0
    ds_read_b64_tr_b16 v[32:33], v2 offset:256
    ds_read_b64_tr_b16 v[34:35], v2 offset:384
    v_mfma_f32_16x16x32_bf16 v[88:91], v[44:47], v[136:139], v[88:91]
    s_waitcnt lgkmcnt(6)
    buffer_load_dwordx4 v4, s[20:23], s36 offen offset:3120 nt lds
    v_mfma_f32_16x16x32_bf16 v[88:91], v[48:51], v[144:147], v[88:91]
    ds_read_b64_tr_b16 v[36:37], v2 offset:1296
    ds_read_b64_tr_b16 v[38:39], v2 offset:1424
    v_mfma_f32_16x16x32_bf16 v[88:91], v[52:55], v[152:155], v[88:91]
    s_lshr_b32 s46, s2, 3
    s_lshl_b32 s47, s46, 12
    v_mul_f32 v56, v56, v6
    v_mfma_f32_16x16x32_bf16 v[92:95], v[40:43], v[132:135], 0
    ds_read_b64_tr_b16 v[40:41], v2 offset:32
    ds_read_b64_tr_b16 v[42:43], v2 offset:160
    v_mfma_f32_16x16x32_bf16 v[92:95], v[44:47], v[140:143], v[92:95]
    s_lshl_b32 s46, s28, 7
    s_add_u32 s47, s47, s46
    v_mul_f32 v57, v57, v6
    v_mfma_f32_16x16x32_bf16 v[92:95], v[48:51], v[148:151], v[92:95]
    ds_read_b64_tr_b16 v[44:45], v2 offset:1072
    ds_read_b64_tr_b16 v[46:47], v2 offset:1200
    s_add_u32 s47, s47, 33554432
    s_add_u32 s4, s84, s47
    s_addc_u32 s5, s85, 0
    s_mov_b32 s6, 3712
    s_mov_b32 s7, 0x20000
    v_mfma_f32_16x16x32_bf16 v[92:95], v[52:55], v[156:159], v[92:95]
    s_waitcnt lgkmcnt(8)
    v_mul_f32 v58, v58, v6
    v_mul_f32 v59, v59, v6
    v_mul_f32 v60, v60, v6
    v_mul_f32 v61, v61, v6
    v_mul_f32 v62, v62, v6
    v_mul_f32 v63, v63, v6
    v_cvt_pk_bf16_f32 v168, v56, v57
    v_cvt_pk_bf16_f32 v169, v58, v59
    v_cvt_pk_bf16_f32 v170, v60, v61
    v_cvt_pk_bf16_f32 v171, v62, v63
    v_mfma_f32_16x16x32_bf16 v[96:99], v[24:27], v[160:163], v[96:99]
    ds_read_b64_tr_b16 v[48:49], v2 offset:288
    ds_read_b64_tr_b16 v[50:51], v2 offset:416
    v_accvgpr_read_b32 v14, a48
    v_accvgpr_read_b32 v15, a49
    v_accvgpr_read_b32 v16, a50
    v_accvgpr_read_b32 v17, a51
    v_accvgpr_read_b32 v18, a52
    v_accvgpr_read_b32 v19, a53
    v_accvgpr_read_b32 v20, a54
    v_accvgpr_read_b32 v21, a55
    v_mul_f32 v14, v14, v6
    v_mul_f32 v15, v15, v6
    v_mul_f32 v16, v16, v6
    v_mul_f32 v17, v17, v6
    v_mul_f32 v18, v18, v6
    v_mul_f32 v19, v19, v6
    v_mul_f32 v20, v20, v6
    v_mul_f32 v21, v21, v6
    v_cvt_pk_bf16_f32 v176, v14, v15
    v_cvt_pk_bf16_f32 v177, v16, v17
    v_cvt_pk_bf16_f32 v178, v18, v19
    v_cvt_pk_bf16_f32 v179, v20, v21
    v_mfma_f32_16x16x32_bf16 v[96:99], v[28:31], v[168:171], v[96:99]
    s_waitcnt lgkmcnt(6)
    v_accvgpr_read_b32 v56, a56
    v_accvgpr_read_b32 v57, a57
    v_accvgpr_read_b32 v58, a58
    v_accvgpr_read_b32 v59, a59
    v_accvgpr_read_b32 v60, a60
    v_accvgpr_read_b32 v61, a61
    v_accvgpr_read_b32 v62, a62
    v_accvgpr_read_b32 v63, a63
    v_mul_f32 v56, v56, v6
    v_mul_f32 v57, v57, v6
    v_mul_f32 v58, v58, v6
    v_mul_f32 v59, v59, v6
    v_mul_f32 v60, v60, v6
    v_mul_f32 v61, v61, v6
    v_mul_f32 v62, v62, v6
    v_mul_f32 v63, v63, v6
    v_cvt_pk_bf16_f32 v184, v56, v57
    v_cvt_pk_bf16_f32 v185, v58, v59
    v_cvt_pk_bf16_f32 v186, v60, v61
    v_cvt_pk_bf16_f32 v187, v62, v63
    v_mfma_f32_16x16x32_bf16 v[96:99], v[32:35], v[176:179], v[96:99]
    ds_read_b64_tr_b16 v[52:53], v2 offset:1328
    ds_read_b64_tr_b16 v[54:55], v2 offset:1456
    v_accvgpr_read_b32 v14, a96
    v_accvgpr_read_b32 v15, a97
    v_accvgpr_read_b32 v16, a98
    v_accvgpr_read_b32 v17, a99
    v_accvgpr_read_b32 v18, a100
    v_accvgpr_read_b32 v19, a101
    v_accvgpr_read_b32 v20, a102
    v_accvgpr_read_b32 v21, a103
    v_mul_f32 v14, v14, v7
    v_mul_f32 v15, v15, v7
    v_mul_f32 v16, v16, v7
    v_mul_f32 v17, v17, v7
    v_mul_f32 v18, v18, v7
    v_mul_f32 v19, v19, v7
    v_mul_f32 v20, v20, v7
    v_mul_f32 v21, v21, v7
    v_cvt_pk_bf16_f32 v164, v14, v15
    v_cvt_pk_bf16_f32 v165, v16, v17
    v_cvt_pk_bf16_f32 v166, v18, v19
    v_cvt_pk_bf16_f32 v167, v20, v21
    v_mfma_f32_16x16x32_bf16 v[96:99], v[36:39], v[184:187], v[96:99]
    s_waitcnt vmcnt(16)
    s_barrier
    v_accvgpr_read_b32 v56, a104
    v_accvgpr_read_b32 v57, a105
    v_accvgpr_read_b32 v58, a106
    v_accvgpr_read_b32 v59, a107
    v_accvgpr_read_b32 v60, a108
    v_accvgpr_read_b32 v61, a109
    v_accvgpr_read_b32 v62, a110
    v_accvgpr_read_b32 v63, a111
    v_mul_f32 v56, v56, v7
    v_mul_f32 v57, v57, v7
    v_mul_f32 v58, v58, v7
    v_mul_f32 v59, v59, v7
    v_mul_f32 v60, v60, v7
    v_mul_f32 v61, v61, v7
    v_mul_f32 v62, v62, v7
    v_mul_f32 v63, v63, v7
    v_cvt_pk_bf16_f32 v172, v56, v57
    v_cvt_pk_bf16_f32 v173, v58, v59
    v_cvt_pk_bf16_f32 v174, v60, v61
    v_cvt_pk_bf16_f32 v175, v62, v63
    v_mfma_f32_16x16x32_bf16 v[100:103], v[24:27], v[164:167], v[100:103]
    ds_read_b64_tr_b16 v[24:25], v2 offset:64
    ds_read_b64_tr_b16 v[26:27], v2 offset:192
    v_accvgpr_read_b32 v14, a112
    v_accvgpr_read_b32 v15, a113
    v_accvgpr_read_b32 v16, a114
    v_accvgpr_read_b32 v17, a115
    v_accvgpr_read_b32 v18, a116
    v_accvgpr_read_b32 v19, a117
    v_accvgpr_read_b32 v20, a118
    v_accvgpr_read_b32 v21, a119
    v_mul_f32 v14, v14, v7
    v_mul_f32 v15, v15, v7
    v_mul_f32 v16, v16, v7
    v_mul_f32 v17, v17, v7
    v_mul_f32 v18, v18, v7
    v_mul_f32 v19, v19, v7
    v_mul_f32 v20, v20, v7
    v_mul_f32 v21, v21, v7
    v_cvt_pk_bf16_f32 v180, v14, v15
    v_cvt_pk_bf16_f32 v181, v16, v17
    v_cvt_pk_bf16_f32 v182, v18, v19
    v_cvt_pk_bf16_f32 v183, v20, v21
    v_mfma_f32_16x16x32_bf16 v[100:103], v[28:31], v[172:175], v[100:103]
    v_accvgpr_read_b32 v56, a120
    v_accvgpr_read_b32 v57, a121
    v_accvgpr_read_b32 v58, a122
    v_accvgpr_read_b32 v59, a123
    v_accvgpr_read_b32 v60, a124
    v_accvgpr_read_b32 v61, a125
    v_accvgpr_read_b32 v62, a126
    v_accvgpr_read_b32 v63, a127
    v_mul_f32 v56, v56, v7
    v_mul_f32 v57, v57, v7
    v_mul_f32 v58, v58, v7
    v_mul_f32 v59, v59, v7
    v_mul_f32 v60, v60, v7
    v_mul_f32 v61, v61, v7
    v_mul_f32 v62, v62, v7
    v_mul_f32 v63, v63, v7
    v_cvt_pk_bf16_f32 v188, v56, v57
    v_cvt_pk_bf16_f32 v189, v58, v59
    v_cvt_pk_bf16_f32 v190, v60, v61
    v_cvt_pk_bf16_f32 v191, v62, v63
    v_mfma_f32_16x16x32_bf16 v[100:103], v[32:35], v[180:183], v[100:103]
    ds_read_b64_tr_b16 v[28:29], v2 offset:1104
    ds_read_b64_tr_b16 v[30:31], v2 offset:1232
    v_mfma_f32_16x16x32_bf16 v[100:103], v[36:39], v[188:191], v[100:103]
    s_waitcnt lgkmcnt(8)
    v_accvgpr_read_b32 v14, a128
    v_accvgpr_read_b32 v15, a129
    v_mfma_f32_16x16x32_bf16 v[104:107], v[40:43], v[160:163], v[104:107]
    ds_read_b64_tr_b16 v[32:33], v2 offset:320
    ds_read_b64_tr_b16 v[34:35], v2 offset:448
    v_mfma_f32_16x16x32_bf16 v[104:107], v[44:47], v[168:171], v[104:107]
    s_waitcnt lgkmcnt(6)
    v_accvgpr_read_b32 v16, a130
    v_accvgpr_read_b32 v17, a131
    v_mfma_f32_16x16x32_bf16 v[104:107], v[48:51], v[176:179], v[104:107]
    ds_read_b64_tr_b16 v[36:37], v2 offset:1360
    ds_read_b64_tr_b16 v[38:39], v2 offset:1488
    v_mfma_f32_16x16x32_bf16 v[104:107], v[52:55], v[184:187], v[104:107]
    s_add_u32 m0, s29, 16640
    s_lshr_b32 s44, s82, 12
    v_accvgpr_read_b32 v18, a132
    v_mfma_f32_16x16x32_bf16 v[108:111], v[40:43], v[164:167], v[108:111]
    ds_read_b64_tr_b16 v[40:41], v2 offset:96
    ds_read_b64_tr_b16 v[42:43], v2 offset:224
    v_mfma_f32_16x16x32_bf16 v[108:111], v[44:47], v[172:175], v[108:111]
    s_add_u32 s36, s44, 116736
    buffer_load_dwordx4 v4, s[20:23], s36 offen offset:0 nt lds
    v_mfma_f32_16x16x32_bf16 v[108:111], v[48:51], v[180:183], v[108:111]
    ds_read_b64_tr_b16 v[44:45], v2 offset:1136
    ds_read_b64_tr_b16 v[46:47], v2 offset:1264
    v_mfma_f32_16x16x32_bf16 v[108:111], v[52:55], v[188:191], v[108:111]
    s_waitcnt lgkmcnt(8)
    s_add_u32 s36, s44, 144368
    v_accvgpr_read_b32 v19, a133
    v_mfma_f32_16x16x32_bf16 v[112:115], v[24:27], v[160:163], v[112:115]
    ds_read_b64_tr_b16 v[48:49], v2 offset:352
    ds_read_b64_tr_b16 v[50:51], v2 offset:480
    v_mfma_f32_16x16x32_bf16 v[112:115], v[28:31], v[168:171], v[112:115]
    s_waitcnt lgkmcnt(6)
    buffer_load_dwordx4 v4, s[20:23], s36 offen offset:1040 nt lds
    v_mfma_f32_16x16x32_bf16 v[112:115], v[32:35], v[176:179], v[112:115]
    ds_read_b64_tr_b16 v[52:53], v2 offset:1392
    ds_read_b64_tr_b16 v[54:55], v2 offset:1520
    v_mfma_f32_16x16x32_bf16 v[112:115], v[36:39], v[184:187], v[112:115]
    s_add_u32 s36, s44, 115552
    v_add_u32 v2, 66560, v1
    v_accvgpr_read_b32 v20, a134
    v_mfma_f32_16x16x32_bf16 v[116:119], v[24:27], v[164:167], v[116:119]
    ds_read_b64_tr_b16 v[24:25], v2 offset:0
    ds_read_b64_tr_b16 v[26:27], v2 offset:128
    v_mfma_f32_16x16x32_bf16 v[116:119], v[28:31], v[172:175], v[116:119]
    buffer_load_dwordx4 v4, s[20:23], s36 offen offset:2080 nt lds
    v_mfma_f32_16x16x32_bf16 v[116:119], v[32:35], v[180:183], v[116:119]
    ds_read_b64_tr_b16 v[28:29], v2 offset:1040
    ds_read_b64_tr_b16 v[30:31], v2 offset:1168
    v_mfma_f32_16x16x32_bf16 v[116:119], v[36:39], v[188:191], v[116:119]
    s_waitcnt lgkmcnt(8)
    s_add_u32 s36, s44, 143184
    v_accvgpr_read_b32 v21, a135
    v_mfma_f32_16x16x32_bf16 v[120:123], v[40:43], v[160:163], v[120:123]
    ds_read_b64_tr_b16 v[32:33], v2 offset:256
    ds_read_b64_tr_b16 v[34:35], v2 offset:384
    v_mfma_f32_16x16x32_bf16 v[120:123], v[44:47], v[168:171], v[120:123]
    s_waitcnt lgkmcnt(6)
    buffer_load_dwordx4 v4, s[20:23], s36 offen offset:3120 nt lds
    v_mfma_f32_16x16x32_bf16 v[120:123], v[48:51], v[176:179], v[120:123]
    ds_read_b64_tr_b16 v[36:37], v2 offset:1296
    ds_read_b64_tr_b16 v[38:39], v2 offset:1424
    v_mfma_f32_16x16x32_bf16 v[120:123], v[52:55], v[184:187], v[120:123]
    s_cmp_eq_u32 s3, 7
    s_cselect_b32 s32, 114688, 0
    v_mul_f32 v14, v14, v8
    v_mfma_f32_16x16x32_bf16 v[124:127], v[40:43], v[164:167], v[124:127]
    ds_read_b64_tr_b16 v[40:41], v2 offset:32
    ds_read_b64_tr_b16 v[42:43], v2 offset:160
    v_mfma_f32_16x16x32_bf16 v[124:127], v[44:47], v[172:175], v[124:127]
    s_cselect_b32 s33, 0, 16384
    s_cselect_b32 s40, -1, 768
    v_mul_f32 v15, v15, v8
    v_mfma_f32_16x16x32_bf16 v[124:127], v[48:51], v[180:183], v[124:127]
    ds_read_b64_tr_b16 v[44:45], v2 offset:1072
    ds_read_b64_tr_b16 v[46:47], v2 offset:1200
    s_cselect_b32 s61, -1, 0x40
    s_lshl_b32 s41, s3, 9
    s_lshl_b32 s60, s3, 17
    v_mfma_f32_16x16x32_bf16 v[124:127], v[52:55], v[188:191], v[124:127]
    s_waitcnt lgkmcnt(8)
    v_mul_f32 v16, v16, v8
    v_mul_f32 v17, v17, v8
    v_mfma_f32_16x16x32_bf16 v[64:67], v[24:27], v[160:163], v[64:67]
    ds_read_b64_tr_b16 v[48:49], v2 offset:288
    ds_read_b64_tr_b16 v[50:51], v2 offset:416
    v_mfma_f32_16x16x32_bf16 v[64:67], v[28:31], v[168:171], v[64:67]
    s_waitcnt lgkmcnt(6)
    v_mul_f32 v18, v18, v8
    v_mul_f32 v19, v19, v8
    v_mfma_f32_16x16x32_bf16 v[64:67], v[32:35], v[176:179], v[64:67]
    ds_read_b64_tr_b16 v[52:53], v2 offset:1328
    ds_read_b64_tr_b16 v[54:55], v2 offset:1456
    v_mfma_f32_16x16x32_bf16 v[64:67], v[36:39], v[184:187], v[64:67]
    v_mul_f32 v20, v20, v8
    v_mul_f32 v21, v21, v8
    v_mfma_f32_16x16x32_bf16 v[68:71], v[24:27], v[164:167], v[68:71]
    ds_read_b64_tr_b16 v[24:25], v2 offset:64
    ds_read_b64_tr_b16 v[26:27], v2 offset:192
    v_mfma_f32_16x16x32_bf16 v[68:71], v[28:31], v[172:175], v[68:71]
    v_cvt_pk_bf16_f32 v192, v14, v15
    v_cvt_pk_bf16_f32 v193, v16, v17
    v_mfma_f32_16x16x32_bf16 v[68:71], v[32:35], v[180:183], v[68:71]
    ds_read_b64_tr_b16 v[28:29], v2 offset:1104
    ds_read_b64_tr_b16 v[30:31], v2 offset:1232
    v_mfma_f32_16x16x32_bf16 v[68:71], v[36:39], v[188:191], v[68:71]
    s_waitcnt lgkmcnt(8)
    v_cvt_pk_bf16_f32 v194, v18, v19
    v_cvt_pk_bf16_f32 v195, v20, v21
    v_mfma_f32_16x16x32_bf16 v[72:75], v[40:43], v[160:163], v[72:75]
    ds_read_b64_tr_b16 v[32:33], v2 offset:320
    ds_read_b64_tr_b16 v[34:35], v2 offset:448
    v_mfma_f32_16x16x32_bf16 v[72:75], v[44:47], v[168:171], v[72:75]
    s_waitcnt lgkmcnt(6)
    v_accvgpr_read_b32 v56, a136
    v_accvgpr_read_b32 v57, a137
    v_mfma_f32_16x16x32_bf16 v[72:75], v[48:51], v[176:179], v[72:75]
    ds_read_b64_tr_b16 v[36:37], v2 offset:1360
    ds_read_b64_tr_b16 v[38:39], v2 offset:1488
    v_mfma_f32_16x16x32_bf16 v[72:75], v[52:55], v[184:187], v[72:75]
    s_add_u32 m0, s29, 33280
    s_lshr_b32 s44, s82, 12
    v_accvgpr_read_b32 v58, a138
    v_mfma_f32_16x16x32_bf16 v[76:79], v[40:43], v[164:167], v[76:79]
    ds_read_b64_tr_b16 v[40:41], v2 offset:96
    ds_read_b64_tr_b16 v[42:43], v2 offset:224
    v_mfma_f32_16x16x32_bf16 v[76:79], v[44:47], v[172:175], v[76:79]
    s_add_u32 s36, s44, 231424
    buffer_load_dwordx4 v4, s[20:23], s36 offen offset:0 nt lds
    v_mfma_f32_16x16x32_bf16 v[76:79], v[48:51], v[180:183], v[76:79]
    ds_read_b64_tr_b16 v[44:45], v2 offset:1136
    ds_read_b64_tr_b16 v[46:47], v2 offset:1264
    v_mfma_f32_16x16x32_bf16 v[76:79], v[52:55], v[188:191], v[76:79]
    s_waitcnt lgkmcnt(8)
    s_add_u32 s36, s44, 259056
    v_accvgpr_read_b32 v59, a139
    v_mfma_f32_16x16x32_bf16 v[80:83], v[24:27], v[160:163], v[80:83]
    ds_read_b64_tr_b16 v[48:49], v2 offset:352
    ds_read_b64_tr_b16 v[50:51], v2 offset:480
    v_mfma_f32_16x16x32_bf16 v[80:83], v[28:31], v[168:171], v[80:83]
    s_waitcnt lgkmcnt(6)
    buffer_load_dwordx4 v4, s[20:23], s36 offen offset:1040 nt lds
    v_mfma_f32_16x16x32_bf16 v[80:83], v[32:35], v[176:179], v[80:83]
    ds_read_b64_tr_b16 v[52:53], v2 offset:1392
    ds_read_b64_tr_b16 v[54:55], v2 offset:1520
    v_mfma_f32_16x16x32_bf16 v[80:83], v[36:39], v[184:187], v[80:83]
    s_add_u32 s36, s44, 230240
    v_add_u32 v2, 83200, v1
    v_accvgpr_read_b32 v60, a140
    v_mfma_f32_16x16x32_bf16 v[84:87], v[24:27], v[164:167], v[84:87]
    ds_read_b64_tr_b16 v[24:25], v2 offset:0
    ds_read_b64_tr_b16 v[26:27], v2 offset:128
    v_mfma_f32_16x16x32_bf16 v[84:87], v[28:31], v[172:175], v[84:87]
    buffer_load_dwordx4 v4, s[20:23], s36 offen offset:2080 nt lds
    v_mfma_f32_16x16x32_bf16 v[84:87], v[32:35], v[180:183], v[84:87]
    ds_read_b64_tr_b16 v[28:29], v2 offset:1040
    ds_read_b64_tr_b16 v[30:31], v2 offset:1168
    v_mfma_f32_16x16x32_bf16 v[84:87], v[36:39], v[188:191], v[84:87]
    s_waitcnt lgkmcnt(8)
    s_add_u32 s36, s44, 257872
    v_accvgpr_read_b32 v61, a141
    v_mfma_f32_16x16x32_bf16 v[88:91], v[40:43], v[160:163], v[88:91]
    ds_read_b64_tr_b16 v[32:33], v2 offset:256
    ds_read_b64_tr_b16 v[34:35], v2 offset:384
    v_mfma_f32_16x16x32_bf16 v[88:91], v[44:47], v[168:171], v[88:91]
    s_waitcnt lgkmcnt(6)
    buffer_load_dwordx4 v4, s[20:23], s36 offen offset:3120 nt lds
    v_mfma_f32_16x16x32_bf16 v[88:91], v[48:51], v[176:179], v[88:91]
    ds_read_b64_tr_b16 v[36:37], v2 offset:1296
    ds_read_b64_tr_b16 v[38:39], v2 offset:1424
    v_mfma_f32_16x16x32_bf16 v[88:91], v[52:55], v[184:187], v[88:91]
    s_mov_b32 s12, s88
    s_mov_b32 s13, s89
    v_accvgpr_read_b32 v62, a142
    v_mfma_f32_16x16x32_bf16 v[92:95], v[40:43], v[164:167], v[92:95]
    ds_read_b64_tr_b16 v[40:41], v2 offset:32
    ds_read_b64_tr_b16 v[42:43], v2 offset:160
    v_mfma_f32_16x16x32_bf16 v[92:95], v[44:47], v[172:175], v[92:95]
    s_mov_b32 s14, 256
    s_mov_b32 s15, 0x20000
    v_accvgpr_read_b32 v63, a143
    v_mfma_f32_16x16x32_bf16 v[92:95], v[48:51], v[180:183], v[92:95]
    ds_read_b64_tr_b16 v[44:45], v2 offset:1072
    ds_read_b64_tr_b16 v[46:47], v2 offset:1200
    s_mov_b32 s16, s86
    s_mov_b32 s17, s87
    s_mov_b32 s18, 3670016
    s_mov_b32 s19, 0x20000
    v_mfma_f32_16x16x32_bf16 v[92:95], v[52:55], v[188:191], v[92:95]
    s_waitcnt lgkmcnt(8)
    v_mul_f32 v56, v56, v8
    v_mul_f32 v57, v57, v8
    v_mul_f32 v58, v58, v8
    v_mul_f32 v59, v59, v8
    v_mul_f32 v60, v60, v8
    v_mul_f32 v61, v61, v8
    v_mul_f32 v62, v62, v8
    v_mul_f32 v63, v63, v8
    v_cvt_pk_bf16_f32 v200, v56, v57
    v_cvt_pk_bf16_f32 v201, v58, v59
    v_cvt_pk_bf16_f32 v202, v60, v61
    v_cvt_pk_bf16_f32 v203, v62, v63
    v_mfma_f32_16x16x32_bf16 v[96:99], v[24:27], v[192:195], v[96:99]
    ds_read_b64_tr_b16 v[48:49], v2 offset:288
    ds_read_b64_tr_b16 v[50:51], v2 offset:416
    v_accvgpr_read_b32 v14, a144
    v_accvgpr_read_b32 v15, a145
    v_accvgpr_read_b32 v16, a146
    v_accvgpr_read_b32 v17, a147
    v_accvgpr_read_b32 v18, a148
    v_accvgpr_read_b32 v19, a149
    v_accvgpr_read_b32 v20, a150
    v_accvgpr_read_b32 v21, a151
    v_mul_f32 v14, v14, v8
    v_mul_f32 v15, v15, v8
    v_mul_f32 v16, v16, v8
    v_mul_f32 v17, v17, v8
    v_mul_f32 v18, v18, v8
    v_mul_f32 v19, v19, v8
    v_mul_f32 v20, v20, v8
    v_mul_f32 v21, v21, v8
    v_cvt_pk_bf16_f32 v208, v14, v15
    v_cvt_pk_bf16_f32 v209, v16, v17
    v_cvt_pk_bf16_f32 v210, v18, v19
    v_cvt_pk_bf16_f32 v211, v20, v21
    v_mfma_f32_16x16x32_bf16 v[96:99], v[28:31], v[200:203], v[96:99]
    s_waitcnt lgkmcnt(6)
    v_accvgpr_read_b32 v56, a152
    v_accvgpr_read_b32 v57, a153
    v_accvgpr_read_b32 v58, a154
    v_accvgpr_read_b32 v59, a155
    v_accvgpr_read_b32 v60, a156
    v_accvgpr_read_b32 v61, a157
    v_accvgpr_read_b32 v62, a158
    v_accvgpr_read_b32 v63, a159
    v_mul_f32 v56, v56, v8
    v_mul_f32 v57, v57, v8
    v_mul_f32 v58, v58, v8
    v_mul_f32 v59, v59, v8
    v_mul_f32 v60, v60, v8
    v_mul_f32 v61, v61, v8
    v_mul_f32 v62, v62, v8
    v_mul_f32 v63, v63, v8
    v_cvt_pk_bf16_f32 v216, v56, v57
    v_cvt_pk_bf16_f32 v217, v58, v59
    v_cvt_pk_bf16_f32 v218, v60, v61
    v_cvt_pk_bf16_f32 v219, v62, v63
    v_mfma_f32_16x16x32_bf16 v[96:99], v[32:35], v[208:211], v[96:99]
    ds_read_b64_tr_b16 v[52:53], v2 offset:1328
    ds_read_b64_tr_b16 v[54:55], v2 offset:1456
    v_accvgpr_read_b32 v14, a192
    v_accvgpr_read_b32 v15, a193
    v_accvgpr_read_b32 v16, a194
    v_accvgpr_read_b32 v17, a195
    v_accvgpr_read_b32 v18, a196
    v_accvgpr_read_b32 v19, a197
    v_accvgpr_read_b32 v20, a198
    v_accvgpr_read_b32 v21, a199
    v_mul_f32 v14, v14, v9
    v_mul_f32 v15, v15, v9
    v_mul_f32 v16, v16, v9
    v_mul_f32 v17, v17, v9
    v_mul_f32 v18, v18, v9
    v_mul_f32 v19, v19, v9
    v_mul_f32 v20, v20, v9
    v_mul_f32 v21, v21, v9
    v_cvt_pk_bf16_f32 v196, v14, v15
    v_cvt_pk_bf16_f32 v197, v16, v17
    v_cvt_pk_bf16_f32 v198, v18, v19
    v_cvt_pk_bf16_f32 v199, v20, v21
    v_mfma_f32_16x16x32_bf16 v[96:99], v[36:39], v[216:219], v[96:99]
    s_waitcnt vmcnt(16)
    s_barrier
    v_accvgpr_read_b32 v56, a200
    v_accvgpr_read_b32 v57, a201
    v_accvgpr_read_b32 v58, a202
    v_accvgpr_read_b32 v59, a203
    v_accvgpr_read_b32 v60, a204
    v_accvgpr_read_b32 v61, a205
    v_accvgpr_read_b32 v62, a206
    v_accvgpr_read_b32 v63, a207
    v_mul_f32 v56, v56, v9
    v_mul_f32 v57, v57, v9
    v_mul_f32 v58, v58, v9
    v_mul_f32 v59, v59, v9
    v_mul_f32 v60, v60, v9
    v_mul_f32 v61, v61, v9
    v_mul_f32 v62, v62, v9
    v_mul_f32 v63, v63, v9
    v_cvt_pk_bf16_f32 v204, v56, v57
    v_cvt_pk_bf16_f32 v205, v58, v59
    v_cvt_pk_bf16_f32 v206, v60, v61
    v_cvt_pk_bf16_f32 v207, v62, v63
    v_mfma_f32_16x16x32_bf16 v[100:103], v[24:27], v[196:199], v[100:103]
    ds_read_b64_tr_b16 v[24:25], v2 offset:64
    ds_read_b64_tr_b16 v[26:27], v2 offset:192
    v_accvgpr_read_b32 v14, a208
    v_accvgpr_read_b32 v15, a209
    v_accvgpr_read_b32 v16, a210
    v_accvgpr_read_b32 v17, a211
    v_accvgpr_read_b32 v18, a212
    v_accvgpr_read_b32 v19, a213
    v_accvgpr_read_b32 v20, a214
    v_accvgpr_read_b32 v21, a215
    v_mul_f32 v14, v14, v9
    v_mul_f32 v15, v15, v9
    v_mul_f32 v16, v16, v9
    v_mul_f32 v17, v17, v9
    v_mul_f32 v18, v18, v9
    v_mul_f32 v19, v19, v9
    v_mul_f32 v20, v20, v9
    v_mul_f32 v21, v21, v9
    v_cvt_pk_bf16_f32 v212, v14, v15
    v_cvt_pk_bf16_f32 v213, v16, v17
    v_cvt_pk_bf16_f32 v214, v18, v19
    v_cvt_pk_bf16_f32 v215, v20, v21
    v_mfma_f32_16x16x32_bf16 v[100:103], v[28:31], v[204:207], v[100:103]
    v_accvgpr_read_b32 v56, a216
    v_accvgpr_read_b32 v57, a217
    v_accvgpr_read_b32 v58, a218
    v_accvgpr_read_b32 v59, a219
    v_accvgpr_read_b32 v60, a220
    v_accvgpr_read_b32 v61, a221
    v_accvgpr_read_b32 v62, a222
    v_accvgpr_read_b32 v63, a223
    v_mul_f32 v56, v56, v9
    v_mul_f32 v57, v57, v9
    v_mul_f32 v58, v58, v9
    v_mul_f32 v59, v59, v9
    v_mul_f32 v60, v60, v9
    v_mul_f32 v61, v61, v9
    v_mul_f32 v62, v62, v9
    v_mul_f32 v63, v63, v9
    v_cvt_pk_bf16_f32 v220, v56, v57
    v_cvt_pk_bf16_f32 v221, v58, v59
    v_cvt_pk_bf16_f32 v222, v60, v61
    v_cvt_pk_bf16_f32 v223, v62, v63
    v_mfma_f32_16x16x32_bf16 v[100:103], v[32:35], v[212:215], v[100:103]
    ds_read_b64_tr_b16 v[28:29], v2 offset:1104
    ds_read_b64_tr_b16 v[30:31], v2 offset:1232
    v_mfma_f32_16x16x32_bf16 v[100:103], v[36:39], v[220:223], v[100:103]
    s_waitcnt lgkmcnt(8)
    v_accvgpr_read_b32 v14, a160
    v_accvgpr_read_b32 v15, a161
    v_mfma_f32_16x16x32_bf16 v[104:107], v[40:43], v[192:195], v[104:107]
    ds_read_b64_tr_b16 v[32:33], v2 offset:320
    ds_read_b64_tr_b16 v[34:35], v2 offset:448
    v_mfma_f32_16x16x32_bf16 v[104:107], v[44:47], v[200:203], v[104:107]
    s_waitcnt lgkmcnt(6)
    v_accvgpr_read_b32 v16, a162
    v_accvgpr_read_b32 v17, a163
    v_mfma_f32_16x16x32_bf16 v[104:107], v[48:51], v[208:211], v[104:107]
    ds_read_b64_tr_b16 v[36:37], v2 offset:1360
    ds_read_b64_tr_b16 v[38:39], v2 offset:1488
    v_mfma_f32_16x16x32_bf16 v[104:107], v[52:55], v[216:219], v[104:107]
    s_add_u32 m0, s29, 49920
    s_lshr_b32 s44, s82, 12
    v_accvgpr_read_b32 v18, a164
    v_mfma_f32_16x16x32_bf16 v[108:111], v[40:43], v[196:199], v[108:111]
    ds_read_b64_tr_b16 v[40:41], v2 offset:96
    ds_read_b64_tr_b16 v[42:43], v2 offset:224
    v_mfma_f32_16x16x32_bf16 v[108:111], v[44:47], v[204:207], v[108:111]
    s_add_u32 s36, s44, 346112
    v_accvgpr_read_b32 v19, a165
    v_accvgpr_read_b32 v20, a166
    v_mfma_f32_16x16x32_bf16 v[108:111], v[48:51], v[212:215], v[108:111]
    ds_read_b64_tr_b16 v[44:45], v2 offset:1136
    ds_read_b64_tr_b16 v[46:47], v2 offset:1264
    v_mfma_f32_16x16x32_bf16 v[108:111], v[52:55], v[220:223], v[108:111]
    s_waitcnt lgkmcnt(8)
    buffer_load_dwordx4 v4, s[20:23], s36 offen offset:0 nt lds
    v_mfma_f32_16x16x32_bf16 v[112:115], v[24:27], v[192:195], v[112:115]
    ds_read_b64_tr_b16 v[48:49], v2 offset:352
    ds_read_b64_tr_b16 v[50:51], v2 offset:480
    v_mfma_f32_16x16x32_bf16 v[112:115], v[28:31], v[200:203], v[112:115]
    s_waitcnt lgkmcnt(6)
    s_add_u32 s36, s44, 373744
    v_accvgpr_read_b32 v21, a167
    v_mfma_f32_16x16x32_bf16 v[112:115], v[32:35], v[208:211], v[112:115]
    ds_read_b64_tr_b16 v[52:53], v2 offset:1392
    ds_read_b64_tr_b16 v[54:55], v2 offset:1520
    v_mfma_f32_16x16x32_bf16 v[112:115], v[36:39], v[216:219], v[112:115]
    v_add_u32 v2, 99840, v1
    v_mul_f32 v14, v14, v8
    v_mfma_f32_16x16x32_bf16 v[116:119], v[24:27], v[196:199], v[116:119]
    ds_read_b64_tr_b16 v[24:25], v2 offset:0
    ds_read_b64_tr_b16 v[26:27], v2 offset:128
    v_mfma_f32_16x16x32_bf16 v[116:119], v[28:31], v[204:207], v[116:119]
    buffer_load_dwordx4 v4, s[20:23], s36 offen offset:1040 nt lds
    v_mfma_f32_16x16x32_bf16 v[116:119], v[32:35], v[212:215], v[116:119]
    ds_read_b64_tr_b16 v[28:29], v2 offset:1040
    ds_read_b64_tr_b16 v[30:31], v2 offset:1168
    v_mfma_f32_16x16x32_bf16 v[116:119], v[36:39], v[220:223], v[116:119]
    s_waitcnt lgkmcnt(8)
    s_add_u32 s36, s44, 344928
    v_mul_f32 v15, v15, v8
    v_mfma_f32_16x16x32_bf16 v[120:123], v[40:43], v[192:195], v[120:123]
    ds_read_b64_tr_b16 v[32:33], v2 offset:256
    ds_read_b64_tr_b16 v[34:35], v2 offset:384
    v_mfma_f32_16x16x32_bf16 v[120:123], v[44:47], v[200:203], v[120:123]
    s_waitcnt lgkmcnt(6)
    buffer_load_dwordx4 v4, s[20:23], s36 offen offset:2080 nt lds
    v_mfma_f32_16x16x32_bf16 v[120:123], v[48:51], v[208:211], v[120:123]
    ds_read_b64_tr_b16 v[36:37], v2 offset:1296
    ds_read_b64_tr_b16 v[38:39], v2 offset:1424
    v_mfma_f32_16x16x32_bf16 v[120:123], v[52:55], v[216:219], v[120:123]
    s_add_u32 s36, s44, 372560
    buffer_load_dwordx4 v4, s[20:23], s36 offen offset:3120 nt lds
    v_mfma_f32_16x16x32_bf16 v[124:127], v[40:43], v[196:199], v[124:127]
    ds_read_b64_tr_b16 v[40:41], v2 offset:32
    ds_read_b64_tr_b16 v[42:43], v2 offset:160
    v_mfma_f32_16x16x32_bf16 v[124:127], v[44:47], v[204:207], v[124:127]
    s_mov_b32 s8, s24
    s_mov_b32 s9, s25
    v_mul_f32 v16, v16, v8
    v_mfma_f32_16x16x32_bf16 v[124:127], v[48:51], v[212:215], v[124:127]
    ds_read_b64_tr_b16 v[44:45], v2 offset:1072
    ds_read_b64_tr_b16 v[46:47], v2 offset:1200
    s_mov_b32 s10, 0
    s_mov_b32 s11, 0x20000
    v_mfma_f32_16x16x32_bf16 v[124:127], v[52:55], v[220:223], v[124:127]
    s_waitcnt lgkmcnt(8)
    v_mul_f32 v17, v17, v8
    v_mul_f32 v18, v18, v8
    v_mfma_f32_16x16x32_bf16 v[64:67], v[24:27], v[192:195], v[64:67]
    ds_read_b64_tr_b16 v[48:49], v2 offset:288
    ds_read_b64_tr_b16 v[50:51], v2 offset:416
    v_mfma_f32_16x16x32_bf16 v[64:67], v[28:31], v[200:203], v[64:67]
    s_waitcnt lgkmcnt(6)
    v_mul_f32 v19, v19, v8
    v_mul_f32 v20, v20, v8
    v_mfma_f32_16x16x32_bf16 v[64:67], v[32:35], v[208:211], v[64:67]
    ds_read_b64_tr_b16 v[52:53], v2 offset:1328
    ds_read_b64_tr_b16 v[54:55], v2 offset:1456
    v_mfma_f32_16x16x32_bf16 v[64:67], v[36:39], v[216:219], v[64:67]
    v_mul_f32 v21, v21, v8
    v_cvt_pk_bf16_f32 v224, v14, v15
    v_mfma_f32_16x16x32_bf16 v[68:71], v[24:27], v[196:199], v[68:71]
    ds_read_b64_tr_b16 v[24:25], v2 offset:64
    ds_read_b64_tr_b16 v[26:27], v2 offset:192
    v_mfma_f32_16x16x32_bf16 v[68:71], v[28:31], v[204:207], v[68:71]
    v_cvt_pk_bf16_f32 v225, v16, v17
    v_cvt_pk_bf16_f32 v226, v18, v19
    v_mfma_f32_16x16x32_bf16 v[68:71], v[32:35], v[212:215], v[68:71]
    ds_read_b64_tr_b16 v[28:29], v2 offset:1104
    ds_read_b64_tr_b16 v[30:31], v2 offset:1232
    v_mfma_f32_16x16x32_bf16 v[68:71], v[36:39], v[220:223], v[68:71]
    s_waitcnt lgkmcnt(8)
    v_cvt_pk_bf16_f32 v227, v20, v21
    v_accvgpr_read_b32 v56, a168
    v_mfma_f32_16x16x32_bf16 v[72:75], v[40:43], v[192:195], v[72:75]
    ds_read_b64_tr_b16 v[32:33], v2 offset:320
    ds_read_b64_tr_b16 v[34:35], v2 offset:448
    v_mfma_f32_16x16x32_bf16 v[72:75], v[44:47], v[200:203], v[72:75]
    s_waitcnt lgkmcnt(6)
    v_accvgpr_read_b32 v57, a169
    v_accvgpr_read_b32 v58, a170
    v_mfma_f32_16x16x32_bf16 v[72:75], v[48:51], v[208:211], v[72:75]
    ds_read_b64_tr_b16 v[36:37], v2 offset:1360
    ds_read_b64_tr_b16 v[38:39], v2 offset:1488
    v_mfma_f32_16x16x32_bf16 v[72:75], v[52:55], v[216:219], v[72:75]
    s_add_u32 m0, s29, 66560
    s_lshr_b32 s44, s83, 12
    v_accvgpr_read_b32 v59, a171
    v_mfma_f32_16x16x32_bf16 v[76:79], v[40:43], v[196:199], v[76:79]
    ds_read_b64_tr_b16 v[40:41], v2 offset:96
    ds_read_b64_tr_b16 v[42:43], v2 offset:224
    v_mfma_f32_16x16x32_bf16 v[76:79], v[44:47], v[204:207], v[76:79]
    s_add_u32 s36, s44, 2048
    buffer_load_dwordx4 v4, s[20:23], s36 offen offset:0 nt lds
    v_mfma_f32_16x16x32_bf16 v[76:79], v[48:51], v[212:215], v[76:79]
    ds_read_b64_tr_b16 v[44:45], v2 offset:1136
    ds_read_b64_tr_b16 v[46:47], v2 offset:1264
    v_mfma_f32_16x16x32_bf16 v[76:79], v[52:55], v[220:223], v[76:79]
    s_waitcnt lgkmcnt(8)
    s_add_u32 s36, s44, 29680
    v_accvgpr_read_b32 v60, a172
    v_mfma_f32_16x16x32_bf16 v[80:83], v[24:27], v[192:195], v[80:83]
    ds_read_b64_tr_b16 v[48:49], v2 offset:352
    ds_read_b64_tr_b16 v[50:51], v2 offset:480
    v_mfma_f32_16x16x32_bf16 v[80:83], v[28:31], v[200:203], v[80:83]
    s_waitcnt lgkmcnt(6)
    buffer_load_dwordx4 v4, s[20:23], s36 offen offset:1040 nt lds
    v_mfma_f32_16x16x32_bf16 v[80:83], v[32:35], v[208:211], v[80:83]
    ds_read_b64_tr_b16 v[52:53], v2 offset:1392
    ds_read_b64_tr_b16 v[54:55], v2 offset:1520
    v_mfma_f32_16x16x32_bf16 v[80:83], v[36:39], v[216:219], v[80:83]
    s_add_u32 s36, s44, 864
    v_add_u32 v2, 116480, v1
    v_accvgpr_read_b32 v61, a173
    v_mfma_f32_16x16x32_bf16 v[84:87], v[24:27], v[196:199], v[84:87]
    ds_read_b64_tr_b16 v[24:25], v2 offset:0
    ds_read_b64_tr_b16 v[26:27], v2 offset:128
    v_mfma_f32_16x16x32_bf16 v[84:87], v[28:31], v[204:207], v[84:87]
    buffer_load_dwordx4 v4, s[20:23], s36 offen offset:2080 nt lds
    v_mfma_f32_16x16x32_bf16 v[84:87], v[32:35], v[212:215], v[84:87]
    ds_read_b64_tr_b16 v[28:29], v2 offset:1040
    ds_read_b64_tr_b16 v[30:31], v2 offset:1168
    v_mfma_f32_16x16x32_bf16 v[84:87], v[36:39], v[220:223], v[84:87]
    s_waitcnt lgkmcnt(8)
    s_add_u32 s36, s44, 28496
    v_accvgpr_read_b32 v62, a174
    v_mfma_f32_16x16x32_bf16 v[88:91], v[40:43], v[192:195], v[88:91]
    ds_read_b64_tr_b16 v[32:33], v2 offset:256
    ds_read_b64_tr_b16 v[34:35], v2 offset:384
    v_mfma_f32_16x16x32_bf16 v[88:91], v[44:47], v[200:203], v[88:91]
    s_waitcnt lgkmcnt(6)
    buffer_load_dwordx4 v4, s[20:23], s36 offen offset:3120 nt lds
    v_mfma_f32_16x16x32_bf16 v[88:91], v[48:51], v[208:211], v[88:91]
    ds_read_b64_tr_b16 v[36:37], v2 offset:1296
    ds_read_b64_tr_b16 v[38:39], v2 offset:1424
    v_mfma_f32_16x16x32_bf16 v[88:91], v[52:55], v[216:219], v[88:91]
    s_lshr_b32 s30, s62, 2
    s_add_u32 s30, s30, s32
    v_accvgpr_read_b32 v63, a175
    v_mfma_f32_16x16x32_bf16 v[92:95], v[40:43], v[196:199], v[92:95]
    ds_read_b64_tr_b16 v[40:41], v2 offset:32
    ds_read_b64_tr_b16 v[42:43], v2 offset:160
    v_mfma_f32_16x16x32_bf16 v[92:95], v[44:47], v[204:207], v[92:95]
    s_add_u32 s32, s32, s33
    s_lshr_b32 s31, s63, 2
    v_mul_f32 v56, v56, v8
    v_mfma_f32_16x16x32_bf16 v[92:95], v[48:51], v[212:215], v[92:95]
    ds_read_b64_tr_b16 v[44:45], v2 offset:1072
    ds_read_b64_tr_b16 v[46:47], v2 offset:1200
    s_add_u32 s31, s31, s32
    s_add_u32 s32, s32, s33
    v_mfma_f32_16x16x32_bf16 v[92:95], v[52:55], v[220:223], v[92:95]
    s_waitcnt lgkmcnt(8)
    v_mul_f32 v57, v57, v8
    v_mul_f32 v58, v58, v8
    v_mul_f32 v59, v59, v8
    v_mul_f32 v60, v60, v8
    v_mul_f32 v61, v61, v8
    v_mul_f32 v62, v62, v8
    v_mul_f32 v63, v63, v8
    v_cvt_pk_bf16_f32 v232, v56, v57
    v_cvt_pk_bf16_f32 v233, v58, v59
    v_cvt_pk_bf16_f32 v234, v60, v61
    v_cvt_pk_bf16_f32 v235, v62, v63
    v_mfma_f32_16x16x32_bf16 v[96:99], v[24:27], v[224:227], v[96:99]
    ds_read_b64_tr_b16 v[48:49], v2 offset:288
    ds_read_b64_tr_b16 v[50:51], v2 offset:416
    v_accvgpr_read_b32 v14, a176
    v_accvgpr_read_b32 v15, a177
    v_accvgpr_read_b32 v16, a178
    v_accvgpr_read_b32 v17, a179
    v_accvgpr_read_b32 v18, a180
    v_accvgpr_read_b32 v19, a181
    v_accvgpr_read_b32 v20, a182
    v_accvgpr_read_b32 v21, a183
    v_mul_f32 v14, v14, v8
    v_mul_f32 v15, v15, v8
    v_mul_f32 v16, v16, v8
    v_mul_f32 v17, v17, v8
    v_mul_f32 v18, v18, v8
    v_mul_f32 v19, v19, v8
    v_mul_f32 v20, v20, v8
    v_mul_f32 v21, v21, v8
    v_cvt_pk_bf16_f32 v240, v14, v15
    v_cvt_pk_bf16_f32 v241, v16, v17
    v_cvt_pk_bf16_f32 v242, v18, v19
    v_cvt_pk_bf16_f32 v243, v20, v21
    v_mfma_f32_16x16x32_bf16 v[96:99], v[28:31], v[232:235], v[96:99]
    s_waitcnt lgkmcnt(6)
    v_accvgpr_read_b32 v56, a184
    v_accvgpr_read_b32 v57, a185
    v_accvgpr_read_b32 v58, a186
    v_accvgpr_read_b32 v59, a187
    v_accvgpr_read_b32 v60, a188
    v_accvgpr_read_b32 v61, a189
    v_accvgpr_read_b32 v62, a190
    v_accvgpr_read_b32 v63, a191
    v_mul_f32 v56, v56, v8
    v_mul_f32 v57, v57, v8
    v_mul_f32 v58, v58, v8
    v_mul_f32 v59, v59, v8
    v_mul_f32 v60, v60, v8
    v_mul_f32 v61, v61, v8
    v_mul_f32 v62, v62, v8
    v_mul_f32 v63, v63, v8
    v_cvt_pk_bf16_f32 v248, v56, v57
    v_cvt_pk_bf16_f32 v249, v58, v59
    v_cvt_pk_bf16_f32 v250, v60, v61
    v_cvt_pk_bf16_f32 v251, v62, v63
    v_mfma_f32_16x16x32_bf16 v[96:99], v[32:35], v[240:243], v[96:99]
    ds_read_b64_tr_b16 v[52:53], v2 offset:1328
    ds_read_b64_tr_b16 v[54:55], v2 offset:1456
    v_accvgpr_read_b32 v14, a224
    v_accvgpr_read_b32 v15, a225
    v_accvgpr_read_b32 v16, a226
    v_accvgpr_read_b32 v17, a227
    v_accvgpr_read_b32 v18, a228
    v_accvgpr_read_b32 v19, a229
    v_accvgpr_read_b32 v20, a230
    v_accvgpr_read_b32 v21, a231
    v_mul_f32 v14, v14, v9
    v_mul_f32 v15, v15, v9
    v_mul_f32 v16, v16, v9
    v_mul_f32 v17, v17, v9
    v_mul_f32 v18, v18, v9
    v_mul_f32 v19, v19, v9
    v_mul_f32 v20, v20, v9
    v_mul_f32 v21, v21, v9
    v_cvt_pk_bf16_f32 v228, v14, v15
    v_cvt_pk_bf16_f32 v229, v16, v17
    v_cvt_pk_bf16_f32 v230, v18, v19
    v_cvt_pk_bf16_f32 v231, v20, v21
    v_mfma_f32_16x16x32_bf16 v[96:99], v[36:39], v[248:251], v[96:99]
    s_waitcnt vmcnt(16)
    s_barrier
    v_accvgpr_read_b32 v56, a232
    v_accvgpr_read_b32 v57, a233
    v_accvgpr_read_b32 v58, a234
    v_accvgpr_read_b32 v59, a235
    v_accvgpr_read_b32 v60, a236
    v_accvgpr_read_b32 v61, a237
    v_accvgpr_read_b32 v62, a238
    v_accvgpr_read_b32 v63, a239
    v_mul_f32 v56, v56, v9
    v_mul_f32 v57, v57, v9
    v_mul_f32 v58, v58, v9
    v_mul_f32 v59, v59, v9
    v_mul_f32 v60, v60, v9
    v_mul_f32 v61, v61, v9
    v_mul_f32 v62, v62, v9
    v_mul_f32 v63, v63, v9
    v_cvt_pk_bf16_f32 v236, v56, v57
    v_cvt_pk_bf16_f32 v237, v58, v59
    v_cvt_pk_bf16_f32 v238, v60, v61
    v_cvt_pk_bf16_f32 v239, v62, v63
    v_mfma_f32_16x16x32_bf16 v[100:103], v[24:27], v[228:231], v[100:103]
    ds_read_b64_tr_b16 v[24:25], v2 offset:64
    ds_read_b64_tr_b16 v[26:27], v2 offset:192
    v_accvgpr_read_b32 v14, a240
    v_accvgpr_read_b32 v15, a241
    v_accvgpr_read_b32 v16, a242
    v_accvgpr_read_b32 v17, a243
    v_accvgpr_read_b32 v18, a244
    v_accvgpr_read_b32 v19, a245
    v_accvgpr_read_b32 v20, a246
    v_accvgpr_read_b32 v21, a247
    v_mul_f32 v14, v14, v9
    v_mul_f32 v15, v15, v9
    v_mul_f32 v16, v16, v9
    v_mul_f32 v17, v17, v9
    v_mul_f32 v18, v18, v9
    v_mul_f32 v19, v19, v9
    v_mul_f32 v20, v20, v9
    v_mul_f32 v21, v21, v9
    v_cvt_pk_bf16_f32 v244, v14, v15
    v_cvt_pk_bf16_f32 v245, v16, v17
    v_cvt_pk_bf16_f32 v246, v18, v19
    v_cvt_pk_bf16_f32 v247, v20, v21
    v_mfma_f32_16x16x32_bf16 v[100:103], v[28:31], v[236:239], v[100:103]
    v_accvgpr_read_b32 v56, a248
    v_accvgpr_read_b32 v57, a249
    v_accvgpr_read_b32 v58, a250
    v_accvgpr_read_b32 v59, a251
    v_accvgpr_read_b32 v60, a252
    v_accvgpr_read_b32 v61, a253
    v_accvgpr_read_b32 v62, a254
    v_accvgpr_read_b32 v63, a255
    v_mul_f32 v56, v56, v9
    v_mul_f32 v57, v57, v9
    v_mul_f32 v58, v58, v9
    v_mul_f32 v59, v59, v9
    v_mul_f32 v60, v60, v9
    v_mul_f32 v61, v61, v9
    v_mul_f32 v62, v62, v9
    v_mul_f32 v63, v63, v9
    v_cvt_pk_bf16_f32 v252, v56, v57
    v_cvt_pk_bf16_f32 v253, v58, v59
    v_cvt_pk_bf16_f32 v254, v60, v61
    v_cvt_pk_bf16_f32 v255, v62, v63
    v_mfma_f32_16x16x32_bf16 v[100:103], v[32:35], v[244:247], v[100:103]
    ds_read_b64_tr_b16 v[28:29], v2 offset:1104
    ds_read_b64_tr_b16 v[30:31], v2 offset:1232
    v_mfma_f32_16x16x32_bf16 v[100:103], v[36:39], v[252:255], v[100:103]
    s_waitcnt lgkmcnt(8)
    v_mfma_f32_16x16x32_bf16 v[104:107], v[40:43], v[224:227], v[104:107]
    ds_read_b64_tr_b16 v[32:33], v2 offset:320
    ds_read_b64_tr_b16 v[34:35], v2 offset:448
    v_mfma_f32_16x16x32_bf16 v[104:107], v[44:47], v[232:235], v[104:107]
    s_waitcnt lgkmcnt(6)
    v_mfma_f32_16x16x32_bf16 v[104:107], v[48:51], v[240:243], v[104:107]
    ds_read_b64_tr_b16 v[36:37], v2 offset:1360
    ds_read_b64_tr_b16 v[38:39], v2 offset:1488
    v_mfma_f32_16x16x32_bf16 v[104:107], v[52:55], v[248:251], v[104:107]
    s_add_u32 m0, s29, 83200
    s_lshr_b32 s44, s83, 12
    v_mfma_f32_16x16x32_bf16 v[108:111], v[40:43], v[228:231], v[108:111]
    ds_read_b64_tr_b16 v[40:41], v2 offset:96
    ds_read_b64_tr_b16 v[42:43], v2 offset:224
    v_mfma_f32_16x16x32_bf16 v[108:111], v[44:47], v[236:239], v[108:111]
    s_add_u32 s36, s44, 116736
    buffer_load_dwordx4 v4, s[20:23], s36 offen offset:0 nt lds
    v_mfma_f32_16x16x32_bf16 v[108:111], v[48:51], v[244:247], v[108:111]
    ds_read_b64_tr_b16 v[44:45], v2 offset:1136
    ds_read_b64_tr_b16 v[46:47], v2 offset:1264
    v_mfma_f32_16x16x32_bf16 v[108:111], v[52:55], v[252:255], v[108:111]
    s_waitcnt lgkmcnt(8)
    s_add_u32 s36, s44, 144368
    v_cvt_pk_bf16_f32 v56, v96, v97
    v_mfma_f32_16x16x32_bf16 v[112:115], v[24:27], v[224:227], v[112:115]
    ds_read_b64_tr_b16 v[48:49], v2 offset:352
    ds_read_b64_tr_b16 v[50:51], v2 offset:480
    v_mfma_f32_16x16x32_bf16 v[112:115], v[28:31], v[232:235], v[112:115]
    s_waitcnt lgkmcnt(6)
    buffer_load_dwordx4 v4, s[20:23], s36 offen offset:1040 nt lds
    v_mfma_f32_16x16x32_bf16 v[112:115], v[32:35], v[240:243], v[112:115]
    ds_read_b64_tr_b16 v[52:53], v2 offset:1392
    ds_read_b64_tr_b16 v[54:55], v2 offset:1520
    v_mfma_f32_16x16x32_bf16 v[112:115], v[36:39], v[248:251], v[112:115]
    s_add_u32 s36, s44, 115552
    v_add_u32 v2, 133120, v1
    v_cvt_pk_bf16_f32 v57, v98, v99
    v_mfma_f32_16x16x32_bf16 v[116:119], v[24:27], v[228:231], v[116:119]
    ds_read_b64_tr_b16 v[24:25], v2 offset:0
    ds_read_b64_tr_b16 v[26:27], v2 offset:128
    v_mfma_f32_16x16x32_bf16 v[116:119], v[28:31], v[236:239], v[116:119]
    buffer_load_dwordx4 v4, s[20:23], s36 offen offset:2080 nt lds
    v_mfma_f32_16x16x32_bf16 v[116:119], v[32:35], v[244:247], v[116:119]
    ds_read_b64_tr_b16 v[28:29], v2 offset:1040
    ds_read_b64_tr_b16 v[30:31], v2 offset:1168
    v_mfma_f32_16x16x32_bf16 v[116:119], v[36:39], v[252:255], v[116:119]
    s_waitcnt lgkmcnt(8)
    s_add_u32 s36, s44, 143184
    v_cvt_pk_bf16_f32 v58, v104, v105
    v_mfma_f32_16x16x32_bf16 v[120:123], v[40:43], v[224:227], v[120:123]
    ds_read_b64_tr_b16 v[32:33], v2 offset:256
    ds_read_b64_tr_b16 v[34:35], v2 offset:384
    v_mfma_f32_16x16x32_bf16 v[120:123], v[44:47], v[232:235], v[120:123]
    s_waitcnt lgkmcnt(6)
    buffer_load_dwordx4 v4, s[20:23], s36 offen offset:3120 nt lds
    v_mfma_f32_16x16x32_bf16 v[120:123], v[48:51], v[240:243], v[120:123]
    ds_read_b64_tr_b16 v[36:37], v2 offset:1296
    ds_read_b64_tr_b16 v[38:39], v2 offset:1424
    v_mfma_f32_16x16x32_bf16 v[120:123], v[52:55], v[248:251], v[120:123]
    s_lshr_b32 s55, s30, 17
    s_lshl_b32 s55, s55, 9
    v_cvt_pk_bf16_f32 v59, v106, v107
    v_mfma_f32_16x16x32_bf16 v[124:127], v[40:43], v[228:231], v[124:127]
    ds_read_b64_tr_b16 v[40:41], v2 offset:32
    ds_read_b64_tr_b16 v[42:43], v2 offset:160
    v_mfma_f32_16x16x32_bf16 v[124:127], v[44:47], v[236:239], v[124:127]
    s_bfe_u32 s46, s30, 0x3000e
    s_lshl_b32 s46, s46, 2
    buffer_store_dwordx4 v[56:59], v0, s[24:27], s30 offen offset:0 sc1
    v_mfma_f32_16x16x32_bf16 v[124:127], v[48:51], v[244:247], v[124:127]
    ds_read_b64_tr_b16 v[44:45], v2 offset:1072
    ds_read_b64_tr_b16 v[46:47], v2 offset:1200
    s_add_u32 s55, s55, s46
    v_mfma_f32_16x16x32_bf16 v[124:127], v[52:55], v[252:255], v[124:127]
    s_waitcnt lgkmcnt(8)
    v_cvt_pk_bf16_f32 v60, v100, v101
    v_cvt_pk_bf16_f32 v61, v102, v103
    v_mfma_f32_16x16x32_bf16 v[64:67], v[24:27], v[224:227], v[64:67]
    ds_read_b64_tr_b16 v[48:49], v2 offset:288
    ds_read_b64_tr_b16 v[50:51], v2 offset:416
    v_mfma_f32_16x16x32_bf16 v[64:67], v[28:31], v[232:235], v[64:67]
    s_waitcnt lgkmcnt(6)
    v_cvt_pk_bf16_f32 v62, v108, v109
    v_cvt_pk_bf16_f32 v63, v110, v111
    v_mfma_f32_16x16x32_bf16 v[64:67], v[32:35], v[240:243], v[64:67]
    ds_read_b64_tr_b16 v[52:53], v2 offset:1328
    ds_read_b64_tr_b16 v[54:55], v2 offset:1456
    v_mfma_f32_16x16x32_bf16 v[64:67], v[36:39], v[248:251], v[64:67]
    buffer_store_dwordx4 v[60:63], v0, s[24:27], s30 offen offset:2048 sc1
    v_mfma_f32_16x16x32_bf16 v[68:71], v[24:27], v[228:231], v[68:71]
    ds_read_b64_tr_b16 v[24:25], v2 offset:64
    ds_read_b64_tr_b16 v[26:27], v2 offset:192
    v_mfma_f32_16x16x32_bf16 v[68:71], v[28:31], v[236:239], v[68:71]
    v_cvt_pk_bf16_f32 v56, v112, v113
    v_cvt_pk_bf16_f32 v57, v114, v115
    v_mfma_f32_16x16x32_bf16 v[68:71], v[32:35], v[244:247], v[68:71]
    ds_read_b64_tr_b16 v[28:29], v2 offset:1104
    ds_read_b64_tr_b16 v[30:31], v2 offset:1232
    v_mfma_f32_16x16x32_bf16 v[68:71], v[36:39], v[252:255], v[68:71]
    s_waitcnt lgkmcnt(8)
    v_cvt_pk_bf16_f32 v58, v120, v121
    v_cvt_pk_bf16_f32 v59, v122, v123
    v_mfma_f32_16x16x32_bf16 v[72:75], v[40:43], v[224:227], v[72:75]
    ds_read_b64_tr_b16 v[32:33], v2 offset:320
    ds_read_b64_tr_b16 v[34:35], v2 offset:448
    buffer_store_dwordx4 v[56:59], v0, s[24:27], s30 offen offset:1024 sc1
    v_cvt_pk_bf16_f32 v60, v116, v117
    v_cvt_pk_bf16_f32 v61, v118, v119
    v_cvt_pk_bf16_f32 v62, v124, v125
    v_cvt_pk_bf16_f32 v63, v126, v127
    buffer_store_dwordx4 v[60:63], v0, s[24:27], s30 offen offset:3072 sc1
    v_mfma_f32_16x16x32_bf16 v[72:75], v[44:47], v[232:235], v[72:75]
    s_waitcnt lgkmcnt(6)
    v_lshrrev_b32 v20, 2, v0
    v_min_u32 v20, 28, v20
    v_mfma_f32_16x16x32_bf16 v[72:75], v[48:51], v[240:243], v[72:75]
    ds_read_b64_tr_b16 v[36:37], v2 offset:1360
    ds_read_b64_tr_b16 v[38:39], v2 offset:1488
    v_mfma_f32_16x16x32_bf16 v[72:75], v[52:55], v[248:251], v[72:75]
    s_add_u32 m0, s29, 99840
    s_lshr_b32 s44, s83, 12
    v_mov_b32 v19, 1
    v_mfma_f32_16x16x32_bf16 v[76:79], v[40:43], v[228:231], v[76:79]
    ds_read_b64_tr_b16 v[40:41], v2 offset:96
    ds_read_b64_tr_b16 v[42:43], v2 offset:224
    v_mfma_f32_16x16x32_bf16 v[76:79], v[44:47], v[236:239], v[76:79]
    s_add_u32 s36, s44, 231424
    v_cvt_pk_bf16_f32 v56, v64, v65
    v_cvt_pk_bf16_f32 v57, v66, v67
    v_mfma_f32_16x16x32_bf16 v[76:79], v[48:51], v[244:247], v[76:79]
    ds_read_b64_tr_b16 v[44:45], v2 offset:1136
    ds_read_b64_tr_b16 v[46:47], v2 offset:1264
    v_mfma_f32_16x16x32_bf16 v[76:79], v[52:55], v[252:255], v[76:79]
    s_waitcnt lgkmcnt(8)
    buffer_load_dwordx4 v4, s[20:23], s36 offen offset:0 nt lds
    v_mfma_f32_16x16x32_bf16 v[80:83], v[24:27], v[224:227], v[80:83]
    ds_read_b64_tr_b16 v[48:49], v2 offset:352
    ds_read_b64_tr_b16 v[50:51], v2 offset:480
    v_mfma_f32_16x16x32_bf16 v[80:83], v[28:31], v[232:235], v[80:83]
    s_waitcnt lgkmcnt(6)
    s_add_u32 s36, s44, 259056
    v_cvt_pk_bf16_f32 v58, v72, v73
    v_mfma_f32_16x16x32_bf16 v[80:83], v[32:35], v[240:243], v[80:83]
    ds_read_b64_tr_b16 v[52:53], v2 offset:1392
    ds_read_b64_tr_b16 v[54:55], v2 offset:1520
    v_mfma_f32_16x16x32_bf16 v[80:83], v[36:39], v[248:251], v[80:83]
    v_add_u32 v2, 0, v1
    v_cvt_pk_bf16_f32 v59, v74, v75
    v_mfma_f32_16x16x32_bf16 v[84:87], v[24:27], v[228:231], v[84:87]
    ds_read_b64_tr_b16 v[24:25], v2 offset:0
    ds_read_b64_tr_b16 v[26:27], v2 offset:128
    v_mfma_f32_16x16x32_bf16 v[84:87], v[28:31], v[236:239], v[84:87]
    buffer_load_dwordx4 v4, s[20:23], s36 offen offset:1040 nt lds
    v_mfma_f32_16x16x32_bf16 v[84:87], v[32:35], v[244:247], v[84:87]
    ds_read_b64_tr_b16 v[28:29], v2 offset:1040
    ds_read_b64_tr_b16 v[30:31], v2 offset:1168
    v_mfma_f32_16x16x32_bf16 v[84:87], v[36:39], v[252:255], v[84:87]
    s_waitcnt lgkmcnt(8)
    s_add_u32 s36, s44, 230240
    buffer_store_dwordx4 v[56:59], v0, s[24:27], s31 offen offset:0 sc1
    v_mfma_f32_16x16x32_bf16 v[88:91], v[40:43], v[224:227], v[88:91]
    ds_read_b64_tr_b16 v[32:33], v2 offset:256
    ds_read_b64_tr_b16 v[34:35], v2 offset:384
    v_mfma_f32_16x16x32_bf16 v[88:91], v[44:47], v[232:235], v[88:91]
    s_waitcnt lgkmcnt(6)
    buffer_load_dwordx4 v4, s[20:23], s36 offen offset:2080 nt lds
    v_mfma_f32_16x16x32_bf16 v[88:91], v[48:51], v[240:243], v[88:91]
    ds_read_b64_tr_b16 v[36:37], v2 offset:1296
    ds_read_b64_tr_b16 v[38:39], v2 offset:1424
    v_mfma_f32_16x16x32_bf16 v[88:91], v[52:55], v[248:251], v[88:91]
    s_add_u32 s36, s44, 257872
    buffer_load_dwordx4 v4, s[20:23], s36 offen offset:3120 nt lds
    v_mfma_f32_16x16x32_bf16 v[92:95], v[40:43], v[228:231], v[92:95]
    ds_read_b64_tr_b16 v[40:41], v2 offset:32
    ds_read_b64_tr_b16 v[42:43], v2 offset:160
    v_mfma_f32_16x16x32_bf16 v[92:95], v[44:47], v[236:239], v[92:95]
    s_lshr_b32 s30, s82, 2
    s_add_u32 s30, s30, s32
    v_cvt_pk_bf16_f32 v60, v68, v69
    v_mfma_f32_16x16x32_bf16 v[92:95], v[48:51], v[244:247], v[92:95]
    ds_read_b64_tr_b16 v[44:45], v2 offset:1072
    ds_read_b64_tr_b16 v[46:47], v2 offset:1200
    v_cvt_pk_bf16_f32 v61, v70, v71
    v_cvt_pk_bf16_f32 v62, v76, v77
    v_cvt_pk_bf16_f32 v63, v78, v79
    buffer_store_dwordx4 v[60:63], v0, s[24:27], s31 offen offset:2048 sc1
    v_mfma_f32_16x16x32_bf16 v[92:95], v[52:55], v[252:255], v[92:95]
    s_waitcnt lgkmcnt(8)
    s_mov_b32 s39, 256
    v_lshrrev_b32 v14, 4, v0
    s_lshr_b32 s34, s83, 12
    s_lshr_b32 s35, s80, 12
    s_mov_b32 s37, 0
    s_mov_b32 s38, 116480
    v_bfe_u32 v15, v14, 2, 2
    v_lshrrev_b32 v16, 4, v14
    v_cmp_eq_u32 vcc, v15, v16
    v_and_b32 v15, 1, v14
    v_lshlrev_b32 v15, 4, v15
    v_mov_b32 v16, 0x3f80
    v_lshlrev_b32 v15, v15, v16
    v_cndmask_b32 v15, 0, v15, vcc
    v_and_b32 v16, 2, v14
    v_cmp_eq_u32 vcc, 0, v16
    v_mov_b32 v6, 0
    v_mov_b32 v7, 0
    v_mov_b32 v10, 0
    v_mov_b32 v11, 0
    v_cndmask_b32 v8, 0, v15, vcc
    v_cndmask_b32 v9, v15, 0, vcc
    v_accvgpr_write_b32 a128, 0
    v_accvgpr_write_b32 a129, 0
    v_accvgpr_write_b32 a130, 0
    v_accvgpr_write_b32 a131, 0
    v_accvgpr_write_b32 a132, 0
    v_accvgpr_write_b32 a133, 0
    v_accvgpr_write_b32 a134, 0
    v_accvgpr_write_b32 a135, 0
    v_accvgpr_write_b32 a136, 0
    v_accvgpr_write_b32 a137, 0
    v_accvgpr_write_b32 a138, 0
    v_accvgpr_write_b32 a139, 0
    v_accvgpr_write_b32 a140, 0
    v_accvgpr_write_b32 a141, 0
    v_accvgpr_write_b32 a142, 0
    v_accvgpr_write_b32 a143, 0
    v_mov_b32 v96, 0
    v_mov_b32 v97, 0
    v_mov_b32 v98, 0
    v_mov_b32 v99, 0
    v_mov_b32 v100, 0
    v_mov_b32 v101, 0
    v_mov_b32 v102, 0
    v_mov_b32 v103, 0
    v_mov_b32 v104, 0
    v_mov_b32 v105, 0
    v_mov_b32 v106, 0
    v_mov_b32 v107, 0
    v_mov_b32 v108, 0
    v_mov_b32 v109, 0
    v_mov_b32 v110, 0
    v_mov_b32 v111, 0
    v_mov_b32 v112, 0
    v_mov_b32 v113, 0
    v_mov_b32 v114, 0
    v_mov_b32 v115, 0
    v_mov_b32 v116, 0
    v_mov_b32 v117, 0
    v_mov_b32 v118, 0
    v_mov_b32 v119, 0
    v_mov_b32 v120, 0
    v_mov_b32 v121, 0
    v_mov_b32 v122, 0
    v_mov_b32 v123, 0
    v_mov_b32 v124, 0
    v_mov_b32 v125, 0
    v_mov_b32 v126, 0
    v_mov_b32 v127, 0
L_oloop:
    v_mfma_f32_16x16x32_bf16 v[64:67], v[24:27], v[128:131], 0
    ds_read_b64_tr_b16 v[48:49], v2 offset:288
    ds_read_b64_tr_b16 v[50:51], v2 offset:416
    v_mfma_f32_16x16x32_bf16 v[64:67], v[28:31], v[136:139], v[64:67]
    s_waitcnt lgkmcnt(6)
    v_cvt_pk_bf16_f32 v56, v80, v81
    v_cvt_pk_bf16_f32 v57, v82, v83
    v_mfma_f32_16x16x32_bf16 v[64:67], v[32:35], v[144:147], v[64:67]
    ds_read_b64_tr_b16 v[52:53], v2 offset:1328
    ds_read_b64_tr_b16 v[54:55], v2 offset:1456
    v_mfma_f32_16x16x32_bf16 v[64:67], v[36:39], v[152:155], v[64:67]
    s_waitcnt vmcnt(16)
    s_barrier
    v_cvt_pk_bf16_f32 v58, v88, v89
    v_mfma_f32_16x16x32_bf16 v[68:71], v[24:27], v[132:135], 0
    ds_read_b64_tr_b16 v[24:25], v2 offset:64
    ds_read_b64_tr_b16 v[26:27], v2 offset:192
    v_mfma_f32_16x16x32_bf16 v[68:71], v[28:31], v[140:143], v[68:71]
    buffer_load_dword v21, v20, s[4:7], s41 offen sc1
    v_cvt_pk_bf16_f32 v59, v90, v91
    v_cvt_pk_bf16_f32 v60, v84, v85
    v_mfma_f32_16x16x32_bf16 v[68:71], v[32:35], v[148:151], v[68:71]
    ds_read_b64_tr_b16 v[28:29], v2 offset:1104
    ds_read_b64_tr_b16 v[30:31], v2 offset:1232
    v_mfma_f32_16x16x32_bf16 v[68:71], v[36:39], v[156:159], v[68:71]
    s_waitcnt lgkmcnt(8)
    s_add_u32 s37, s37, 16640
    buffer_store_dwordx4 v[56:59], v0, s[24:27], s31 offen offset:1024 sc1
    v_mfma_f32_16x16x32_bf16 v[72:75], v[40:43], v[128:131], 0
    ds_read_b64_tr_b16 v[32:33], v2 offset:320
    ds_read_b64_tr_b16 v[34:35], v2 offset:448
    v_mfma_f32_16x16x32_bf16 v[72:75], v[44:47], v[136:139], v[72:75]
    s_waitcnt lgkmcnt(6)
    s_cmp_eq_u32 s37, 149760
    v_cvt_pk_bf16_f32 v61, v86, v87
    v_mfma_f32_16x16x32_bf16 v[72:75], v[48:51], v[144:147], v[72:75]
    ds_read_b64_tr_b16 v[36:37], v2 offset:1360
    ds_read_b64_tr_b16 v[38:39], v2 offset:1488
    v_mfma_f32_16x16x32_bf16 v[72:75], v[52:55], v[152:155], v[72:75]
    s_cselect_b32 s37, 0, s37
    s_add_u32 m0, s38, s29
    v_cvt_pk_bf16_f32 v62, v92, v93
    v_mfma_f32_16x16x32_bf16 v[76:79], v[40:43], v[132:135], 0
    ds_read_b64_tr_b16 v[40:41], v2 offset:96
    ds_read_b64_tr_b16 v[42:43], v2 offset:224
    v_mfma_f32_16x16x32_bf16 v[76:79], v[44:47], v[140:143], v[76:79]
    s_add_u32 s36, s34, 346112
    buffer_load_dwordx4 v4, s[20:23], s36 offen offset:0 nt lds
    v_mfma_f32_16x16x32_bf16 v[76:79], v[48:51], v[148:151], v[76:79]
    ds_read_b64_tr_b16 v[44:45], v2 offset:1136
    ds_read_b64_tr_b16 v[46:47], v2 offset:1264
    v_mfma_f32_16x16x32_bf16 v[76:79], v[52:55], v[156:159], v[76:79]
    s_waitcnt lgkmcnt(8)
    s_add_u32 s36, s34, 373744
    v_cvt_pk_bf16_f32 v63, v94, v95
    v_mfma_f32_16x16x32_bf16 v[80:83], v[24:27], v[128:131], 0
    ds_read_b64_tr_b16 v[48:49], v2 offset:352
    ds_read_b64_tr_b16 v[50:51], v2 offset:480
    v_mfma_f32_16x16x32_bf16 v[80:83], v[28:31], v[136:139], v[80:83]
    s_waitcnt lgkmcnt(6)
    buffer_load_dwordx4 v4, s[20:23], s36 offen offset:1040 nt lds
    v_mfma_f32_16x16x32_bf16 v[80:83], v[32:35], v[144:147], v[80:83]
    ds_read_b64_tr_b16 v[52:53], v2 offset:1392
    ds_read_b64_tr_b16 v[54:55], v2 offset:1520
    v_mfma_f32_16x16x32_bf16 v[80:83], v[36:39], v[152:155], v[80:83]
    s_add_u32 s36, s34, 344928
    v_add_u32 v2, s37, v1
    buffer_store_dwordx4 v[60:63], v0, s[24:27], s31 offen offset:3072 sc1
    v_mfma_f32_16x16x32_bf16 v[84:87], v[24:27], v[132:135], 0
    ds_read_b64_tr_b16 v[24:25], v2 offset:0
    ds_read_b64_tr_b16 v[26:27], v2 offset:128
    v_mfma_f32_16x16x32_bf16 v[84:87], v[28:31], v[140:143], v[84:87]
    buffer_load_dwordx4 v4, s[20:23], s36 offen offset:2080 nt lds
    v_mfma_f32_16x16x32_bf16 v[84:87], v[32:35], v[148:151], v[84:87]
    ds_read_b64_tr_b16 v[28:29], v2 offset:1040
    ds_read_b64_tr_b16 v[30:31], v2 offset:1168
    v_mfma_f32_16x16x32_bf16 v[84:87], v[36:39], v[156:159], v[84:87]
    s_waitcnt lgkmcnt(8)
    s_add_u32 s36, s34, 372560
    v_mfma_f32_16x16x32_bf16 v[88:91], v[40:43], v[128:131], 0
    ds_read_b64_tr_b16 v[32:33], v2 offset:256
    ds_read_b64_tr_b16 v[34:35], v2 offset:384
    v_mfma_f32_16x16x32_bf16 v[88:91], v[44:47], v[136:139], v[88:91]
    s_waitcnt lgkmcnt(6)
    buffer_load_dwordx4 v4, s[20:23], s36 offen offset:3120 nt lds
    v_mfma_f32_16x16x32_bf16 v[88:91], v[48:51], v[144:147], v[88:91]
    ds_read_b64_tr_b16 v[36:37], v2 offset:1296
    ds_read_b64_tr_b16 v[38:39], v2 offset:1424
    v_mfma_f32_16x16x32_bf16 v[88:91], v[52:55], v[152:155], v[88:91]
    s_add_u32 s38, s38, 16640
    s_cmp_eq_u32 s38, 149760
    v_mfma_f32_16x16x32_bf16 v[92:95], v[40:43], v[132:135], 0
    ds_read_b64_tr_b16 v[40:41], v2 offset:32
    ds_read_b64_tr_b16 v[42:43], v2 offset:160
    v_mfma_f32_16x16x32_bf16 v[92:95], v[44:47], v[140:143], v[92:95]
    s_cselect_b32 s38, 0, s38
    s_cmp_ge_u32 s39, 640
    v_mfma_f32_16x16x32_bf16 v[92:95], v[48:51], v[148:151], v[92:95]
    ds_read_b64_tr_b16 v[44:45], v2 offset:1072
    ds_read_b64_tr_b16 v[46:47], v2 offset:1200
    s_cselect_b32 s22, 0, s22
    v_mfma_f32_16x16x32_bf16 v[92:95], v[52:55], v[156:159], v[92:95]
    s_waitcnt lgkmcnt(8)
    v_mfma_f32_16x16x32_bf16 v[64:67], v[24:27], v[160:163], v[64:67]
    ds_read_b64_tr_b16 v[48:49], v2 offset:288
    ds_read_b64_tr_b16 v[50:51], v2 offset:416
    v_mfma_f32_16x16x32_bf16 v[64:67], v[28:31], v[168:171], v[64:67]
    s_waitcnt lgkmcnt(6)
    s_lshr_b32 s54, s31, 17
    v_mfma_f32_16x16x32_bf16 v[64:67], v[32:35], v[176:179], v[64:67]
    ds_read_b64_tr_b16 v[52:53], v2 offset:1328
    ds_read_b64_tr_b16 v[54:55], v2 offset:1456
    v_mfma_f32_16x16x32_bf16 v[64:67], v[36:39], v[184:187], v[64:67]
    s_lshl_b32 s54, s54, 9
    s_bfe_u32 s46, s31, 0x3000e
    v_mfma_f32_16x16x32_bf16 v[68:71], v[24:27], v[164:167], v[68:71]
    ds_read_b64_tr_b16 v[24:25], v2 offset:64
    ds_read_b64_tr_b16 v[26:27], v2 offset:192
    v_mfma_f32_16x16x32_bf16 v[68:71], v[28:31], v[172:175], v[68:71]
    s_lshl_b32 s46, s46, 2
    s_add_u32 s54, s54, s46
    v_mfma_f32_16x16x32_bf16 v[68:71], v[32:35], v[180:183], v[68:71]
    ds_read_b64_tr_b16 v[28:29], v2 offset:1104
    ds_read_b64_tr_b16 v[30:31], v2 offset:1232
    v_mfma_f32_16x16x32_bf16 v[68:71], v[36:39], v[188:191], v[68:71]
    s_waitcnt lgkmcnt(8)
    s_add_u32 s37, s37, 16640
    v_mfma_f32_16x16x32_bf16 v[72:75], v[40:43], v[160:163], v[72:75]
    ds_read_b64_tr_b16 v[32:33], v2 offset:320
    ds_read_b64_tr_b16 v[34:35], v2 offset:448
    v_mfma_f32_16x16x32_bf16 v[72:75], v[44:47], v[168:171], v[72:75]
    s_waitcnt lgkmcnt(6)
    s_cmp_eq_u32 s37, 149760
    v_mfma_f32_16x16x32_bf16 v[72:75], v[48:51], v[176:179], v[72:75]
    ds_read_b64_tr_b16 v[36:37], v2 offset:1360
    ds_read_b64_tr_b16 v[38:39], v2 offset:1488
    v_mfma_f32_16x16x32_bf16 v[72:75], v[52:55], v[184:187], v[72:75]
    s_cselect_b32 s37, 0, s37
    s_add_u32 m0, s38, s29
    v_mfma_f32_16x16x32_bf16 v[76:79], v[40:43], v[164:167], v[76:79]
    ds_read_b64_tr_b16 v[40:41], v2 offset:96
    ds_read_b64_tr_b16 v[42:43], v2 offset:224
    v_mfma_f32_16x16x32_bf16 v[76:79], v[44:47], v[172:175], v[76:79]
    s_add_u32 s36, s35, 2048
    buffer_load_dwordx4 v4, s[20:23], s36 offen offset:0 nt lds
    v_mfma_f32_16x16x32_bf16 v[76:79], v[48:51], v[180:183], v[76:79]
    ds_read_b64_tr_b16 v[44:45], v2 offset:1136
    ds_read_b64_tr_b16 v[46:47], v2 offset:1264
    v_mfma_f32_16x16x32_bf16 v[76:79], v[52:55], v[188:191], v[76:79]
    s_waitcnt lgkmcnt(8)
    s_add_u32 s36, s35, 29680
    v_mfma_f32_16x16x32_bf16 v[80:83], v[24:27], v[160:163], v[80:83]
    ds_read_b64_tr_b16 v[48:49], v2 offset:352
    ds_read_b64_tr_b16 v[50:51], v2 offset:480
    v_mfma_f32_16x16x32_bf16 v[80:83], v[28:31], v[168:171], v[80:83]
    s_waitcnt lgkmcnt(6)
    buffer_load_dwordx4 v4, s[20:23], s36 offen offset:1040 nt lds
    v_mfma_f32_16x16x32_bf16 v[80:83], v[32:35], v[176:179], v[80:83]
    ds_read_b64_tr_b16 v[52:53], v2 offset:1392
    ds_read_b64_tr_b16 v[54:55], v2 offset:1520
    v_mfma_f32_16x16x32_bf16 v[80:83], v[36:39], v[184:187], v[80:83]
    s_add_u32 s36, s35, 864
    v_add_u32 v2, s37, v1
    v_mfma_f32_16x16x32_bf16 v[84:87], v[24:27], v[164:167], v[84:87]
    ds_read_b64_tr_b16 v[24:25], v2 offset:0
    ds_read_b64_tr_b16 v[26:27], v2 offset:128
    v_mfma_f32_16x16x32_bf16 v[84:87], v[28:31], v[172:175], v[84:87]
    buffer_load_dwordx4 v4, s[20:23], s36 offen offset:2080 nt lds
    v_mfma_f32_16x16x32_bf16 v[84:87], v[32:35], v[180:183], v[84:87]
    ds_read_b64_tr_b16 v[28:29], v2 offset:1040
    ds_read_b64_tr_b16 v[30:31], v2 offset:1168
    v_mfma_f32_16x16x32_bf16 v[84:87], v[36:39], v[188:191], v[84:87]
    s_waitcnt lgkmcnt(8)
    s_add_u32 s36, s35, 28496
    v_mfma_f32_16x16x32_bf16 v[88:91], v[40:43], v[160:163], v[88:91]
    ds_read_b64_tr_b16 v[32:33], v2 offset:256
    ds_read_b64_tr_b16 v[34:35], v2 offset:384
    v_mfma_f32_16x16x32_bf16 v[88:91], v[44:47], v[168:171], v[88:91]
    s_waitcnt lgkmcnt(6)
    buffer_load_dwordx4 v4, s[20:23], s36 offen offset:3120 nt lds
    v_mfma_f32_16x16x32_bf16 v[88:91], v[48:51], v[176:179], v[88:91]
    ds_read_b64_tr_b16 v[36:37], v2 offset:1296
    ds_read_b64_tr_b16 v[38:39], v2 offset:1424
    v_mfma_f32_16x16x32_bf16 v[88:91], v[52:55], v[184:187], v[88:91]
    s_add_u32 s38, s38, 16640
    s_cmp_eq_u32 s38, 149760
    v_mfma_f32_16x16x32_bf16 v[92:95], v[40:43], v[164:167], v[92:95]
    ds_read_b64_tr_b16 v[40:41], v2 offset:32
    ds_read_b64_tr_b16 v[42:43], v2 offset:160
    v_mfma_f32_16x16x32_bf16 v[92:95], v[44:47], v[172:175], v[92:95]
    s_cselect_b32 s38, 0, s38
    v_mfma_f32_16x16x32_bf16 v[92:95], v[48:51], v[180:183], v[92:95]
    ds_read_b64_tr_b16 v[44:45], v2 offset:1072
    ds_read_b64_tr_b16 v[46:47], v2 offset:1200
    v_mfma_f32_16x16x32_bf16 v[92:95], v[52:55], v[188:191], v[92:95]
    s_waitcnt lgkmcnt(8)
    v_mfma_f32_16x16x32_bf16 v[64:67], v[24:27], v[192:195], v[64:67]
    ds_read_b64_tr_b16 v[48:49], v2 offset:288
    ds_read_b64_tr_b16 v[50:51], v2 offset:416
    v_mfma_f32_16x16x32_bf16 v[64:67], v[28:31], v[200:203], v[64:67]
    s_waitcnt lgkmcnt(6)
    v_mfma_f32_16x16x32_bf16 v[64:67], v[32:35], v[208:211], v[64:67]
    ds_read_b64_tr_b16 v[52:53], v2 offset:1328
    ds_read_b64_tr_b16 v[54:55], v2 offset:1456
    v_mfma_f32_16x16x32_bf16 v[64:67], v[36:39], v[216:219], v[64:67]
    s_waitcnt vmcnt(16)
    s_barrier
    v_mfma_f32_16x16x32_bf16 v[68:71], v[24:27], v[196:199], v[68:71]
    ds_read_b64_tr_b16 v[24:25], v2 offset:64
    ds_read_b64_tr_b16 v[26:27], v2 offset:192
    v_mfma_f32_16x16x32_bf16 v[68:71], v[28:31], v[204:207], v[68:71]
    buffer_store_dword v19, off, s[4:7], s55 sc1
    v_mfma_f32_16x16x32_bf16 v[68:71], v[32:35], v[212:215], v[68:71]
    ds_read_b64_tr_b16 v[28:29], v2 offset:1104
    ds_read_b64_tr_b16 v[30:31], v2 offset:1232
    v_mfma_f32_16x16x32_bf16 v[68:71], v[36:39], v[220:223], v[68:71]
    s_waitcnt lgkmcnt(8)
    s_add_u32 s37, s37, 16640
    v_mfma_f32_16x16x32_bf16 v[72:75], v[40:43], v[192:195], v[72:75]
    ds_read_b64_tr_b16 v[32:33], v2 offset:320
    ds_read_b64_tr_b16 v[34:35], v2 offset:448
    v_mfma_f32_16x16x32_bf16 v[72:75], v[44:47], v[200:203], v[72:75]
    s_waitcnt lgkmcnt(6)
    buffer_load_dword v18, v20, s[4:7], s41 offen sc1
    v_mfma_f32_16x16x32_bf16 v[72:75], v[48:51], v[208:211], v[72:75]
    ds_read_b64_tr_b16 v[36:37], v2 offset:1360
    ds_read_b64_tr_b16 v[38:39], v2 offset:1488
    v_mfma_f32_16x16x32_bf16 v[72:75], v[52:55], v[216:219], v[72:75]
    s_cmp_eq_u32 s37, 149760
    s_cselect_b32 s37, 0, s37
    v_mfma_f32_16x16x32_bf16 v[76:79], v[40:43], v[196:199], v[76:79]
    ds_read_b64_tr_b16 v[40:41], v2 offset:96
    ds_read_b64_tr_b16 v[42:43], v2 offset:224
    v_mfma_f32_16x16x32_bf16 v[76:79], v[44:47], v[204:207], v[76:79]
    s_add_u32 m0, s38, s29
    s_add_u32 s36, s35, 116736
    v_mfma_f32_16x16x32_bf16 v[76:79], v[48:51], v[212:215], v[76:79]
    ds_read_b64_tr_b16 v[44:45], v2 offset:1136
    ds_read_b64_tr_b16 v[46:47], v2 offset:1264
    v_mfma_f32_16x16x32_bf16 v[76:79], v[52:55], v[220:223], v[76:79]
    s_waitcnt lgkmcnt(8)
    buffer_load_dwordx4 v4, s[20:23], s36 offen offset:0 nt lds
    v_mfma_f32_16x16x32_bf16 v[80:83], v[24:27], v[192:195], v[80:83]
    ds_read_b64_tr_b16 v[48:49], v2 offset:352
    ds_read_b64_tr_b16 v[50:51], v2 offset:480
    v_mfma_f32_16x16x32_bf16 v[80:83], v[28:31], v[200:203], v[80:83]
    s_waitcnt lgkmcnt(6)
    s_add_u32 s36, s35, 144368
    v_mfma_f32_16x16x32_bf16 v[80:83], v[32:35], v[208:211], v[80:83]
    ds_read_b64_tr_b16 v[52:53], v2 offset:1392
    ds_read_b64_tr_b16 v[54:55], v2 offset:1520
    v_mfma_f32_16x16x32_bf16 v[80:83], v[36:39], v[216:219], v[80:83]
    v_add_u32 v2, s37, v1
    v_mfma_f32_16x16x32_bf16 v[84:87], v[24:27], v[196:199], v[84:87]
    ds_read_b64_tr_b16 v[24:25], v2 offset:0
    ds_read_b64_tr_b16 v[26:27], v2 offset:128
    v_mfma_f32_16x16x32_bf16 v[84:87], v[28:31], v[204:207], v[84:87]
    buffer_load_dwordx4 v4, s[20:23], s36 offen offset:1040 nt lds
    v_mfma_f32_16x16x32_bf16 v[84:87], v[32:35], v[212:215], v[84:87]
    ds_read_b64_tr_b16 v[28:29], v2 offset:1040
    ds_read_b64_tr_b16 v[30:31], v2 offset:1168
    v_mfma_f32_16x16x32_bf16 v[84:87], v[36:39], v[220:223], v[84:87]
    s_waitcnt lgkmcnt(8)
    s_add_u32 s36, s35, 115552
    v_mfma_f32_16x16x32_bf16 v[88:91], v[40:43], v[192:195], v[88:91]
    ds_read_b64_tr_b16 v[32:33], v2 offset:256
    ds_read_b64_tr_b16 v[34:35], v2 offset:384
    v_mfma_f32_16x16x32_bf16 v[88:91], v[44:47], v[200:203], v[88:91]
    s_waitcnt lgkmcnt(6)
    buffer_load_dwordx4 v4, s[20:23], s36 offen offset:2080 nt lds
    v_mfma_f32_16x16x32_bf16 v[88:91], v[48:51], v[208:211], v[88:91]
    ds_read_b64_tr_b16 v[36:37], v2 offset:1296
    ds_read_b64_tr_b16 v[38:39], v2 offset:1424
    v_mfma_f32_16x16x32_bf16 v[88:91], v[52:55], v[216:219], v[88:91]
    s_add_u32 s36, s35, 143184
    buffer_load_dwordx4 v4, s[20:23], s36 offen offset:3120 nt lds
    v_mfma_f32_16x16x32_bf16 v[92:95], v[40:43], v[196:199], v[92:95]
    ds_read_b64_tr_b16 v[40:41], v2 offset:32
    ds_read_b64_tr_b16 v[42:43], v2 offset:160
    v_mfma_f32_16x16x32_bf16 v[92:95], v[44:47], v[204:207], v[92:95]
    s_add_u32 s38, s38, 16640
    s_cmp_eq_u32 s38, 149760
    s_waitcnt vmcnt(16)
    v_cmp_ne_u32 vcc, 0, v21
    v_mfma_f32_16x16x32_bf16 v[92:95], v[48:51], v[212:215], v[92:95]
    ds_read_b64_tr_b16 v[44:45], v2 offset:1072
    ds_read_b64_tr_b16 v[46:47], v2 offset:1200
    s_cselect_b32 s38, 0, s38
    v_mfma_f32_16x16x32_bf16 v[92:95], v[52:55], v[220:223], v[92:95]
    s_waitcnt lgkmcnt(8)
    v_mfma_f32_16x16x32_bf16 v[96:99], v[8:11], a[128:131], v[96:99]
    s_andn2_b32 s48, vcc_lo, s61
    s_and_b32 s48, s48, 0xff
    s_cselect_b32 s10, s26, 0
    v_mfma_f32_16x16x32_bf16 v[104:107], v[6:9], a[128:131], v[104:107]
    s_ff1_i32_b32 s48, s48
    s_bitset1_b32 s61, s48
    s_lshl_b32 s48, s48, 14
    v_mfma_f32_16x16x32_bf16 v[112:115], v[8:11], a[132:135], v[112:115]
    s_add_u32 s48, s48, s60
    s_cmp_eq_u32 s39, 768
    s_cbranch_scc1 L_urg
L_urgret:
    v_mfma_f32_16x16x32_bf16 v[120:123], v[6:9], a[132:135], v[120:123]
    buffer_load_dwordx4 a[128:131], v0, s[8:11], s48 offen offset:0 sc1
    v_mfma_f32_16x16x32_bf16 v[100:103], v[8:11], a[136:139], v[100:103]
    buffer_load_dwordx4 a[132:135], v0, s[8:11], s48 offen offset:1024 sc1
    v_mfma_f32_16x16x32_bf16 v[108:111], v[6:9], a[136:139], v[108:111]
    buffer_load_dwordx4 a[136:139], v0, s[8:11], s48 offen offset:2048 sc1
    v_mfma_f32_16x16x32_bf16 v[116:119], v[8:11], a[140:143], v[116:119]
    v_mfma_f32_16x16x32_bf16 v[124:127], v[6:9], a[140:143], v[124:127]
    buffer_load_dwordx4 a[140:143], v0, s[8:11], s48 offen offset:3072 sc1
    v_mfma_f32_16x16x32_bf16 v[64:67], v[24:27], v[224:227], v[64:67]
    ds_read_b64_tr_b16 v[48:49], v2 offset:288
    ds_read_b64_tr_b16 v[50:51], v2 offset:416
    v_mfma_f32_16x16x32_bf16 v[64:67], v[28:31], v[232:235], v[64:67]
    s_waitcnt lgkmcnt(6)
    v_mfma_f32_16x16x32_bf16 v[64:67], v[32:35], v[240:243], v[64:67]
    ds_read_b64_tr_b16 v[52:53], v2 offset:1328
    ds_read_b64_tr_b16 v[54:55], v2 offset:1456
    v_mfma_f32_16x16x32_bf16 v[64:67], v[36:39], v[248:251], v[64:67]
    v_mfma_f32_16x16x32_bf16 v[68:71], v[24:27], v[228:231], v[68:71]
    ds_read_b64_tr_b16 v[24:25], v2 offset:64
    ds_read_b64_tr_b16 v[26:27], v2 offset:192
    v_mfma_f32_16x16x32_bf16 v[68:71], v[28:31], v[236:239], v[68:71]
    v_mfma_f32_16x16x32_bf16 v[68:71], v[32:35], v[244:247], v[68:71]
    ds_read_b64_tr_b16 v[28:29], v2 offset:1104
    ds_read_b64_tr_b16 v[30:31], v2 offset:1232
    v_mfma_f32_16x16x32_bf16 v[68:71], v[36:39], v[252:255], v[68:71]
    s_waitcnt lgkmcnt(8)
    s_add_u32 s37, s37, 16640
    v_mfma_f32_16x16x32_bf16 v[72:75], v[40:43], v[224:227], v[72:75]
    ds_read_b64_tr_b16 v[32:33], v2 offset:320
    ds_read_b64_tr_b16 v[34:35], v2 offset:448
    v_mfma_f32_16x16x32_bf16 v[72:75], v[44:47], v[232:235], v[72:75]
    s_waitcnt lgkmcnt(6)
    s_cmp_eq_u32 s37, 149760
    v_mfma_f32_16x16x32_bf16 v[72:75], v[48:51], v[240:243], v[72:75]
    ds_read_b64_tr_b16 v[36:37], v2 offset:1360
    ds_read_b64_tr_b16 v[38:39], v2 offset:1488
    v_mfma_f32_16x16x32_bf16 v[72:75], v[52:55], v[248:251], v[72:75]
    s_cselect_b32 s37, 0, s37
    s_add_u32 m0, s38, s29
    v_mfma_f32_16x16x32_bf16 v[76:79], v[40:43], v[228:231], v[76:79]
    ds_read_b64_tr_b16 v[40:41], v2 offset:96
    ds_read_b64_tr_b16 v[42:43], v2 offset:224
    v_mfma_f32_16x16x32_bf16 v[76:79], v[44:47], v[236:239], v[76:79]
    s_add_u32 s36, s35, 231424
    buffer_load_dwordx4 v4, s[20:23], s36 offen offset:0 nt lds
    v_mfma_f32_16x16x32_bf16 v[76:79], v[48:51], v[244:247], v[76:79]
    ds_read_b64_tr_b16 v[44:45], v2 offset:1136
    ds_read_b64_tr_b16 v[46:47], v2 offset:1264
    v_mfma_f32_16x16x32_bf16 v[76:79], v[52:55], v[252:255], v[76:79]
    s_waitcnt lgkmcnt(8)
    s_add_u32 s36, s35, 259056
    v_cvt_pk_bf16_f32 v56, v64, v65
    v_mfma_f32_16x16x32_bf16 v[80:83], v[24:27], v[224:227], v[80:83]
    ds_read_b64_tr_b16 v[48:49], v2 offset:352
    ds_read_b64_tr_b16 v[50:51], v2 offset:480
    v_mfma_f32_16x16x32_bf16 v[80:83], v[28:31], v[232:235], v[80:83]
    s_waitcnt lgkmcnt(6)
    buffer_load_dwordx4 v4, s[20:23], s36 offen offset:1040 nt lds
    v_mfma_f32_16x16x32_bf16 v[80:83], v[32:35], v[240:243], v[80:83]
    ds_read_b64_tr_b16 v[52:53], v2 offset:1392
    ds_read_b64_tr_b16 v[54:55], v2 offset:1520
    v_mfma_f32_16x16x32_bf16 v[80:83], v[36:39], v[248:251], v[80:83]
    s_add_u32 s36, s35, 230240
    v_add_u32 v2, s37, v1
    v_cvt_pk_bf16_f32 v57, v66, v67
    v_mfma_f32_16x16x32_bf16 v[84:87], v[24:27], v[228:231], v[84:87]
    ds_read_b64_tr_b16 v[24:25], v2 offset:0
    ds_read_b64_tr_b16 v[26:27], v2 offset:128
    v_mfma_f32_16x16x32_bf16 v[84:87], v[28:31], v[236:239], v[84:87]
    buffer_load_dwordx4 v4, s[20:23], s36 offen offset:2080 nt lds
    v_mfma_f32_16x16x32_bf16 v[84:87], v[32:35], v[244:247], v[84:87]
    ds_read_b64_tr_b16 v[28:29], v2 offset:1040
    ds_read_b64_tr_b16 v[30:31], v2 offset:1168
    v_mfma_f32_16x16x32_bf16 v[84:87], v[36:39], v[252:255], v[84:87]
    s_waitcnt lgkmcnt(8)
    s_add_u32 s36, s35, 257872
    v_cvt_pk_bf16_f32 v58, v72, v73
    v_mfma_f32_16x16x32_bf16 v[88:91], v[40:43], v[224:227], v[88:91]
    ds_read_b64_tr_b16 v[32:33], v2 offset:256
    ds_read_b64_tr_b16 v[34:35], v2 offset:384
    v_mfma_f32_16x16x32_bf16 v[88:91], v[44:47], v[232:235], v[88:91]
    s_waitcnt lgkmcnt(6)
    buffer_load_dwordx4 v4, s[20:23], s36 offen offset:3120 nt lds
    v_mfma_f32_16x16x32_bf16 v[88:91], v[48:51], v[240:243], v[88:91]
    ds_read_b64_tr_b16 v[36:37], v2 offset:1296
    ds_read_b64_tr_b16 v[38:39], v2 offset:1424
    v_mfma_f32_16x16x32_bf16 v[88:91], v[52:55], v[248:251], v[88:91]
    s_add_u32 s38, s38, 16640
    s_cmp_eq_u32 s38, 149760
    v_cvt_pk_bf16_f32 v59, v74, v75
    v_mfma_f32_16x16x32_bf16 v[92:95], v[40:43], v[228:231], v[92:95]
    ds_read_b64_tr_b16 v[40:41], v2 offset:32
    ds_read_b64_tr_b16 v[42:43], v2 offset:160
    v_mfma_f32_16x16x32_bf16 v[92:95], v[44:47], v[236:239], v[92:95]
    s_cselect_b32 s38, 0, s38
    s_mov_b32 s55, s54
    buffer_store_dwordx4 v[56:59], v0, s[24:27], s30 offen offset:0 sc1
    v_mfma_f32_16x16x32_bf16 v[92:95], v[48:51], v[244:247], v[92:95]
    ds_read_b64_tr_b16 v[44:45], v2 offset:1072
    ds_read_b64_tr_b16 v[46:47], v2 offset:1200
    s_lshl_b32 s44, s34, 10
    s_add_u32 s32, s32, s33
    s_add_u32 s44, s44, s32
    s_mov_b32 s34, s35
    s_add_u32 s35, s35, 128
    s_cmp_eq_u32 s35, 896
    s_cselect_b32 s35, 0, s35
    s_add_u32 s39, s39, 128
    v_cvt_pk_bf16_f32 v60, v68, v69
    v_cvt_pk_bf16_f32 v61, v70, v71
    v_cvt_pk_bf16_f32 v62, v76, v77
    v_cvt_pk_bf16_f32 v63, v78, v79
    buffer_store_dwordx4 v[60:63], v0, s[24:27], s30 offen offset:2048 sc1
    v_mfma_f32_16x16x32_bf16 v[92:95], v[52:55], v[252:255], v[92:95]
    s_waitcnt lgkmcnt(8)
    s_mov_b32 s31, s30
    s_mov_b32 s30, s44
    s_cmp_lt_u32 s39, 896
    s_cbranch_scc1 L_oloop
    s_and_b32 s61, s61, 0xff
    s_mov_b32 s40, s61
    s_waitcnt vmcnt(14)
    v_mov_b32 v21, v18
    s_call_b64 s[46:47], L_fetch
    v_cvt_pk_bf16_f32 v56, v80, v81
    v_cvt_pk_bf16_f32 v57, v82, v83
    v_cvt_pk_bf16_f32 v58, v88, v89
    v_cvt_pk_bf16_f32 v59, v90, v91
    buffer_store_dwordx4 v[56:59], v0, s[24:27], s31 offen offset:1024 sc1
    v_cvt_pk_bf16_f32 v60, v84, v85
    v_cvt_pk_bf16_f32 v61, v86, v87
    v_cvt_pk_bf16_f32 v62, v92, v93
    v_cvt_pk_bf16_f32 v63, v94, v95
    buffer_store_dwordx4 v[60:63], v0, s[24:27], s31 offen offset:3072 sc1
    buffer_load_dword v21, v20, s[4:7], s41 offen sc1
    s_waitcnt lgkmcnt(0)
    s_lshr_b32 s54, s31, 17
    s_lshl_b32 s54, s54, 9
    s_bfe_u32 s46, s31, 0x3000e
    s_lshl_b32 s46, s46, 2
    s_add_u32 s54, s54, s46
    v_lshrrev_b32 v4, 4, v0
    v_and_b32 v5, 15, v4
    v_lshrrev_b32 v12, 4, v4
    v_mul_u32_u24 v5, 1792, v5
    v_lshl_add_u32 v5, v12, 4, v5
    v_mov_b32 v12, 0
    v_mov_b32 v14, 1
    s_lshr_b32 s36, s2, 3
    s_lshl_b32 s22, s36, 2
    s_mul_i32 s23, s45, 229376
    s_lshr_b32 s21, s36, 4
    s_mul_i32 s21, s21, 896
    s_add_u32 s23, s23, s21
    s_mul_i32 s21, s28, 57344
    s_add_u32 s23, s23, s21
    s_mov_b32 s39, 0
    s_waitcnt vmcnt(0)
    buffer_store_dword v19, off, s[4:7], s54 sc1
    s_mov_b32 s44, s61
    s_call_b64 s[46:47], L_fetch
    v_mfma_f32_16x16x32_bf16 v[96:99], v[8:11], a[128:131], v[96:99]
    v_mfma_f32_16x16x32_bf16 v[104:107], v[6:9], a[128:131], v[104:107]
    v_mfma_f32_16x16x32_bf16 v[112:115], v[8:11], a[132:135], v[112:115]
    v_mfma_f32_16x16x32_bf16 v[120:123], v[6:9], a[132:135], v[120:123]
    v_mfma_f32_16x16x32_bf16 v[100:103], v[8:11], a[136:139], v[100:103]
    v_mfma_f32_16x16x32_bf16 v[108:111], v[6:9], a[136:139], v[108:111]
    v_mfma_f32_16x16x32_bf16 v[116:119], v[8:11], a[140:143], v[116:119]
    v_mfma_f32_16x16x32_bf16 v[124:127], v[6:9], a[140:143], v[124:127]
L_arrive:
    s_barrier
    s_cmp_lg_u32 s28, 0
    s_cbranch_scc1 L_nosig
    s_mov_b64 exec, 1
    buffer_atomic_add v14, off, s[12:15], s22 sc0 sc1
    s_mov_b64 exec, -1
L_nosig:
    s_cmp_eq_u32 s3, 7
    s_cbranch_scc1 L_next0
    s_cmp_eq_u32 s44, 0xff
    s_cbranch_scc1 L_all2
    s_mov_b32 s45, 100000
L_wf:
    s_cmp_eq_u32 s61, 0xff
    s_cbranch_scc1 L_all
    buffer_load_dword v21, v20, s[4:7], s41 offen sc1
    s_sub_u32 s45, s45, 1
    s_and_b32 s21, s45, 63
    s_cmp_eq_u32 s21, 0
    s_cbranch_scc1 L_slow
L_wf2:
    s_waitcnt vmcnt(0)
    s_call_b64 s[46:47], L_fetch
    s_branch L_wf
L_all:
    s_waitcnt vmcnt(0)
L_all2:
    s_bitcmp1_b32 s40, 0
    s_cbranch_scc1 L_ad0
    v_mfma_f32_16x16x32_bf16 v[96:99], v[8:11], a[0:3], v[96:99]
    v_mfma_f32_16x16x32_bf16 v[104:107], v[6:9], a[0:3], v[104:107]
    v_mfma_f32_16x16x32_bf16 v[112:115], v[8:11], a[4:7], v[112:115]
    v_mfma_f32_16x16x32_bf16 v[120:123], v[6:9], a[4:7], v[120:123]
    v_mfma_f32_16x16x32_bf16 v[100:103], v[8:11], a[8:11], v[100:103]
    v_mfma_f32_16x16x32_bf16 v[108:111], v[6:9], a[8:11], v[108:111]
    v_mfma_f32_16x16x32_bf16 v[116:119], v[8:11], a[12:15], v[116:119]
    v_mfma_f32_16x16x32_bf16 v[124:127], v[6:9], a[12:15], v[124:127]
L_ad0:
    s_bitcmp1_b32 s40, 1
    s_cbranch_scc1 L_ad1
    v_mfma_f32_16x16x32_bf16 v[96:99], v[8:11], a[16:19], v[96:99]
    v_mfma_f32_16x16x32_bf16 v[104:107], v[6:9], a[16:19], v[104:107]
    v_mfma_f32_16x16x32_bf16 v[112:115], v[8:11], a[20:23], v[112:115]
    v_mfma_f32_16x16x32_bf16 v[120:123], v[6:9], a[20:23], v[120:123]
    v_mfma_f32_16x16x32_bf16 v[100:103], v[8:11], a[24:27], v[100:103]
    v_mfma_f32_16x16x32_bf16 v[108:111], v[6:9], a[24:27], v[108:111]
    v_mfma_f32_16x16x32_bf16 v[116:119], v[8:11], a[28:31], v[116:119]
    v_mfma_f32_16x16x32_bf16 v[124:127], v[6:9], a[28:31], v[124:127]
L_ad1:
    s_bitcmp1_b32 s40, 2
    s_cbranch_scc1 L_ad2
    v_mfma_f32_16x16x32_bf16 v[96:99], v[8:11], a[32:35], v[96:99]
    v_mfma_f32_16x16x32_bf16 v[104:107], v[6:9], a[32:35], v[104:107]
    v_mfma_f32_16x16x32_bf16 v[112:115], v[8:11], a[36:39], v[112:115]
    v_mfma_f32_16x16x32_bf16 v[120:123], v[6:9], a[36:39], v[120:123]
    v_mfma_f32_16x16x32_bf16 v[100:103], v[8:11], a[40:43], v[100:103]
    v_mfma_f32_16x16x32_bf16 v[108:111], v[6:9], a[40:43], v[108:111]
    v_mfma_f32_16x16x32_bf16 v[116:119], v[8:11], a[44:47], v[116:119]
    v_mfma_f32_16x16x32_bf16 v[124:127], v[6:9], a[44:47], v[124:127]
L_ad2:
    s_bitcmp1_b32 s40, 3
    s_cbranch_scc1 L_ad3
    v_mfma_f32_16x16x32_bf16 v[96:99], v[8:11], a[48:51], v[96:99]
    v_mfma_f32_16x16x32_bf16 v[104:107], v[6:9], a[48:51], v[104:107]
    v_mfma_f32_16x16x32_bf16 v[112:115], v[8:11], a[52:55], v[112:115]
    v_mfma_f32_16x16x32_bf16 v[120:123], v[6:9], a[52:55], v[120:123]
    v_mfma_f32_16x16x32_bf16 v[100:103], v[8:11], a[56:59], v[100:103]
    v_mfma_f32_16x16x32_bf16 v[108:111], v[6:9], a[56:59], v[108:111]
    v_mfma_f32_16x16x32_bf16 v[116:119], v[8:11], a[60:63], v[116:119]
    v_mfma_f32_16x16x32_bf16 v[124:127], v[6:9], a[60:63], v[124:127]
L_ad3:
    s_bitcmp1_b32 s40, 4
    s_cbranch_scc1 L_ad4
    v_mfma_f32_16x16x32_bf16 v[96:99], v[8:11], a[64:67], v[96:99]
    v_mfma_f32_16x16x32_bf16 v[104:107], v[6:9], a[64:67], v[104:107]
    v_mfma_f32_16x16x32_bf16 v[112:115], v[8:11], a[68:71], v[112:115]
    v_mfma_f32_16x16x32_bf16 v[120:123], v[6:9], a[68:71], v[120:123]
    v_mfma_f32_16x16x32_bf16 v[100:103], v[8:11], a[72:75], v[100:103]
    v_mfma_f32_16x16x32_bf16 v[108:111], v[6:9], a[72:75], v[108:111]
    v_mfma_f32_16x16x32_bf16 v[116:119], v[8:11], a[76:79], v[116:119]
    v_mfma_f32_16x16x32_bf16 v[124:127], v[6:9], a[76:79], v[124:127]
L_ad4:
    s_bitcmp1_b32 s40, 5
    s_cbranch_scc1 L_ad5
    v_mfma_f32_16x16x32_bf16 v[96:99], v[8:11], a[80:83], v[96:99]
    v_mfma_f32_16x16x32_bf16 v[104:107], v[6:9], a[80:83], v[104:107]
    v_mfma_f32_16x16x32_bf16 v[112:115], v[8:11], a[84:87], v[112:115]
    v_mfma_f32_16x16x32_bf16 v[120:123], v[6:9], a[84:87], v[120:123]
    v_mfma_f32_16x16x32_bf16 v[100:103], v[8:11], a[88:91], v[100:103]
    v_mfma_f32_16x16x32_bf16 v[108:111], v[6:9], a[88:91], v[108:111]
    v_mfma_f32_16x16x32_bf16 v[116:119], v[8:11], a[92:95], v[116:119]
    v_mfma_f32_16x16x32_bf16 v[124:127], v[6:9], a[92:95], v[124:127]
L_ad5:
    s_bitcmp1_b32 s40, 7
    s_cbranch_scc1 L_ad7
    v_mfma_f32_16x16x32_bf16 v[96:99], v[8:11], a[112:115], v[96:99]
    v_mfma_f32_16x16x32_bf16 v[104:107], v[6:9], a[112:115], v[104:107]
    v_mfma_f32_16x16x32_bf16 v[112:115], v[8:11], a[116:119], v[112:115]
    v_mfma_f32_16x16x32_bf16 v[120:123], v[6:9], a[116:119], v[120:123]
    v_mfma_f32_16x16x32_bf16 v[100:103], v[8:11], a[120:123], v[100:103]
    v_mfma_f32_16x16x32_bf16 v[108:111], v[6:9], a[120:123], v[108:111]
    v_mfma_f32_16x16x32_bf16 v[116:119], v[8:11], a[124:127], v[116:119]
    v_mfma_f32_16x16x32_bf16 v[124:127], v[6:9], a[124:127], v[124:127]
L_ad7:
    s_lshl_b32 s31, s3, 7
    s_nop 6
    v_pk_add_f32 v[64:65], v[64:65], v[96:97]
    v_pk_add_f32 v[66:67], v[66:67], v[98:99]
    v_pk_add_f32 v[68:69], v[68:69], v[100:101]
    v_pk_add_f32 v[70:71], v[70:71], v[102:103]
    v_pk_add_f32 v[72:73], v[72:73], v[104:105]
    v_pk_add_f32 v[74:75], v[74:75], v[106:107]
    v_pk_add_f32 v[76:77], v[76:77], v[108:109]
    v_pk_add_f32 v[78:79], v[78:79], v[110:111]
    v_pk_add_f32 v[80:81], v[80:81], v[112:113]
    v_pk_add_f32 v[82:83], v[82:83], v[114:115]
    v_pk_add_f32 v[84:85], v[84:85], v[116:117]
    v_pk_add_f32 v[86:87], v[86:87], v[118:119]
    v_pk_add_f32 v[88:89], v[88:89], v[120:121]
    v_pk_add_f32 v[90:91], v[90:91], v[122:123]
    v_pk_add_f32 v[92:93], v[92:93], v[124:125]
    v_pk_add_f32 v[94:95], v[94:95], v[126:127]
L_emit:
    s_add_u32 s31, s31, s23
    s_add_u32 s30, s31, 28672
    v_cvt_pk_bf16_f32 v32, v64, v65
    v_cvt_pk_bf16_f32 v33, v66, v67
    v_cvt_pk_bf16_f32 v34, v72, v73
    v_cvt_pk_bf16_f32 v35, v74, v75
    v_cvt_pk_bf16_f32 v36, v80, v81
    v_cvt_pk_bf16_f32 v37, v82, v83
    v_cvt_pk_bf16_f32 v38, v88, v89
    v_cvt_pk_bf16_f32 v39, v90, v91
    v_cvt_pk_bf16_f32 v40, v68, v69
    v_cvt_pk_bf16_f32 v41, v70, v71
    v_cvt_pk_bf16_f32 v42, v76, v77
    v_cvt_pk_bf16_f32 v43, v78, v79
    v_cvt_pk_bf16_f32 v44, v84, v85
    v_cvt_pk_bf16_f32 v45, v86, v87
    v_cvt_pk_bf16_f32 v46, v92, v93
    v_cvt_pk_bf16_f32 v47, v94, v95
    v_permlane32_swap_b32 v32, v34
    v_permlane32_swap_b32 v33, v35
    v_permlane32_swap_b32 v36, v38
    v_permlane32_swap_b32 v37, v39
    v_permlane32_swap_b32 v40, v42
    v_permlane32_swap_b32 v41, v43
    v_permlane32_swap_b32 v44, v46
    v_permlane32_swap_b32 v45, v47
    v_permlane16_swap_b32 v32, v34
    v_permlane16_swap_b32 v33, v35
    v_permlane16_swap_b32 v36, v38
    v_permlane16_swap_b32 v37, v39
    v_permlane16_swap_b32 v40, v42
    v_permlane16_swap_b32 v41, v43
    v_permlane16_swap_b32 v44, v46
    v_permlane16_swap_b32 v45, v47
    buffer_store_dwordx4 v[32:35], v5, s[16:19], s31 offen offset:0
    buffer_store_dwordx4 v[36:39], v5, s[16:19], s31 offen offset:64
    buffer_store_dwordx4 v[40:43], v5, s[16:19], s30 offen offset:0
    buffer_store_dwordx4 v[44:47], v5, s[16:19], s30 offen offset:64
L_next:
    s_cmp_lg_u32 s39, 0
    s_cbranch_scc1 L_havemask
    s_cmp_lg_u32 s28, 0
    s_cbranch_scc1 L_nopub
    s_waitcnt vmcnt(4)
    v_readfirstlane_b32 s21, v14
    s_nop 0
    s_and_b32 s34, s21, 15
    s_lshr_b32 s21, s21, 8
    s_cmp_eq_u32 s34, 7
    s_cselect_b32 s21, s21, 0
    v_mov_b32 v13, s21
    ds_write_b32 v12, v13
    s_waitcnt lgkmcnt(0)
L_nopub:
    s_barrier
    ds_read_b32 v13, v12
    s_waitcnt lgkmcnt(0)
    v_readfirstlane_b32 s39, v13
    s_nop 0
    s_or_b32 s39, s39, 0x100
L_havemask:
    s_ff1_i32_b32 s38, s39
    s_cmp_eq_u32 s38, 8
    s_cbranch_scc1 L_done
    s_bitset0_b32 s39, s38
    s_waitcnt vmcnt(0)
    v_mov_b32 v64, 0
    v_mov_b32 v65, 0
    v_mov_b32 v66, 0
    v_mov_b32 v67, 0
    v_mov_b32 v68, 0
    v_mov_b32 v69, 0
    v_mov_b32 v70, 0
    v_mov_b32 v71, 0
    v_mov_b32 v72, 0
    v_mov_b32 v73, 0
    v_mov_b32 v74, 0
    v_mov_b32 v75, 0
    v_mov_b32 v76, 0
    v_mov_b32 v77, 0
    v_mov_b32 v78, 0
    v_mov_b32 v79, 0
    v_mov_b32 v80, 0
    v_mov_b32 v81, 0
    v_mov_b32 v82, 0
    v_mov_b32 v83, 0
    v_mov_b32 v84, 0
    v_mov_b32 v85, 0
    v_mov_b32 v86, 0
    v_mov_b32 v87, 0
    v_mov_b32 v88, 0
    v_mov_b32 v89, 0
    v_mov_b32 v90, 0
    v_mov_b32 v91, 0
    v_mov_b32 v92, 0
    v_mov_b32 v93, 0
    v_mov_b32 v94, 0
    v_mov_b32 v95, 0
    s_lshl_b32 s34, s38, 17
    s_mov_b32 s35, 0
L_redo:
    buffer_load_dwordx4 a[0:3], v0, s[24:27], s34 offen offset:0 sc1
    buffer_load_dwordx4 a[4:7], v0, s[24:27], s34 offen offset:1024 sc1
    buffer_load_dwordx4 a[8:11], v0, s[24:27], s34 offen offset:2048 sc1
    buffer_load_dwordx4 a[12:15], v0, s[24:27], s34 offen offset:3072 sc1
    s_waitcnt vmcnt(0)
    v_mfma_f32_16x16x32_bf16 v[64:67], v[8:11], a[0:3], v[64:67]
    v_mfma_f32_16x16x32_bf16 v[72:75], v[6:9], a[0:3], v[72:75]
    v_mfma_f32_16x16x32_bf16 v[80:83], v[8:11], a[4:7], v[80:83]
    v_mfma_f32_16x16x32_bf16 v[88:91], v[6:9], a[4:7], v[88:91]
    v_mfma_f32_16x16x32_bf16 v[68:71], v[8:11], a[8:11], v[68:71]
    v_mfma_f32_16x16x32_bf16 v[76:79], v[6:9], a[8:11], v[76:79]
    v_mfma_f32_16x16x32_bf16 v[84:87], v[8:11], a[12:15], v[84:87]
    v_mfma_f32_16x16x32_bf16 v[92:95], v[6:9], a[12:15], v[92:95]
    s_nop 7
    s_add_u32 s34, s34, 16384
    s_add_u32 s35, s35, 1
    s_cmp_lt_u32 s35, 8
    s_cbranch_scc1 L_redo
    s_lshl_b32 s31, s38, 7
    s_branch L_emit
L_next0:
    s_waitcnt vmcnt(0)
    s_branch L_next
L_slow:
    s_cmp_eq_u32 s45, 0
    s_cbranch_scc1 L_quit
    buffer_load_dword v13, off, s[12:15], s22 sc1
    s_waitcnt vmcnt(0)
    v_readfirstlane_b32 s21, v13
    s_nop 0
L_chk8:
    s_and_b32 s21, s21, 15
    s_cmp_eq_u32 s21, 8
    s_cbranch_scc0 L_no8
    v_mov_b32 v21, 1
    s_or_b32 s45, s45, 1
    s_branch L_wf2
L_no8:
    s_cmp_eq_u32 s45, 0
    s_cbranch_scc1 L_next
    s_sleep 64
    s_branch L_wf2
L_quit:
    s_lshl_b32 s21, 0x100, s3
    v_mov_b32 v13, s21
    s_mov_b64 exec, 1
    buffer_atomic_or v13, off, s[12:15], s22 sc0 sc1
    s_waitcnt vmcnt(0)
    v_readfirstlane_b32 s21, v13
    s_mov_b64 exec, -1
    s_branch L_chk8
L_done:
L_end:
    s_endpgm
L_fix0:
    s_mov_b32 s12, s16
    s_mov_b32 s13, s17
    s_mov_b32 s14, s18
    s_mov_b32 s30, s31
    s_mov_b32 s16, s20
    s_mov_b32 s17, s21
    s_mov_b32 s18, s22
    v_mbcnt_lo_u32_b32 v22, -1, 0
    v_mbcnt_hi_u32_b32 v22, -1, v22
    v_bfe_u32 v23, v22, 4, 1
    v_lshlrev_b32 v5, 6, v23
    v_bfe_u32 v23, v22, 3, 1
    v_lshl_add_u32 v5, v23, 4, v5
    v_lshrrev_b32 v23, 5, v22
    v_lshl_add_u32 v5, v23, 3, v5
    s_lshl_b32 s48, s28, 1
    v_add_u32 v5, s48, v5
    v_mul_u32_u24 v5, 896, v5
    v_and_b32 v23, 7, v22
    v_lshl_add_u32 v5, v23, 4, v5
    s_lshr_b32 s31, s62, 12
    s_add_u32 s31, s31, 2048
    s_mov_b32 s35, 114688
    s_mov_b32 s55, 27632
    s_mov_b32 s60, -1184
    s_mov_b32 s61, 26448
    v_min_u32 v22, 55, v22
    v_lshlrev_b32 v22, 7, v22
    s_mul_i32 s48, s45, 28672
    s_mul_i32 s49, s28, 7168
    s_add_u32 s48, s48, s49
    buffer_load_dword v23, v22, s[20:23], s48 offen offset:2048
    s_branch L_fixret0
L_fix1:
    s_mov_b32 s12, s20
    s_mov_b32 s13, s21
    s_mov_b32 s14, s22
    v_mov_b32 v4, v5
    s_lshr_b32 s30, s63, 12
    s_add_u32 s30, s30, 2048
    s_mov_b32 s34, 114688
    s_mov_b32 s32, 27632
    s_mov_b32 s33, -1184
    s_mov_b32 s54, 26448
    s_branch L_fixret1
L_urg:
    s_waitcnt vmcnt(12)
    buffer_store_dword v19, off, s[4:7], s54 sc1
    s_branch L_urgret
L_fetch:
    v_cmp_ne_u32 vcc, 0, v21
    s_nop 0
    s_andn2_b32 s48, vcc_lo, s61
    s_and_b32 s48, s48, 0xff
    s_or_b32 s61, s61, s48
    s_bitcmp1_b32 s48, 0
    s_cbranch_scc0 L_ft0
    s_add_u32 s49, s60, 0
    buffer_load_dwordx4 a[0:3], v0, s[24:27], s49 offen offset:0 sc1
    buffer_load_dwordx4 a[4:7], v0, s[24:27], s49 offen offset:1024 sc1
    buffer_load_dwordx4 a[8:11], v0, s[24:27], s49 offen offset:2048 sc1
    buffer_load_dwordx4 a[12:15], v0, s[24:27], s49 offen offset:3072 sc1
L_ft0:
    s_bitcmp1_b32 s48, 1
    s_cbranch_scc0 L_ft1
    s_add_u32 s49, s60, 16384
    buffer_load_dwordx4 a[16:19], v0, s[24:27], s49 offen offset:0 sc1
    buffer_load_dwordx4 a[20:23], v0, s[24:27], s49 offen offset:1024 sc1
    buffer_load_dwordx4 a[24:27], v0, s[24:27], s49 offen offset:2048 sc1
    buffer_load_dwordx4 a[28:31], v0, s[24:27], s49 offen offset:3072 sc1
L_ft1:
    s_bitcmp1_b32 s48, 2
    s_cbranch_scc0 L_ft2
    s_add_u32 s49, s60, 32768
    buffer_load_dwordx4 a[32:35], v0, s[24:27], s49 offen offset:0 sc1
    buffer_load_dwordx4 a[36:39], v0, s[24:27], s49 offen offset:1024 sc1
    buffer_load_dwordx4 a[40:43], v0, s[24:27], s49 offen offset:2048 sc1
    buffer_load_dwordx4 a[44:47], v0, s[24:27], s49 offen offset:3072 sc1
L_ft2:
    s_bitcmp1_b32 s48, 3
    s_cbranch_scc0 L_ft3
    s_add_u32 s49, s60, 49152
    buffer_load_dwordx4 a[48:51], v0, s[24:27], s49 offen offset:0 sc1
    buffer_load_dwordx4 a[52:55], v0, s[24:27], s49 offen offset:1024 sc1
    buffer_load_dwordx4 a[56:59], v0, s[24:27], s49 offen offset:2048 sc1
    buffer_load_dwordx4 a[60:63], v0, s[24:27], s49 offen offset:3072 sc1
L_ft3:
    s_bitcmp1_b32 s48, 4
    s_cbranch_scc0 L_ft4
    s_add_u32 s49, s60, 65536
    buffer_load_dwordx4 a[64:67], v0, s[24:27], s49 offen offset:0 sc1
    buffer_load_dwordx4 a[68:71], v0, s[24:27], s49 offen offset:1024 sc1
    buffer_load_dwordx4 a[72:75], v0, s[24:27], s49 offen offset:2048 sc1
    buffer_load_dwordx4 a[76:79], v0, s[24:27], s49 offen offset:3072 sc1
L_ft4:
    s_bitcmp1_b32 s48, 5
    s_cbranch_scc0 L_ft5
    s_add_u32 s49, s60, 81920
    buffer_load_dwordx4 a[80:83], v0, s[24:27], s49 offen offset:0 sc1
    buffer_load_dwordx4 a[84:87], v0, s[24:27], s49 offen offset:1024 sc1
    buffer_load_dwordx4 a[88:91], v0, s[24:27], s49 offen offset:2048 sc1
    buffer_load_dwordx4 a[92:95], v0, s[24:27], s49 offen offset:3072 sc1
L_ft5:
    s_bitcmp1_b32 s48, 7
    s_cbranch_scc0 L_ft7
    s_add_u32 s49, s60, 114688
    buffer_load_dwordx4 a[112:115], v0, s[24:27], s49 offen offset:0 sc1
    buffer_load_dwordx4 a[116:119], v0, s[24:27], s49 offen offset:1024 sc1
    buffer_load_dwordx4 a[120:123], v0, s[24:27], s49 offen offset:2048 sc1
    buffer_load_dwordx4 a[124:127], v0, s[24:27], s49 offen offset:3072 sc1
L_ft7:
    s_setpc_b64 s[46:47]
L_rarep0:
    s_call_b64 s[46:47], L_fn_c1_1
    s_branch L_backp0
L_rarea1:
    s_call_b64 s[46:47], L_fn_c2_1
    s_branch L_backa1
L_rareb1:
    s_call_b64 s[46:47], L_fn_c1_0
    s_branch L_backb1
L_rarea0:
    s_call_b64 s[46:47], L_fn_c2_0
    s_branch L_backa0
L_rareb0:
    s_call_b64 s[46:47], L_fn_c1_1
    s_branch L_backb0
L_raret:
    s_call_b64 s[46:47], L_fn_c2_1
    s_branch L_backt
L_fn_c1_0:
    s_nop 7
    s_nop 7
    v_max3_f32 v18, v80, v81, v82
    v_max3_f32 v18, v18, v83, v84
    v_max3_f32 v18, v18, v85, v86
    v_max3_f32 v18, v18, v87, 0
    v_max3_f32 v19, v88, v89, v90
    v_max3_f32 v19, v19, v91, v92
    v_max3_f32 v19, v19, v93, v94
    v_max3_f32 v19, v19, v95, 0
    v_mov_b32 v20, v18
    v_mov_b32 v21, v19
    s_nop 0
    v_permlane32_swap_b32 v18, v20
    v_permlane32_swap_b32 v19, v21
    v_max_f32 v18, v18, v20
    v_max_f32 v19, v19, v21
    v_mov_b32 v20, v18
    v_mov_b32 v21, v19
    s_nop 0
    v_permlane16_swap_b32 v18, v20
    v_permlane16_swap_b32 v19, v21
    v_max_f32 v18, v18, v20
    v_max_f32 v19, v19, v21
    v_add_f32 v6, v6, v18
    v_add_f32 v7, v7, v19
    v_exp_f32 v20, -v18
    v_exp_f32 v21, -v19
    v_mul_f32 v10, v10, v20
    v_mul_f32 v11, v11, v21
    v_sub_f32 v80, v80, v18
    v_sub_f32 v81, v81, v18
    v_exp_f32 v14, v80
    v_exp_f32 v15, v81
    s_nop 0
    v_add_f32 v16, v14, v15
    v_cvt_pk_bf16_f32 v56, v14, v15
    v_sub_f32 v82, v82, v18
    v_sub_f32 v83, v83, v18
    v_exp_f32 v14, v82
    v_exp_f32 v15, v83
    v_add_f32 v16, v16, v14
    v_add_f32 v16, v16, v15
    v_cvt_pk_bf16_f32 v57, v14, v15
    v_sub_f32 v84, v84, v18
    v_sub_f32 v85, v85, v18
    v_exp_f32 v14, v84
    v_exp_f32 v15, v85
    v_add_f32 v16, v16, v14
    v_add_f32 v16, v16, v15
    v_cvt_pk_bf16_f32 v58, v14, v15
    v_sub_f32 v86, v86, v18
    v_sub_f32 v87, v87, v18
    v_exp_f32 v14, v86
    v_exp_f32 v15, v87
    v_add_f32 v16, v16, v14
    v_add_f32 v16, v16, v15
    v_cvt_pk_bf16_f32 v59, v14, v15
    v_cmp_lt_f32 vcc, 0x42800000, v18
    s_nop 1
    v_cndmask_b32 v10, v10, v16, vcc
    v_sub_f32 v88, v88, v19
    v_sub_f32 v89, v89, v19
    v_exp_f32 v14, v88
    v_exp_f32 v15, v89
    s_nop 0
    v_add_f32 v16, v14, v15
    v_cvt_pk_bf16_f32 v60, v14, v15
    v_sub_f32 v90, v90, v19
    v_sub_f32 v91, v91, v19
    v_exp_f32 v14, v90
    v_exp_f32 v15, v91
    v_add_f32 v16, v16, v14
    v_add_f32 v16, v16, v15
    v_cvt_pk_bf16_f32 v61, v14, v15
    v_sub_f32 v92, v92, v19
    v_sub_f32 v93, v93, v19
    v_exp_f32 v14, v92
    v_exp_f32 v15, v93
    v_add_f32 v16, v16, v14
    v_add_f32 v16, v16, v15
    v_cvt_pk_bf16_f32 v62, v14, v15
    v_sub_f32 v94, v94, v19
    v_sub_f32 v95, v95, v19
    v_exp_f32 v14, v94
    v_exp_f32 v15, v95
    v_add_f32 v16, v16, v14
    v_add_f32 v16, v16, v15
    v_cvt_pk_bf16_f32 v63, v14, v15
    v_cmp_lt_f32 vcc, 0x42800000, v19
    s_nop 1
    v_cndmask_b32 v11, v11, v16, vcc
    s_branch L_rescale0
L_fn_c1_1:
    s_nop 7
    s_nop 7
    v_max3_f32 v18, v80, v81, v82
    v_max3_f32 v18, v18, v83, v84
    v_max3_f32 v18, v18, v85, v86
    v_max3_f32 v18, v18, v87, 0
    v_max3_f32 v19, v88, v89, v90
    v_max3_f32 v19, v19, v91, v92
    v_max3_f32 v19, v19, v93, v94
    v_max3_f32 v19, v19, v95, 0
    v_mov_b32 v20, v18
    v_mov_b32 v21, v19
    s_nop 0
    v_permlane32_swap_b32 v18, v20
    v_permlane32_swap_b32 v19, v21
    v_max_f32 v18, v18, v20
    v_max_f32 v19, v19, v21
    v_mov_b32 v20, v18
    v_mov_b32 v21, v19
    s_nop 0
    v_permlane16_swap_b32 v18, v20
    v_permlane16_swap_b32 v19, v21
    v_max_f32 v18, v18, v20
    v_max_f32 v19, v19, v21
    v_add_f32 v6, v6, v18
    v_add_f32 v7, v7, v19
    v_exp_f32 v20, -v18
    v_exp_f32 v21, -v19
    v_mul_f32 v10, v10, v20
    v_mul_f32 v11, v11, v21
    v_sub_f32 v80, v80, v18
    v_sub_f32 v81, v81, v18
    v_exp_f32 v14, v80
    v_exp_f32 v15, v81
    s_nop 0
    v_add_f32 v16, v14, v15
    v_cvt_pk_bf16_f32 v64, v14, v15
    v_sub_f32 v82, v82, v18
    v_sub_f32 v83, v83, v18
    v_exp_f32 v14, v82
    v_exp_f32 v15, v83
    v_add_f32 v16, v16, v14
    v_add_f32 v16, v16, v15
    v_cvt_pk_bf16_f32 v65, v14, v15
    v_sub_f32 v84, v84, v18
    v_sub_f32 v85, v85, v18
    v_exp_f32 v14, v84
    v_exp_f32 v15, v85
    v_add_f32 v16, v16, v14
    v_add_f32 v16, v16, v15
    v_cvt_pk_bf16_f32 v66, v14, v15
    v_sub_f32 v86, v86, v18
    v_sub_f32 v87, v87, v18
    v_exp_f32 v14, v86
    v_exp_f32 v15, v87
    v_add_f32 v16, v16, v14
    v_add_f32 v16, v16, v15
    v_cvt_pk_bf16_f32 v67, v14, v15
    v_cmp_lt_f32 vcc, 0x42800000, v18
    s_nop 1
    v_cndmask_b32 v10, v10, v16, vcc
    v_sub_f32 v88, v88, v19
    v_sub_f32 v89, v89, v19
    v_exp_f32 v14, v88
    v_exp_f32 v15, v89
    s_nop 0
    v_add_f32 v16, v14, v15
    v_cvt_pk_bf16_f32 v68, v14, v15
    v_sub_f32 v90, v90, v19
    v_sub_f32 v91, v91, v19
    v_exp_f32 v14, v90
    v_exp_f32 v15, v91
    v_add_f32 v16, v16, v14
    v_add_f32 v16, v16, v15
    v_cvt_pk_bf16_f32 v69, v14, v15
    v_sub_f32 v92, v92, v19
    v_sub_f32 v93, v93, v19
    v_exp_f32 v14, v92
    v_exp_f32 v15, v93
    v_add_f32 v16, v16, v14
    v_add_f32 v16, v16, v15
    v_cvt_pk_bf16_f32 v70, v14, v15
    v_sub_f32 v94, v94, v19
    v_sub_f32 v95, v95, v19
    v_exp_f32 v14, v94
    v_exp_f32 v15, v95
    v_add_f32 v16, v16, v14
    v_add_f32 v16, v16, v15
    v_cvt_pk_bf16_f32 v71, v14, v15
    v_cmp_lt_f32 vcc, 0x42800000, v19
    s_nop 1
    v_cndmask_b32 v11, v11, v16, vcc
    s_branch L_rescale0
L_fn_c2_0:
    s_nop 7
    s_nop 7
    v_max3_f32 v18, v96, v97, v98
    v_max3_f32 v18, v18, v99, v100
    v_max3_f32 v18, v18, v101, v102
    v_max3_f32 v18, v18, v103, 0
    v_max3_f32 v19, v104, v105, v106
    v_max3_f32 v19, v19, v107, v108
    v_max3_f32 v19, v19, v109, v110
    v_max3_f32 v19, v19, v111, 0
    v_mov_b32 v20, v18
    v_mov_b32 v21, v19
    s_nop 0
    v_permlane32_swap_b32 v18, v20
    v_permlane32_swap_b32 v19, v21
    v_max_f32 v18, v18, v20
    v_max_f32 v19, v19, v21
    v_mov_b32 v20, v18
    v_mov_b32 v21, v19
    s_nop 0
    v_permlane16_swap_b32 v18, v20
    v_permlane16_swap_b32 v19, v21
    v_max_f32 v18, v18, v20
    v_max_f32 v19, v19, v21
    v_add_f32 v8, v8, v18
    v_add_f32 v9, v9, v19
    v_exp_f32 v20, -v18
    v_exp_f32 v21, -v19
    v_mul_f32 v12, v12, v20
    v_mul_f32 v13, v13, v21
    v_sub_f32 v96, v96, v18
    v_sub_f32 v97, v97, v18
    v_exp_f32 v14, v96
    v_exp_f32 v15, v97
    s_nop 0
    v_add_f32 v16, v14, v15
    v_cvt_pk_bf16_f32 v72, v14, v15
    v_sub_f32 v98, v98, v18
    v_sub_f32 v99, v99, v18
    v_exp_f32 v14, v98
    v_exp_f32 v15, v99
    v_add_f32 v16, v16, v14
    v_add_f32 v16, v16, v15
    v_cvt_pk_bf16_f32 v73, v14, v15
    v_sub_f32 v100, v100, v18
    v_sub_f32 v101, v101, v18
    v_exp_f32 v14, v100
    v_exp_f32 v15, v101
    v_add_f32 v16, v16, v14
    v_add_f32 v16, v16, v15
    v_cvt_pk_bf16_f32 v74, v14, v15
    v_sub_f32 v102, v102, v18
    v_sub_f32 v103, v103, v18
    v_exp_f32 v14, v102
    v_exp_f32 v15, v103
    v_add_f32 v16, v16, v14
    v_add_f32 v16, v16, v15
    v_cvt_pk_bf16_f32 v75, v14, v15
    v_cmp_lt_f32 vcc, 0x42800000, v18
    s_nop 1
    v_cndmask_b32 v12, v12, v16, vcc
    v_sub_f32 v104, v104, v19
    v_sub_f32 v105, v105, v19
    v_exp_f32 v14, v104
    v_exp_f32 v15, v105
    s_nop 0
    v_add_f32 v16, v14, v15
    v_cvt_pk_bf16_f32 v76, v14, v15
    v_sub_f32 v106, v106, v19
    v_sub_f32 v107, v107, v19
    v_exp_f32 v14, v106
    v_exp_f32 v15, v107
    v_add_f32 v16, v16, v14
    v_add_f32 v16, v16, v15
    v_cvt_pk_bf16_f32 v77, v14, v15
    v_sub_f32 v108, v108, v19
    v_sub_f32 v109, v109, v19
    v_exp_f32 v14, v108
    v_exp_f32 v15, v109
    v_add_f32 v16, v16, v14
    v_add_f32 v16, v16, v15
    v_cvt_pk_bf16_f32 v78, v14, v15
    v_sub_f32 v110, v110, v19
    v_sub_f32 v111, v111, v19
    v_exp_f32 v14, v110
    v_exp_f32 v15, v111
    v_add_f32 v16, v16, v14
    v_add_f32 v16, v16, v15
    v_cvt_pk_bf16_f32 v79, v14, v15
    v_cmp_lt_f32 vcc, 0x42800000, v19
    s_nop 1
    v_cndmask_b32 v13, v13, v16, vcc
    s_branch L_rescale2
L_fn_c2_1:
    s_nop 7
    s_nop 7
    v_max3_f32 v18, v112, v113, v114
    v_max3_f32 v18, v18, v115, v116
    v_max3_f32 v18, v18, v117, v118
    v_max3_f32 v18, v18, v119, 0
    v_max3_f32 v19, v120, v121, v122
    v_max3_f32 v19, v19, v123, v124
    v_max3_f32 v19, v19, v125, v126
    v_max3_f32 v19, v19, v127, 0
    v_mov_b32 v20, v18
    v_mov_b32 v21, v19
    s_nop 0
    v_permlane32_swap_b32 v18, v20
    v_permlane32_swap_b32 v19, v21
    v_max_f32 v18, v18, v20
    v_max_f32 v19, v19, v21
    v_mov_b32 v20, v18
    v_mov_b32 v21, v19
    s_nop 0
    v_permlane16_swap_b32 v18, v20
    v_permlane16_swap_b32 v19, v21
    v_max_f32 v18, v18, v20
    v_max_f32 v19, v19, v21
    v_add_f32 v8, v8, v18
    v_add_f32 v9, v9, v19
    v_exp_f32 v20, -v18
    v_exp_f32 v21, -v19
    v_mul_f32 v12, v12, v20
    v_mul_f32 v13, v13, v21
    v_sub_f32 v112, v112, v18
    v_sub_f32 v113, v113, v18
    v_exp_f32 v14, v112
    v_exp_f32 v15, v113
    s_nop 0
    v_add_f32 v16, v14, v15
    v_cvt_pk_bf16_f32 v72, v14, v15
    v_sub_f32 v114, v114, v18
    v_sub_f32 v115, v115, v18
    v_exp_f32 v14, v114
    v_exp_f32 v15, v115
    v_add_f32 v16, v16, v14
    v_add_f32 v16, v16, v15
    v_cvt_pk_bf16_f32 v73, v14, v15
    v_sub_f32 v116, v116, v18
    v_sub_f32 v117, v117, v18
    v_exp_f32 v14, v116
    v_exp_f32 v15, v117
    v_add_f32 v16, v16, v14
    v_add_f32 v16, v16, v15
    v_cvt_pk_bf16_f32 v74, v14, v15
    v_sub_f32 v118, v118, v18
    v_sub_f32 v119, v119, v18
    v_exp_f32 v14, v118
    v_exp_f32 v15, v119
    v_add_f32 v16, v16, v14
    v_add_f32 v16, v16, v15
    v_cvt_pk_bf16_f32 v75, v14, v15
    v_cmp_lt_f32 vcc, 0x42800000, v18
    s_nop 1
    v_cndmask_b32 v12, v12, v16, vcc
    v_sub_f32 v120, v120, v19
    v_sub_f32 v121, v121, v19
    v_exp_f32 v14, v120
    v_exp_f32 v15, v121
    s_nop 0
    v_add_f32 v16, v14, v15
    v_cvt_pk_bf16_f32 v76, v14, v15
    v_sub_f32 v122, v122, v19
    v_sub_f32 v123, v123, v19
    v_exp_f32 v14, v122
    v_exp_f32 v15, v123
    v_add_f32 v16, v16, v14
    v_add_f32 v16, v16, v15
    v_cvt_pk_bf16_f32 v77, v14, v15
    v_sub_f32 v124, v124, v19
    v_sub_f32 v125, v125, v19
    v_exp_f32 v14, v124
    v_exp_f32 v15, v125
    v_add_f32 v16, v16, v14
    v_add_f32 v16, v16, v15
    v_cvt_pk_bf16_f32 v78, v14, v15
    v_sub_f32 v126, v126, v19
    v_sub_f32 v127, v127, v19
    v_exp_f32 v14, v126
    v_exp_f32 v15, v127
    v_add_f32 v16, v16, v14
    v_add_f32 v16, v16, v15
    v_cvt_pk_bf16_f32 v79, v14, v15
    v_cmp_lt_f32 vcc, 0x42800000, v19
    s_nop 1
    v_cndmask_b32 v13, v13, v16, vcc
    s_branch L_rescale2
L_rescale0:
    v_accvgpr_read_b32 v14, a0
    v_accvgpr_read_b32 v15, a1
    v_accvgpr_read_b32 v16, a2
    v_accvgpr_read_b32 v17, a3
    v_mul_f32 v14, v14, v20
    v_mul_f32 v15, v15, v20
    v_mul_f32 v16, v16, v20
    v_mul_f32 v17, v17, v20
    v_accvgpr_write_b32 a0, v14
    v_accvgpr_write_b32 a1, v15
    v_accvgpr_write_b32 a2, v16
    v_accvgpr_write_b32 a3, v17
    v_accvgpr_read_b32 v14, a4
    v_accvgpr_read_b32 v15, a5
    v_accvgpr_read_b32 v16, a6
    v_accvgpr_read_b32 v17, a7
    v_mul_f32 v14, v14, v20
    v_mul_f32 v15, v15, v20
    v_mul_f32 v16, v16, v20
    v_mul_f32 v17, v17, v20
    v_accvgpr_write_b32 a4, v14
    v_accvgpr_write_b32 a5, v15
    v_accvgpr_write_b32 a6, v16
    v_accvgpr_write_b32 a7, v17
    v_accvgpr_read_b32 v14, a8
    v_accvgpr_read_b32 v15, a9
    v_accvgpr_read_b32 v16, a10
    v_accvgpr_read_b32 v17, a11
    v_mul_f32 v14, v14, v20
    v_mul_f32 v15, v15, v20
    v_mul_f32 v16, v16, v20
    v_mul_f32 v17, v17, v20
    v_accvgpr_write_b32 a8, v14
    v_accvgpr_write_b32 a9, v15
    v_accvgpr_write_b32 a10, v16
    v_accvgpr_write_b32 a11, v17
    v_accvgpr_read_b32 v14, a12
    v_accvgpr_read_b32 v15, a13
    v_accvgpr_read_b32 v16, a14
    v_accvgpr_read_b32 v17, a15
    v_mul_f32 v14, v14, v20
    v_mul_f32 v15, v15, v20
    v_mul_f32 v16, v16, v20
    v_mul_f32 v17, v17, v20
    v_accvgpr_write_b32 a12, v14
    v_accvgpr_write_b32 a13, v15
    v_accvgpr_write_b32 a14, v16
    v_accvgpr_write_b32 a15, v17
    v_accvgpr_read_b32 v14, a16
    v_accvgpr_read_b32 v15, a17
    v_accvgpr_read_b32 v16, a18
    v_accvgpr_read_b32 v17, a19
    v_mul_f32 v14, v14, v20
    v_mul_f32 v15, v15, v20
    v_mul_f32 v16, v16, v20
    v_mul_f32 v17, v17, v20
    v_accvgpr_write_b32 a16, v14
    v_accvgpr_write_b32 a17, v15
    v_accvgpr_write_b32 a18, v16
    v_accvgpr_write_b32 a19, v17
    v_accvgpr_read_b32 v14, a20
    v_accvgpr_read_b32 v15, a21
    v_accvgpr_read_b32 v16, a22
    v_accvgpr_read_b32 v17, a23
    v_mul_f32 v14, v14, v20
    v_mul_f32 v15, v15, v20
    v_mul_f32 v16, v16, v20
    v_mul_f32 v17, v17, v20
    v_accvgpr_write_b32 a20, v14
    v_accvgpr_write_b32 a21, v15
    v_accvgpr_write_b32 a22, v16
    v_accvgpr_write_b32 a23, v17
    v_accvgpr_read_b32 v14, a24
    v_accvgpr_read_b32 v15, a25
    v_accvgpr_read_b32 v16, a26
    v_accvgpr_read_b32 v17, a27
    v_mul_f32 v14, v14, v20
    v_mul_f32 v15, v15, v20
    v_mul_f32 v16, v16, v20
    v_mul_f32 v17, v17, v20
    v_accvgpr_write_b32 a24, v14
    v_accvgpr_write_b32 a25, v15
    v_accvgpr_write_b32 a26, v16
    v_accvgpr_write_b32 a27, v17
    v_accvgpr_read_b32 v14, a28
    v_accvgpr_read_b32 v15, a29
    v_accvgpr_read_b32 v16, a30
    v_accvgpr_read_b32 v17, a31
    v_mul_f32 v14, v14, v20
    v_mul_f32 v15, v15, v20
    v_mul_f32 v16, v16, v20
    v_mul_f32 v17, v17, v20
    v_accvgpr_write_b32 a28, v14
    v_accvgpr_write_b32 a29, v15
    v_accvgpr_write_b32 a30, v16
    v_accvgpr_write_b32 a31, v17
    v_accvgpr_read_b32 v14, a32
    v_accvgpr_read_b32 v15, a33
    v_accvgpr_read_b32 v16, a34
    v_accvgpr_read_b32 v17, a35
    v_mul_f32 v14, v14, v20
    v_mul_f32 v15, v15, v20
    v_mul_f32 v16, v16, v20
    v_mul_f32 v17, v17, v20
    v_accvgpr_write_b32 a32, v14
    v_accvgpr_write_b32 a33, v15
    v_accvgpr_write_b32 a34, v16
    v_accvgpr_write_b32 a35, v17
    v_accvgpr_read_b32 v14, a36
    v_accvgpr_read_b32 v15, a37
    v_accvgpr_read_b32 v16, a38
    v_accvgpr_read_b32 v17, a39
    v_mul_f32 v14, v14, v20
    v_mul_f32 v15, v15, v20
    v_mul_f32 v16, v16, v20
    v_mul_f32 v17, v17, v20
    v_accvgpr_write_b32 a36, v14
    v_accvgpr_write_b32 a37, v15
    v_accvgpr_write_b32 a38, v16
    v_accvgpr_write_b32 a39, v17
    v_accvgpr_read_b32 v14, a40
    v_accvgpr_read_b32 v15, a41
    v_accvgpr_read_b32 v16, a42
    v_accvgpr_read_b32 v17, a43
    v_mul_f32 v14, v14, v20
    v_mul_f32 v15, v15, v20
    v_mul_f32 v16, v16, v20
    v_mul_f32 v17, v17, v20
    v_accvgpr_write_b32 a40, v14
    v_accvgpr_write_b32 a41, v15
    v_accvgpr_write_b32 a42, v16
    v_accvgpr_write_b32 a43, v17
    v_accvgpr_read_b32 v14, a44
    v_accvgpr_read_b32 v15, a45
    v_accvgpr_read_b32 v16, a46
    v_accvgpr_read_b32 v17, a47
    v_mul_f32 v14, v14, v20
    v_mul_f32 v15, v15, v20
    v_mul_f32 v16, v16, v20
    v_mul_f32 v17, v17, v20
    v_accvgpr_write_b32 a44, v14
    v_accvgpr_write_b32 a45, v15
    v_accvgpr_write_b32 a46, v16
    v_accvgpr_write_b32 a47, v17
    v_accvgpr_read_b32 v14, a48
    v_accvgpr_read_b32 v15, a49
    v_accvgpr_read_b32 v16, a50
    v_accvgpr_read_b32 v17, a51
    v_mul_f32 v14, v14, v20
    v_mul_f32 v15, v15, v20
    v_mul_f32 v16, v16, v20
    v_mul_f32 v17, v17, v20
    v_accvgpr_write_b32 a48, v14
    v_accvgpr_write_b32 a49, v15
    v_accvgpr_write_b32 a50, v16
    v_accvgpr_write_b32 a51, v17
    v_accvgpr_read_b32 v14, a52
    v_accvgpr_read_b32 v15, a53
    v_accvgpr_read_b32 v16, a54
    v_accvgpr_read_b32 v17, a55
    v_mul_f32 v14, v14, v20
    v_mul_f32 v15, v15, v20
    v_mul_f32 v16, v16, v20
    v_mul_f32 v17, v17, v20
    v_accvgpr_write_b32 a52, v14
    v_accvgpr_write_b32 a53, v15
    v_accvgpr_write_b32 a54, v16
    v_accvgpr_write_b32 a55, v17
    v_accvgpr_read_b32 v14, a56
    v_accvgpr_read_b32 v15, a57
    v_accvgpr_read_b32 v16, a58
    v_accvgpr_read_b32 v17, a59
    v_mul_f32 v14, v14, v20
    v_mul_f32 v15, v15, v20
    v_mul_f32 v16, v16, v20
    v_mul_f32 v17, v17, v20
    v_accvgpr_write_b32 a56, v14
    v_accvgpr_write_b32 a57, v15
    v_accvgpr_write_b32 a58, v16
    v_accvgpr_write_b32 a59, v17
    v_accvgpr_read_b32 v14, a60
    v_accvgpr_read_b32 v15, a61
    v_accvgpr_read_b32 v16, a62
    v_accvgpr_read_b32 v17, a63
    v_mul_f32 v14, v14, v20
    v_mul_f32 v15, v15, v20
    v_mul_f32 v16, v16, v20
    v_mul_f32 v17, v17, v20
    v_accvgpr_write_b32 a60, v14
    v_accvgpr_write_b32 a61, v15
    v_accvgpr_write_b32 a62, v16
    v_accvgpr_write_b32 a63, v17
    v_accvgpr_read_b32 v14, a64
    v_accvgpr_read_b32 v15, a65
    v_accvgpr_read_b32 v16, a66
    v_accvgpr_read_b32 v17, a67
    v_mul_f32 v14, v14, v21
    v_mul_f32 v15, v15, v21
    v_mul_f32 v16, v16, v21
    v_mul_f32 v17, v17, v21
    v_accvgpr_write_b32 a64, v14
    v_accvgpr_write_b32 a65, v15
    v_accvgpr_write_b32 a66, v16
    v_accvgpr_write_b32 a67, v17
    v_accvgpr_read_b32 v14, a68
    v_accvgpr_read_b32 v15, a69
    v_accvgpr_read_b32 v16, a70
    v_accvgpr_read_b32 v17, a71
    v_mul_f32 v14, v14, v21
    v_mul_f32 v15, v15, v21
    v_mul_f32 v16, v16, v21
    v_mul_f32 v17, v17, v21
    v_accvgpr_write_b32 a68, v14
    v_accvgpr_write_b32 a69, v15
    v_accvgpr_write_b32 a70, v16
    v_accvgpr_write_b32 a71, v17
    v_accvgpr_read_b32 v14, a72
    v_accvgpr_read_b32 v15, a73
    v_accvgpr_read_b32 v16, a74
    v_accvgpr_read_b32 v17, a75
    v_mul_f32 v14, v14, v21
    v_mul_f32 v15, v15, v21
    v_mul_f32 v16, v16, v21
    v_mul_f32 v17, v17, v21
    v_accvgpr_write_b32 a72, v14
    v_accvgpr_write_b32 a73, v15
    v_accvgpr_write_b32 a74, v16
    v_accvgpr_write_b32 a75, v17
    v_accvgpr_read_b32 v14, a76
    v_accvgpr_read_b32 v15, a77
    v_accvgpr_read_b32 v16, a78
    v_accvgpr_read_b32 v17, a79
    v_mul_f32 v14, v14, v21
    v_mul_f32 v15, v15, v21
    v_mul_f32 v16, v16, v21
    v_mul_f32 v17, v17, v21
    v_accvgpr_write_b32 a76, v14
    v_accvgpr_write_b32 a77, v15
    v_accvgpr_write_b32 a78, v16
    v_accvgpr_write_b32 a79, v17
    v_accvgpr_read_b32 v14, a80
    v_accvgpr_read_b32 v15, a81
    v_accvgpr_read_b32 v16, a82
    v_accvgpr_read_b32 v17, a83
    v_mul_f32 v14, v14, v21
    v_mul_f32 v15, v15, v21
    v_mul_f32 v16, v16, v21
    v_mul_f32 v17, v17, v21
    v_accvgpr_write_b32 a80, v14
    v_accvgpr_write_b32 a81, v15
    v_accvgpr_write_b32 a82, v16
    v_accvgpr_write_b32 a83, v17
    v_accvgpr_read_b32 v14, a84
    v_accvgpr_read_b32 v15, a85
    v_accvgpr_read_b32 v16, a86
    v_accvgpr_read_b32 v17, a87
    v_mul_f32 v14, v14, v21
    v_mul_f32 v15, v15, v21
    v_mul_f32 v16, v16, v21
    v_mul_f32 v17, v17, v21
    v_accvgpr_write_b32 a84, v14
    v_accvgpr_write_b32 a85, v15
    v_accvgpr_write_b32 a86, v16
    v_accvgpr_write_b32 a87, v17
    v_accvgpr_read_b32 v14, a88
    v_accvgpr_read_b32 v15, a89
    v_accvgpr_read_b32 v16, a90
    v_accvgpr_read_b32 v17, a91
    v_mul_f32 v14, v14, v21
    v_mul_f32 v15, v15, v21
    v_mul_f32 v16, v16, v21
    v_mul_f32 v17, v17, v21
    v_accvgpr_write_b32 a88, v14
    v_accvgpr_write_b32 a89, v15
    v_accvgpr_write_b32 a90, v16
    v_accvgpr_write_b32 a91, v17
    v_accvgpr_read_b32 v14, a92
    v_accvgpr_read_b32 v15, a93
    v_accvgpr_read_b32 v16, a94
    v_accvgpr_read_b32 v17, a95
    v_mul_f32 v14, v14, v21
    v_mul_f32 v15, v15, v21
    v_mul_f32 v16, v16, v21
    v_mul_f32 v17, v17, v21
    v_accvgpr_write_b32 a92, v14
    v_accvgpr_write_b32 a93, v15
    v_accvgpr_write_b32 a94, v16
    v_accvgpr_write_b32 a95, v17
    v_accvgpr_read_b32 v14, a96
    v_accvgpr_read_b32 v15, a97
    v_accvgpr_read_b32 v16, a98
    v_accvgpr_read_b32 v17, a99
    v_mul_f32 v14, v14, v21
    v_mul_f32 v15, v15, v21
    v_mul_f32 v16, v16, v21
    v_mul_f32 v17, v17, v21
    v_accvgpr_write_b32 a96, v14
    v_accvgpr_write_b32 a97, v15
    v_accvgpr_write_b32 a98, v16
    v_accvgpr_write_b32 a99, v17
    v_accvgpr_read_b32 v14, a100
    v_accvgpr_read_b32 v15, a101
    v_accvgpr_read_b32 v16, a102
    v_accvgpr_read_b32 v17, a103
    v_mul_f32 v14, v14, v21
    v_mul_f32 v15, v15, v21
    v_mul_f32 v16, v16, v21
    v_mul_f32 v17, v17, v21
    v_accvgpr_write_b32 a100, v14
    v_accvgpr_write_b32 a101, v15
    v_accvgpr_write_b32 a102, v16
    v_accvgpr_write_b32 a103, v17
    v_accvgpr_read_b32 v14, a104
    v_accvgpr_read_b32 v15, a105
    v_accvgpr_read_b32 v16, a106
    v_accvgpr_read_b32 v17, a107
    v_mul_f32 v14, v14, v21
    v_mul_f32 v15, v15, v21
    v_mul_f32 v16, v16, v21
    v_mul_f32 v17, v17, v21
    v_accvgpr_write_b32 a104, v14
    v_accvgpr_write_b32 a105, v15
    v_accvgpr_write_b32 a106, v16
    v_accvgpr_write_b32 a107, v17
    v_accvgpr_read_b32 v14, a108
    v_accvgpr_read_b32 v15, a109
    v_accvgpr_read_b32 v16, a110
    v_accvgpr_read_b32 v17, a111
    v_mul_f32 v14, v14, v21
    v_mul_f32 v15, v15, v21
    v_mul_f32 v16, v16, v21
    v_mul_f32 v17, v17, v21
    v_accvgpr_write_b32 a108, v14
    v_accvgpr_write_b32 a109, v15
    v_accvgpr_write_b32 a110, v16
    v_accvgpr_write_b32 a111, v17
    v_accvgpr_read_b32 v14, a112
    v_accvgpr_read_b32 v15, a113
    v_accvgpr_read_b32 v16, a114
    v_accvgpr_read_b32 v17, a115
    v_mul_f32 v14, v14, v21
    v_mul_f32 v15, v15, v21
    v_mul_f32 v16, v16, v21
    v_mul_f32 v17, v17, v21
    v_accvgpr_write_b32 a112, v14
    v_accvgpr_write_b32 a113, v15
    v_accvgpr_write_b32 a114, v16
    v_accvgpr_write_b32 a115, v17
    v_accvgpr_read_b32 v14, a116
    v_accvgpr_read_b32 v15, a117
    v_accvgpr_read_b32 v16, a118
    v_accvgpr_read_b32 v17, a119
    v_mul_f32 v14, v14, v21
    v_mul_f32 v15, v15, v21
    v_mul_f32 v16, v16, v21
    v_mul_f32 v17, v17, v21
    v_accvgpr_write_b32 a116, v14
    v_accvgpr_write_b32 a117, v15
    v_accvgpr_write_b32 a118, v16
    v_accvgpr_write_b32 a119, v17
    v_accvgpr_read_b32 v14, a120
    v_accvgpr_read_b32 v15, a121
    v_accvgpr_read_b32 v16, a122
    v_accvgpr_read_b32 v17, a123
    v_mul_f32 v14, v14, v21
    v_mul_f32 v15, v15, v21
    v_mul_f32 v16, v16, v21
    v_mul_f32 v17, v17, v21
    v_accvgpr_write_b32 a120, v14
    v_accvgpr_write_b32 a121, v15
    v_accvgpr_write_b32 a122, v16
    v_accvgpr_write_b32 a123, v17
    v_accvgpr_read_b32 v14, a124
    v_accvgpr_read_b32 v15, a125
    v_accvgpr_read_b32 v16, a126
    v_accvgpr_read_b32 v17, a127
    v_mul_f32 v14, v14, v21
    v_mul_f32 v15, v15, v21
    v_mul_f32 v16, v16, v21
    v_mul_f32 v17, v17, v21
    v_accvgpr_write_b32 a124, v14
    v_accvgpr_write_b32 a125, v15
    v_accvgpr_write_b32 a126, v16
    v_accvgpr_write_b32 a127, v17
    s_nop 3
    s_setpc_b64 s[46:47]
L_rescale2:
    v_accvgpr_read_b32 v14, a128
    v_accvgpr_read_b32 v15, a129
    v_accvgpr_read_b32 v16, a130
    v_accvgpr_read_b32 v17, a131
    v_mul_f32 v14, v14, v20
    v_mul_f32 v15, v15, v20
    v_mul_f32 v16, v16, v20
    v_mul_f32 v17, v17, v20
    v_accvgpr_write_b32 a128, v14
    v_accvgpr_write_b32 a129, v15
    v_accvgpr_write_b32 a130, v16
    v_accvgpr_write_b32 a131, v17
    v_accvgpr_read_b32 v14, a132
    v_accvgpr_read_b32 v15, a133
    v_accvgpr_read_b32 v16, a134
    v_accvgpr_read_b32 v17, a135
    v_mul_f32 v14, v14, v20
    v_mul_f32 v15, v15, v20
    v_mul_f32 v16, v16, v20
    v_mul_f32 v17, v17, v20
    v_accvgpr_write_b32 a132, v14
    v_accvgpr_write_b32 a133, v15
    v_accvgpr_write_b32 a134, v16
    v_accvgpr_write_b32 a135, v17
    v_accvgpr_read_b32 v14, a136
    v_accvgpr_read_b32 v15, a137
    v_accvgpr_read_b32 v16, a138
    v_accvgpr_read_b32 v17, a139
    v_mul_f32 v14, v14, v20
    v_mul_f32 v15, v15, v20
    v_mul_f32 v16, v16, v20
    v_mul_f32 v17, v17, v20
    v_accvgpr_write_b32 a136, v14
    v_accvgpr_write_b32 a137, v15
    v_accvgpr_write_b32 a138, v16
    v_accvgpr_write_b32 a139, v17
    v_accvgpr_read_b32 v14, a140
    v_accvgpr_read_b32 v15, a141
    v_accvgpr_read_b32 v16, a142
    v_accvgpr_read_b32 v17, a143
    v_mul_f32 v14, v14, v20
    v_mul_f32 v15, v15, v20
    v_mul_f32 v16, v16, v20
    v_mul_f32 v17, v17, v20
    v_accvgpr_write_b32 a140, v14
    v_accvgpr_write_b32 a141, v15
    v_accvgpr_write_b32 a142, v16
    v_accvgpr_write_b32 a143, v17
    v_accvgpr_read_b32 v14, a144
    v_accvgpr_read_b32 v15, a145
    v_accvgpr_read_b32 v16, a146
    v_accvgpr_read_b32 v17, a147
    v_mul_f32 v14, v14, v20
    v_mul_f32 v15, v15, v20
    v_mul_f32 v16, v16, v20
    v_mul_f32 v17, v17, v20
    v_accvgpr_write_b32 a144, v14
    v_accvgpr_write_b32 a145, v15
    v_accvgpr_write_b32 a146, v16
    v_accvgpr_write_b32 a147, v17
    v_accvgpr_read_b32 v14, a148
    v_accvgpr_read_b32 v15, a149
    v_accvgpr_read_b32 v16, a150
    v_accvgpr_read_b32 v17, a151
    v_mul_f32 v14, v14, v20
    v_mul_f32 v15, v15, v20
    v_mul_f32 v16, v16, v20
    v_mul_f32 v17, v17, v20
    v_accvgpr_write_b32 a148, v14
    v_accvgpr_write_b32 a149, v15
    v_accvgpr_write_b32 a150, v16
    v_accvgpr_write_b32 a151, v17
    v_accvgpr_read_b32 v14, a152
    v_accvgpr_read_b32 v15, a153
    v_accvgpr_read_b32 v16, a154
    v_accvgpr_read_b32 v17, a155
    v_mul_f32 v14, v14, v20
    v_mul_f32 v15, v15, v20
    v_mul_f32 v16, v16, v20
    v_mul_f32 v17, v17, v20
    v_accvgpr_write_b32 a152, v14
    v_accvgpr_write_b32 a153, v15
    v_accvgpr_write_b32 a154, v16
    v_accvgpr_write_b32 a155, v17
    v_accvgpr_read_b32 v14, a156
    v_accvgpr_read_b32 v15, a157
    v_accvgpr_read_b32 v16, a158
    v_accvgpr_read_b32 v17, a159
    v_mul_f32 v14, v14, v20
    v_mul_f32 v15, v15, v20
    v_mul_f32 v16, v16, v20
    v_mul_f32 v17, v17, v20
    v_accvgpr_write_b32 a156, v14
    v_accvgpr_write_b32 a157, v15
    v_accvgpr_write_b32 a158, v16
    v_accvgpr_write_b32 a159, v17
    v_accvgpr_read_b32 v14, a160
    v_accvgpr_read_b32 v15, a161
    v_accvgpr_read_b32 v16, a162
    v_accvgpr_read_b32 v17, a163
    v_mul_f32 v14, v14, v20
    v_mul_f32 v15, v15, v20
    v_mul_f32 v16, v16, v20
    v_mul_f32 v17, v17, v20
    v_accvgpr_write_b32 a160, v14
    v_accvgpr_write_b32 a161, v15
    v_accvgpr_write_b32 a162, v16
    v_accvgpr_write_b32 a163, v17
    v_accvgpr_read_b32 v14, a164
    v_accvgpr_read_b32 v15, a165
    v_accvgpr_read_b32 v16, a166
    v_accvgpr_read_b32 v17, a167
    v_mul_f32 v14, v14, v20
    v_mul_f32 v15, v15, v20
    v_mul_f32 v16, v16, v20
    v_mul_f32 v17, v17, v20
    v_accvgpr_write_b32 a164, v14
    v_accvgpr_write_b32 a165, v15
    v_accvgpr_write_b32 a166, v16
    v_accvgpr_write_b32 a167, v17
    v_accvgpr_read_b32 v14, a168
    v_accvgpr_read_b32 v15, a169
    v_accvgpr_read_b32 v16, a170
    v_accvgpr_read_b32 v17, a171
    v_mul_f32 v14, v14, v20
    v_mul_f32 v15, v15, v20
    v_mul_f32 v16, v16, v20
    v_mul_f32 v17, v17, v20
    v_accvgpr_write_b32 a168, v14
    v_accvgpr_write_b32 a169, v15
    v_accvgpr_write_b32 a170, v16
    v_accvgpr_write_b32 a171, v17
    v_accvgpr_read_b32 v14, a172
    v_accvgpr_read_b32 v15, a173
    v_accvgpr_read_b32 v16, a174
    v_accvgpr_read_b32 v17, a175
    v_mul_f32 v14, v14, v20
    v_mul_f32 v15, v15, v20
    v_mul_f32 v16, v16, v20
    v_mul_f32 v17, v17, v20
    v_accvgpr_write_b32 a172, v14
    v_accvgpr_write_b32 a173, v15
    v_accvgpr_write_b32 a174, v16
    v_accvgpr_write_b32 a175, v17
    v_accvgpr_read_b32 v14, a176
    v_accvgpr_read_b32 v15, a177
    v_accvgpr_read_b32 v16, a178
    v_accvgpr_read_b32 v17, a179
    v_mul_f32 v14, v14, v20
    v_mul_f32 v15, v15, v20
    v_mul_f32 v16, v16, v20
    v_mul_f32 v17, v17, v20
    v_accvgpr_write_b32 a176, v14
    v_accvgpr_write_b32 a177, v15
    v_accvgpr_write_b32 a178, v16
    v_accvgpr_write_b32 a179, v17
    v_accvgpr_read_b32 v14, a180
    v_accvgpr_read_b32 v15, a181
    v_accvgpr_read_b32 v16, a182
    v_accvgpr_read_b32 v17, a183
    v_mul_f32 v14, v14, v20
    v_mul_f32 v15, v15, v20
    v_mul_f32 v16, v16, v20
    v_mul_f32 v17, v17, v20
    v_accvgpr_write_b32 a180, v14
    v_accvgpr_write_b32 a181, v15
    v_accvgpr_write_b32 a182, v16
    v_accvgpr_write_b32 a183, v17
    v_accvgpr_read_b32 v14, a184
    v_accvgpr_read_b32 v15, a185
    v_accvgpr_read_b32 v16, a186
    v_accvgpr_read_b32 v17, a187
    v_mul_f32 v14, v14, v20
    v_mul_f32 v15, v15, v20
    v_mul_f32 v16, v16, v20
    v_mul_f32 v17, v17, v20
    v_accvgpr_write_b32 a184, v14
    v_accvgpr_write_b32 a185, v15
    v_accvgpr_write_b32 a186, v16
    v_accvgpr_write_b32 a187, v17
    v_accvgpr_read_b32 v14, a188
    v_accvgpr_read_b32 v15, a189
    v_accvgpr_read_b32 v16, a190
    v_accvgpr_read_b32 v17, a191
    v_mul_f32 v14, v14, v20
    v_mul_f32 v15, v15, v20
    v_mul_f32 v16, v16, v20
    v_mul_f32 v17, v17, v20
    v_accvgpr_write_b32 a188, v14
    v_accvgpr_write_b32 a189, v15
    v_accvgpr_write_b32 a190, v16
    v_accvgpr_write_b32 a191, v17
    v_accvgpr_read_b32 v14, a192
    v_accvgpr_read_b32 v15, a193
    v_accvgpr_read_b32 v16, a194
    v_accvgpr_read_b32 v17, a195
    v_mul_f32 v14, v14, v21
    v_mul_f32 v15, v15, v21
    v_mul_f32 v16, v16, v21
    v_mul_f32 v17, v17, v21
    v_accvgpr_write_b32 a192, v14
    v_accvgpr_write_b32 a193, v15
    v_accvgpr_write_b32 a194, v16
    v_accvgpr_write_b32 a195, v17
    v_accvgpr_read_b32 v14, a196
    v_accvgpr_read_b32 v15, a197
    v_accvgpr_read_b32 v16, a198
    v_accvgpr_read_b32 v17, a199
    v_mul_f32 v14, v14, v21
    v_mul_f32 v15, v15, v21
    v_mul_f32 v16, v16, v21
    v_mul_f32 v17, v17, v21
    v_accvgpr_write_b32 a196, v14
    v_accvgpr_write_b32 a197, v15
    v_accvgpr_write_b32 a198, v16
    v_accvgpr_write_b32 a199, v17
    v_accvgpr_read_b32 v14, a200
    v_accvgpr_read_b32 v15, a201
    v_accvgpr_read_b32 v16, a202
    v_accvgpr_read_b32 v17, a203
    v_mul_f32 v14, v14, v21
    v_mul_f32 v15, v15, v21
    v_mul_f32 v16, v16, v21
    v_mul_f32 v17, v17, v21
    v_accvgpr_write_b32 a200, v14
    v_accvgpr_write_b32 a201, v15
    v_accvgpr_write_b32 a202, v16
    v_accvgpr_write_b32 a203, v17
    v_accvgpr_read_b32 v14, a204
    v_accvgpr_read_b32 v15, a205
    v_accvgpr_read_b32 v16, a206
    v_accvgpr_read_b32 v17, a207
    v_mul_f32 v14, v14, v21
    v_mul_f32 v15, v15, v21
    v_mul_f32 v16, v16, v21
    v_mul_f32 v17, v17, v21
    v_accvgpr_write_b32 a204, v14
    v_accvgpr_write_b32 a205, v15
    v_accvgpr_write_b32 a206, v16
    v_accvgpr_write_b32 a207, v17
    v_accvgpr_read_b32 v14, a208
    v_accvgpr_read_b32 v15, a209
    v_accvgpr_read_b32 v16, a210
    v_accvgpr_read_b32 v17, a211
    v_mul_f32 v14, v14, v21
    v_mul_f32 v15, v15, v21
    v_mul_f32 v16, v16, v21
    v_mul_f32 v17, v17, v21
    v_accvgpr_write_b32 a208, v14
    v_accvgpr_write_b32 a209, v15
    v_accvgpr_write_b32 a210, v16
    v_accvgpr_write_b32 a211, v17
    v_accvgpr_read_b32 v14, a212
    v_accvgpr_read_b32 v15, a213
    v_accvgpr_read_b32 v16, a214
    v_accvgpr_read_b32 v17, a215
    v_mul_f32 v14, v14, v21
    v_mul_f32 v15, v15, v21
    v_mul_f32 v16, v16, v21
    v_mul_f32 v17, v17, v21
    v_accvgpr_write_b32 a212, v14
    v_accvgpr_write_b32 a213, v15
    v_accvgpr_write_b32 a214, v16
    v_accvgpr_write_b32 a215, v17
    v_accvgpr_read_b32 v14, a216
    v_accvgpr_read_b32 v15, a217
    v_accvgpr_read_b32 v16, a218
    v_accvgpr_read_b32 v17, a219
    v_mul_f32 v14, v14, v21
    v_mul_f32 v15, v15, v21
    v_mul_f32 v16, v16, v21
    v_mul_f32 v17, v17, v21
    v_accvgpr_write_b32 a216, v14
    v_accvgpr_write_b32 a217, v15
    v_accvgpr_write_b32 a218, v16
    v_accvgpr_write_b32 a219, v17
    v_accvgpr_read_b32 v14, a220
    v_accvgpr_read_b32 v15, a221
    v_accvgpr_read_b32 v16, a222
    v_accvgpr_read_b32 v17, a223
    v_mul_f32 v14, v14, v21
    v_mul_f32 v15, v15, v21
    v_mul_f32 v16, v16, v21
    v_mul_f32 v17, v17, v21
    v_accvgpr_write_b32 a220, v14
    v_accvgpr_write_b32 a221, v15
    v_accvgpr_write_b32 a222, v16
    v_accvgpr_write_b32 a223, v17
    v_accvgpr_read_b32 v14, a224
    v_accvgpr_read_b32 v15, a225
    v_accvgpr_read_b32 v16, a226
    v_accvgpr_read_b32 v17, a227
    v_mul_f32 v14, v14, v21
    v_mul_f32 v15, v15, v21
    v_mul_f32 v16, v16, v21
    v_mul_f32 v17, v17, v21
    v_accvgpr_write_b32 a224, v14
    v_accvgpr_write_b32 a225, v15
    v_accvgpr_write_b32 a226, v16
    v_accvgpr_write_b32 a227, v17
    v_accvgpr_read_b32 v14, a228
    v_accvgpr_read_b32 v15, a229
    v_accvgpr_read_b32 v16, a230
    v_accvgpr_read_b32 v17, a231
    v_mul_f32 v14, v14, v21
    v_mul_f32 v15, v15, v21
    v_mul_f32 v16, v16, v21
    v_mul_f32 v17, v17, v21
    v_accvgpr_write_b32 a228, v14
    v_accvgpr_write_b32 a229, v15
    v_accvgpr_write_b32 a230, v16
    v_accvgpr_write_b32 a231, v17
    v_accvgpr_read_b32 v14, a232
    v_accvgpr_read_b32 v15, a233
    v_accvgpr_read_b32 v16, a234
    v_accvgpr_read_b32 v17, a235
    v_mul_f32 v14, v14, v21
    v_mul_f32 v15, v15, v21
    v_mul_f32 v16, v16, v21
    v_mul_f32 v17, v17, v21
    v_accvgpr_write_b32 a232, v14
    v_accvgpr_write_b32 a233, v15
    v_accvgpr_write_b32 a234, v16
    v_accvgpr_write_b32 a235, v17
    v_accvgpr_read_b32 v14, a236
    v_accvgpr_read_b32 v15, a237
    v_accvgpr_read_b32 v16, a238
    v_accvgpr_read_b32 v17, a239
    v_mul_f32 v14, v14, v21
    v_mul_f32 v15, v15, v21
    v_mul_f32 v16, v16, v21
    v_mul_f32 v17, v17, v21
    v_accvgpr_write_b32 a236, v14
    v_accvgpr_write_b32 a237, v15
    v_accvgpr_write_b32 a238, v16
    v_accvgpr_write_b32 a239, v17
    v_accvgpr_read_b32 v14, a240
    v_accvgpr_read_b32 v15, a241
    v_accvgpr_read_b32 v16, a242
    v_accvgpr_read_b32 v17, a243
    v_mul_f32 v14, v14, v21
    v_mul_f32 v15, v15, v21
    v_mul_f32 v16, v16, v21
    v_mul_f32 v17, v17, v21
    v_accvgpr_write_b32 a240, v14
    v_accvgpr_write_b32 a241, v15
    v_accvgpr_write_b32 a242, v16
    v_accvgpr_write_b32 a243, v17
    v_accvgpr_read_b32 v14, a244
    v_accvgpr_read_b32 v15, a245
    v_accvgpr_read_b32 v16, a246
    v_accvgpr_read_b32 v17, a247
    v_mul_f32 v14, v14, v21
    v_mul_f32 v15, v15, v21
    v_mul_f32 v16, v16, v21
    v_mul_f32 v17, v17, v21
    v_accvgpr_write_b32 a244, v14
    v_accvgpr_write_b32 a245, v15
    v_accvgpr_write_b32 a246, v16
    v_accvgpr_write_b32 a247, v17
    v_accvgpr_read_b32 v14, a248
    v_accvgpr_read_b32 v15, a249
    v_accvgpr_read_b32 v16, a250
    v_accvgpr_read_b32 v17, a251
    v_mul_f32 v14, v14, v21
    v_mul_f32 v15, v15, v21
    v_mul_f32 v16, v16, v21
    v_mul_f32 v17, v17, v21
    v_accvgpr_write_b32 a248, v14
    v_accvgpr_write_b32 a249, v15
    v_accvgpr_write_b32 a250, v16
    v_accvgpr_write_b32 a251, v17
    v_accvgpr_read_b32 v14, a252
    v_accvgpr_read_b32 v15, a253
    v_accvgpr_read_b32 v16, a254
    v_accvgpr_read_b32 v17, a255
    v_mul_f32 v14, v14, v21
    v_mul_f32 v15, v15, v21
    v_mul_f32 v16, v16, v21
    v_mul_f32 v17, v17, v21
    v_accvgpr_write_b32 a252, v14
    v_accvgpr_write_b32 a253, v15
    v_accvgpr_write_b32 a254, v16
    v_accvgpr_write_b32 a255, v17
    s_nop 3
    s_setpc_b64 s[46:47]
.section .rodata,"a"
.p2align 6
.amdhsa_kernel concat_heads__gqa_block_cached__gqa_block_cached__near_ridge_kernel
  .amdhsa_next_free_vgpr 512
  .amdhsa_next_free_sgpr 102
  .amdhsa_accum_offset 256
  .amdhsa_group_segment_fixed_size 0
  .amdhsa_kernarg_size 104
  .amdhsa_user_sgpr_count 2
  .amdhsa_user_sgpr_kernarg_segment_ptr 1
  .amdhsa_system_sgpr_workgroup_id_x 1
  .amdhsa_float_denorm_mode_32 3
.end_amdhsa_kernel
```
